```python
import torch

def _softmax(x, axis=-1):
    return torch.softmax(x, dim=axis)
def _gelu(x):
    return torch.nn.functional.gelu(x, approximate="tanh")
def _silu(x):
    return torch.nn.functional.silu(x)
def _sigmoid(x):
    return torch.sigmoid(x)
def _layernorm(x, axis=-1, eps=1e-5):
    m = x.mean(dim=axis, keepdim=True)
    v = x.var(dim=axis, keepdim=True, unbiased=False)
    return (x - m) / torch.sqrt(v + eps)
def _scatter_add(tgt, idx, src, axis=0):
    return tgt.clone().index_add_(axis, idx, src)
def _segment_sum(src, seg, n):
    out = torch.zeros((n,) + src.shape[1:], dtype=src.dtype)
    return out.index_add_(0, seg, src)
def _pad(x, pw):
    flat = tuple(v for pair in reversed(pw) for v in pair)
    return torch.nn.functional.pad(x, flat)

kernel_name = 'sequential_preLN__softmax_full_mha__geglu_ffn__prompt'

def setup_inputs():

    _w = (lambda a: (lambda t: t.to(torch.bfloat16) if t.is_floating_point() else t)(torch.as_tensor(a)))
    def _A_setup():
        B, S, D = 1, 2048, 448
        return {
            "x": _w((lambda *s: torch.randn(*s, dtype=torch.bfloat16) * 0.05)(B, S, D)),
            "wqkv": _w((lambda *s: torch.randn(*s, dtype=torch.bfloat16) * 0.05)(D, 3 * D)),
            "wo": _w((lambda *s: torch.randn(*s, dtype=torch.bfloat16) * 0.05)(D, D)),
        }
    _A_in = _A_setup()

    def _B_setup():
        B, S, D, F = 1, 2048, 448, 1792
        return {
            "x": _w((lambda *s: torch.randn(*s, dtype=torch.bfloat16) * 0.05)(B, S, D)),
            "w_gate": _w((lambda *s: torch.randn(*s, dtype=torch.bfloat16) * 0.05)(D, F)),
            "w_up": _w((lambda *s: torch.randn(*s, dtype=torch.bfloat16) * 0.05)(D, F)),
            "w_down": _w((lambda *s: torch.randn(*s, dtype=torch.bfloat16) * 0.05)(F, D)),
        }
    _B_in = _B_setup()

    return {
        "A_x": _A_in["x"],
        "A_wqkv": _A_in["wqkv"],
        "A_wo": _A_in["wo"],
        "B_x": _B_in["x"],
        "B_w_gate": _B_in["w_gate"],
        "B_w_up": _B_in["w_up"],
        "B_w_down": _B_in["w_down"],
    }

def reference(A_x, A_wqkv, A_wo, B_x, B_w_gate, B_w_up, B_w_down):
    def _A_ref(x, wqkv, wo):
        B, S, D = x.shape
        H = 16; Dh = D // H
        qkv = (lambda x, *d: x.permute(*d))((x @ wqkv).reshape(B, S, 3, H, Dh), 2, 0, 3, 1, 4)
        q, k, v = qkv[0], qkv[1], qkv[2]
        scale = Dh ** -0.5
        scores = torch.einsum("bhqd,bhkd->bhqk", q, k) * scale
        p = _softmax(scores, axis=-1)
        o = torch.einsum("bhqk,bhkd->bhqd", p, v)
        return (lambda x, *d: x.permute(*d))(o, 0, 2, 1, 3).reshape(B, S, D) @ wo

    def _B_ref(x, w_gate, w_up, w_down):
        return (_gelu(x @ w_gate) * (x @ w_up)) @ w_down

    x = A_x
    h = x + _A_ref(_layernorm(x, axis=-1), A_wqkv, A_wo)
    h2 = h + _B_ref(_layernorm(h, axis=-1), B_w_gate, B_w_up, B_w_down)
    return h2
```

```asm
; @launch kernel=k1_qkv_kernel grid=(256,1,1) block=(256,1,1) lds=161280
; @launch kernel=k2_attn_kernel grid=(256,1,1) block=(512,1,1) lds=131136
; @launch kernel=k3_wo_kernel grid=(252,1,1) block=(256,1,1) lds=49152
; @launch kernel=k4_ffn_kernel grid=(224,1,1) block=(512,1,1) lds=151552
; @launch kernel=k5_down_kernel grid=(224,1,1) block=(256,1,1) lds=49152
.amdgcn_target "amdgcn-amd-amdhsa--gfx950"
.text
.globl k1_qkv_kernel
.p2align 8
.type k1_qkv_kernel,@function
k1_qkv_kernel:
    s_cmp_ge_u32 s2, 256
    s_cbranch_scc1 k1_qkv_kernel_end
    s_load_dwordx2 s[28:29], s[0:1], 72
    s_load_dwordx2 s[4:5], s[0:1], 0
    s_load_dwordx2 s[6:7], s[0:1], 8
    v_and_b32 v1, 63, v0
    v_lshrrev_b32 v2, 6, v0
    s_and_b32 s30, s2, 7
    s_lshr_b32 s31, s2, 3
    v_readfirstlane_b32 s3, v2
    s_and_b32 s32, s30, 3
    s_lshl_b32 s32, s32, 2
    s_and_b32 s33, s31, 3
    s_add_u32 s32, s32, s33
    s_lshr_b32 s30, s30, 2
    s_lshl_b32 s30, s30, 3
    s_lshr_b32 s31, s31, 2
    s_lshl_b32 s47, s33, 1
    s_add_u32 s47, s47, s31
    s_cmp_ge_u32 s47, 7
    s_cselect_b32 s48, 7, 0
    s_sub_u32 s47, s47, s48
    s_add_u32 s31, s31, s30
    s_mov_b32 s30, s32
    v_lshlrev_b32 v3, 4, v1
    v_and_b32 v12, 31, v1
    v_lshrrev_b32 v8, 5, v1
    v_lshrrev_b32 v4, 3, v1
    v_and_b32 v5, 7, v1
    v_lshrrev_b32 v6, 4, v1
    s_and_b32 s33, s3, 1
    s_lshl_b32 s33, s33, 2
    v_or_b32 v6, s33, v6
    v_xor_b32 v5, v5, v6
    s_movk_i32 s44, 896
    v_mul_u32_u24 v4, s44, v4
    v_lshl_add_u32 v4, v5, 4, v4
    v_lshrrev_b32 v5, 2, v1
    s_movk_i32 s45, 2688
    v_mul_u32_u24 v5, s45, v5
    v_and_b32 v6, 3, v1
    v_lshl_add_u32 v5, v6, 4, v5
    v_min_u32 v13, 223, v0
    v_lshlrev_b32 v13, 4, v13
    v_add_u32 v13, 28672, v13
    v_mov_b32 v52, 0x3f803f80
    v_mov_b32 v53, 0x3f803f80
    v_mov_b32 v54, 0x3f803f80
    v_mov_b32 v55, 0x3f803f80
    v_add_u32 v14, 64512, v13
    v_add_u32 v15, 129024, v13
    ds_write_b128 v13, v[52:55]
    ds_write_b128 v13, v[52:55] offset:32256
    ds_write_b128 v14, v[52:55]
    ds_write_b128 v14, v[52:55] offset:32256
    ds_write_b128 v15, v[52:55]
    s_waitcnt lgkmcnt(0)
    s_mov_b32 s8, s4
    s_mov_b32 s9, s5
    s_mov_b32 s10, 0x1c0000
    s_mov_b32 s11, 0x00020000
    s_mov_b32 s12, s6
    s_mov_b32 s13, s7
    s_mov_b32 s14, 0x126000
    s_mov_b32 s15, 0x00020000
    s_lshl_b32 s33, s31, 17
    s_add_u32 s16, s28, s33
    s_addc_u32 s17, s29, 0
    s_mov_b32 s18, 0x420000
    s_mov_b32 s19, 0x00020000
    s_lshl_b32 s36, s3, 10
    s_lshl_b32 s37, s30, 7
    s_lshl_b32 s38, s3, 3
    s_add_u32 s37, s37, s38
    s_mul_i32 s37, s37, 896
    s_mul_i32 s38, s3, 43008
    s_mul_i32 s39, s31, 56
    s_add_u32 s38, s38, s39
    s_lshl_b32 s48, s47, 7
    s_add_u32 s37, s37, s48
    s_mul_i32 s48, s47, 172032
    s_add_u32 s38, s38, s48
    s_add_u32 m0, s36, 0
    s_add_u32 s39, s37, 0
    buffer_load_dwordx4 v4, s[8:11], s39 offen lds
    s_add_u32 m0, s36, 4096
    s_add_u32 s39, s37, 28672
    buffer_load_dwordx4 v4, s[8:11], s39 offen lds
    s_add_u32 m0, s36, 8192
    s_add_u32 s39, s37, 57344
    buffer_load_dwordx4 v4, s[8:11], s39 offen lds
    s_add_u32 m0, s36, 12288
    s_add_u32 s39, s37, 86016
    buffer_load_dwordx4 v4, s[8:11], s39 offen lds
    s_add_u32 m0, s36, 16384
    s_add_u32 s39, s38, 0
    buffer_load_dwordx4 v5, s[12:15], s39 offen lds
    s_add_u32 m0, s36, 20480
    s_add_u32 s39, s38, 896
    buffer_load_dwordx4 v5, s[12:15], s39 offen lds
    s_add_u32 m0, s36, 24576
    s_add_u32 s39, s38, 1792
    buffer_load_dwordx4 v5, s[12:15], s39 offen lds
    s_add_u32 s37, s37, 128
    s_add_u32 s38, s38, 172032
    s_add_u32 s47, s47, 1
    s_cmp_eq_u32 s47, 7
    s_cselect_b32 s48, 896, 0
    s_cselect_b32 s49, 1204224, 0
    s_sub_u32 s37, s37, s48
    s_sub_u32 s38, s38, s49
    s_add_u32 m0, s36, 32256
    s_add_u32 s39, s37, 0
    buffer_load_dwordx4 v4, s[8:11], s39 offen lds
    s_add_u32 m0, s36, 36352
    s_add_u32 s39, s37, 28672
    buffer_load_dwordx4 v4, s[8:11], s39 offen lds
    s_add_u32 m0, s36, 40448
    s_add_u32 s39, s37, 57344
    buffer_load_dwordx4 v4, s[8:11], s39 offen lds
    s_add_u32 m0, s36, 44544
    s_add_u32 s39, s37, 86016
    buffer_load_dwordx4 v4, s[8:11], s39 offen lds
    s_add_u32 m0, s36, 48640
    s_add_u32 s39, s38, 0
    buffer_load_dwordx4 v5, s[12:15], s39 offen lds
    s_add_u32 m0, s36, 52736
    s_add_u32 s39, s38, 896
    buffer_load_dwordx4 v5, s[12:15], s39 offen lds
    s_add_u32 m0, s36, 56832
    s_add_u32 s39, s38, 1792
    buffer_load_dwordx4 v5, s[12:15], s39 offen lds
    s_add_u32 s37, s37, 128
    s_add_u32 s38, s38, 172032
    s_add_u32 s47, s47, 1
    s_cmp_eq_u32 s47, 7
    s_cselect_b32 s48, 896, 0
    s_cselect_b32 s49, 1204224, 0
    s_sub_u32 s37, s37, s48
    s_sub_u32 s38, s38, s49
    v_bfe_u32 v9, v1, 1, 3
    v_xor_b32 v9, v9, v8
    v_lshlrev_b32 v9, 4, v9
    v_lshl_add_u32 v9, v12, 7, v9
    s_lshl_b32 s40, s3, 12
    v_add_u32 v9, s40, v9
    v_xor_b32 v16, 0, v9
    v_xor_b32 v17, 32, v9
    v_xor_b32 v18, 64, v9
    v_xor_b32 v19, 96, v9
    v_xor_b32 v20, 0, v9
    v_add_u32 v20, 64512, v20
    v_xor_b32 v21, 32, v9
    v_add_u32 v21, 64512, v21
    v_xor_b32 v22, 64, v9
    v_add_u32 v22, 64512, v22
    v_xor_b32 v23, 96, v9
    v_add_u32 v23, 64512, v23
    v_xor_b32 v24, 0, v9
    v_add_u32 v24, 129024, v24
    v_xor_b32 v25, 32, v9
    v_add_u32 v25, 129024, v25
    v_xor_b32 v26, 64, v9
    v_add_u32 v26, 129024, v26
    v_xor_b32 v27, 96, v9
    v_add_u32 v27, 129024, v27
    v_lshlrev_b32 v10, 9, v8
    v_bfe_u32 v11, v1, 2, 2
    v_lshl_add_u32 v10, v11, 6, v10
    v_bfe_u32 v11, v1, 4, 1
    v_lshl_add_u32 v10, v11, 5, v10
    v_and_b32 v11, 3, v1
    v_lshl_add_u32 v28, v11, 3, v10
    v_add_u32 v29, 64512, v28
    v_add_u32 v30, 129024, v28
    v_and_b32 v10, 19, v1
    v_cmp_eq_u32 vcc, 19, v10
    v_mov_b32 v11, 12288
    v_cndmask_b32 v56, v28, v11, vcc
    v_add_u32 v57, 64512, v56
    v_add_u32 v58, 129024, v56
    v_mov_b32 v32, 0
    v_mov_b32 v33, 0
    v_mov_b32 v34, 0
    v_mov_b32 v35, 0
    v_mov_b32 v36, 0
    v_mov_b32 v37, 0
    v_mov_b32 v38, 0
    v_mov_b32 v39, 0
    v_mov_b32 v40, 0
    v_mov_b32 v41, 0
    v_mov_b32 v42, 0
    v_mov_b32 v43, 0
    v_mov_b32 v44, 0
    v_mov_b32 v45, 0
    v_mov_b32 v46, 0
    v_mov_b32 v47, 0
    v_mov_b32 v48, 0
    v_mov_b32 v49, 0
    v_mov_b32 v50, 0
    v_mov_b32 v51, 0
    s_mov_b32 s46, 0x3f803f80
    v_mov_b32 v52, s46
    v_mov_b32 v53, s46
    v_mov_b32 v54, s46
    v_mov_b32 v55, s46
    s_waitcnt vmcnt(7) lgkmcnt(0)
    s_barrier
    ds_read_b128 v[64:67], v16 offset:0
    ds_read_b64_tr_b16 v[68:69], v56 offset:16384
    ds_read_b64_tr_b16 v[70:71], v56 offset:16640
    ds_read_b64_tr_b16 v[72:73], v28 offset:20480
    ds_read_b64_tr_b16 v[74:75], v28 offset:20736
    ds_read_b64_tr_b16 v[76:77], v28 offset:24576
    ds_read_b64_tr_b16 v[78:79], v28 offset:24832
    ds_read_b128 v[80:83], v17 offset:0
    ds_read_b64_tr_b16 v[84:85], v56 offset:17408
    ds_read_b64_tr_b16 v[86:87], v56 offset:17664
    ds_read_b64_tr_b16 v[88:89], v28 offset:21504
    ds_read_b64_tr_b16 v[90:91], v28 offset:21760
    ds_read_b64_tr_b16 v[92:93], v28 offset:25600
    ds_read_b64_tr_b16 v[94:95], v28 offset:25856
    ds_read_b128 v[96:99], v18 offset:0
    ds_read_b64_tr_b16 v[100:101], v56 offset:18432
    ds_read_b64_tr_b16 v[102:103], v56 offset:18688
    ds_read_b64_tr_b16 v[104:105], v28 offset:22528
    ds_read_b64_tr_b16 v[106:107], v28 offset:22784
    ds_read_b64_tr_b16 v[108:109], v28 offset:26624
    ds_read_b64_tr_b16 v[110:111], v28 offset:26880
    ds_read_b128 v[112:115], v19 offset:0
    ds_read_b64_tr_b16 v[116:117], v56 offset:19456
    ds_read_b64_tr_b16 v[118:119], v56 offset:19712
    ds_read_b64_tr_b16 v[120:121], v28 offset:23552
    ds_read_b64_tr_b16 v[122:123], v28 offset:23808
    ds_read_b64_tr_b16 v[124:125], v28 offset:27648
    ds_read_b64_tr_b16 v[126:127], v28 offset:27904
    s_add_u32 m0, s36, 64512
    s_add_u32 s39, s37, 0
    buffer_load_dwordx4 v4, s[8:11], s39 offen lds
    s_add_u32 m0, s36, 68608
    s_add_u32 s39, s37, 28672
    buffer_load_dwordx4 v4, s[8:11], s39 offen lds
    s_add_u32 m0, s36, 72704
    s_add_u32 s39, s37, 57344
    buffer_load_dwordx4 v4, s[8:11], s39 offen lds
    s_add_u32 m0, s36, 76800
    s_add_u32 s39, s37, 86016
    buffer_load_dwordx4 v4, s[8:11], s39 offen lds
    s_add_u32 m0, s36, 80896
    s_add_u32 s39, s38, 0
    buffer_load_dwordx4 v5, s[12:15], s39 offen lds
    s_add_u32 m0, s36, 84992
    s_add_u32 s39, s38, 896
    buffer_load_dwordx4 v5, s[12:15], s39 offen lds
    s_add_u32 m0, s36, 89088
    s_add_u32 s39, s38, 1792
    buffer_load_dwordx4 v5, s[12:15], s39 offen lds
    s_add_u32 s37, s37, 128
    s_add_u32 s38, s38, 172032
    s_add_u32 s47, s47, 1
    s_cmp_eq_u32 s47, 7
    s_cselect_b32 s48, 896, 0
    s_cselect_b32 s49, 1204224, 0
    s_sub_u32 s37, s37, s48
    s_sub_u32 s38, s38, s49
    s_waitcnt vmcnt(7) lgkmcnt(0)
    s_barrier
    v_mfma_f32_32x32x16_bf16 v[192:207], v[68:71], v[64:67], 0
    s_add_u32 m0, s36, 96768
    s_add_u32 s39, s37, 0
    buffer_load_dwordx4 v4, s[8:11], s39 offen lds
    ds_read_b128 v[128:131], v16 offset:32256
    ds_read_b64_tr_b16 v[132:133], v56 offset:48640
    ds_read_b64_tr_b16 v[134:135], v56 offset:48896
    v_mfma_f32_32x32x16_bf16 v[208:223], v[72:75], v[64:67], 0
    s_add_u32 m0, s36, 100864
    s_add_u32 s39, s37, 28672
    buffer_load_dwordx4 v4, s[8:11], s39 offen lds
    ds_read_b64_tr_b16 v[136:137], v28 offset:52736
    ds_read_b64_tr_b16 v[138:139], v28 offset:52992
    ds_read_b64_tr_b16 v[140:141], v28 offset:56832
    v_mfma_f32_32x32x16_bf16 v[224:239], v[64:67], v[76:79], 0
    s_add_u32 m0, s36, 104960
    s_add_u32 s39, s37, 57344
    buffer_load_dwordx4 v4, s[8:11], s39 offen lds
    ds_read_b64_tr_b16 v[142:143], v28 offset:57088
    ds_read_b128 v[144:147], v17 offset:32256
    ds_read_b64_tr_b16 v[148:149], v56 offset:49664
    v_mfma_f32_32x32x16_bf16 v[192:207], v[84:87], v[80:83], v[192:207]
    s_add_u32 m0, s36, 109056
    s_add_u32 s39, s37, 86016
    buffer_load_dwordx4 v4, s[8:11], s39 offen lds
    ds_read_b64_tr_b16 v[150:151], v56 offset:49920
    ds_read_b64_tr_b16 v[152:153], v28 offset:53760
    ds_read_b64_tr_b16 v[154:155], v28 offset:54016
    v_mfma_f32_32x32x16_bf16 v[208:223], v[88:91], v[80:83], v[208:223]
    s_add_u32 m0, s36, 113152
    s_add_u32 s39, s38, 0
    buffer_load_dwordx4 v5, s[12:15], s39 offen lds
    ds_read_b64_tr_b16 v[156:157], v28 offset:57856
    ds_read_b64_tr_b16 v[158:159], v28 offset:58112
    ds_read_b128 v[160:163], v18 offset:32256
    v_dot2_f32_bf16 v36, v64, v64, v36
    v_dot2_f32_bf16 v37, v65, v65, v37
    v_mfma_f32_32x32x16_bf16 v[224:239], v[80:83], v[92:95], v[224:239]
    s_add_u32 m0, s36, 117248
    s_add_u32 s39, s38, 896
    buffer_load_dwordx4 v5, s[12:15], s39 offen lds
    ds_read_b64_tr_b16 v[164:165], v56 offset:50688
    ds_read_b64_tr_b16 v[166:167], v56 offset:50944
    ds_read_b64_tr_b16 v[168:169], v28 offset:54784
    v_dot2_f32_bf16 v38, v66, v66, v38
    v_dot2_f32_bf16 v39, v67, v67, v39
    v_mfma_f32_32x32x16_bf16 v[192:207], v[100:103], v[96:99], v[192:207]
    s_add_u32 m0, s36, 121344
    s_add_u32 s39, s38, 1792
    buffer_load_dwordx4 v5, s[12:15], s39 offen lds
    s_add_u32 s37, s37, 128
    s_add_u32 s38, s38, 172032
    s_add_u32 s47, s47, 1
    s_cmp_eq_u32 s47, 7
    s_cselect_b32 s48, 896, 0
    s_cselect_b32 s49, 1204224, 0
    s_sub_u32 s37, s37, s48
    s_sub_u32 s38, s38, s49
    ds_read_b64_tr_b16 v[170:171], v28 offset:55040
    ds_read_b64_tr_b16 v[172:173], v28 offset:58880
    ds_read_b64_tr_b16 v[174:175], v28 offset:59136
    v_dot2_f32_bf16 v36, v80, v80, v36
    v_dot2_f32_bf16 v37, v81, v81, v37
    v_mfma_f32_32x32x16_bf16 v[208:223], v[104:107], v[96:99], v[208:223]
    ds_read_b128 v[176:179], v19 offset:32256
    ds_read_b64_tr_b16 v[180:181], v56 offset:51712
    ds_read_b64_tr_b16 v[182:183], v56 offset:51968
    v_dot2_f32_bf16 v38, v82, v82, v38
    v_dot2_f32_bf16 v39, v83, v83, v39
    v_mfma_f32_32x32x16_bf16 v[224:239], v[96:99], v[108:111], v[224:239]
    ds_read_b64_tr_b16 v[184:185], v28 offset:55808
    ds_read_b64_tr_b16 v[186:187], v28 offset:56064
    ds_read_b64_tr_b16 v[188:189], v28 offset:59904
    v_dot2_f32_bf16 v36, v96, v96, v36
    v_dot2_f32_bf16 v37, v97, v97, v37
    v_mfma_f32_32x32x16_bf16 v[192:207], v[116:119], v[112:115], v[192:207]
    ds_read_b64_tr_b16 v[190:191], v28 offset:60160
    v_dot2_f32_bf16 v38, v98, v98, v38
    v_dot2_f32_bf16 v39, v99, v99, v39
    v_mfma_f32_32x32x16_bf16 v[208:223], v[120:123], v[112:115], v[208:223]
    v_dot2_f32_bf16 v36, v112, v112, v36
    v_dot2_f32_bf16 v37, v113, v113, v37
    v_mfma_f32_32x32x16_bf16 v[224:239], v[112:115], v[124:127], v[224:239]
    v_dot2_f32_bf16 v38, v114, v114, v38
    v_dot2_f32_bf16 v39, v115, v115, v39
    s_cmp_eq_u32 s3, 0
    s_cbranch_scc0 k1_qkv_kernel_cs2
    v_dot2_f32_bf16 v40, v68, s46, v40
    v_dot2_f32_bf16 v41, v69, s46, v41
    v_dot2_f32_bf16 v42, v70, s46, v42
    v_dot2_f32_bf16 v43, v71, s46, v43
    v_dot2_f32_bf16 v44, v72, s46, v44
    v_dot2_f32_bf16 v45, v73, s46, v45
    v_dot2_f32_bf16 v46, v74, s46, v46
    v_dot2_f32_bf16 v47, v75, s46, v47
    v_dot2_f32_bf16 v48, v76, s46, v48
    v_dot2_f32_bf16 v49, v77, s46, v49
    v_dot2_f32_bf16 v50, v78, s46, v50
    v_dot2_f32_bf16 v51, v79, s46, v51
    s_branch k1_qkv_kernel_csd1
k1_qkv_kernel_cs2:
    s_cmp_eq_u32 s3, 1
    s_cbranch_scc0 k1_qkv_kernel_cs3
    v_dot2_f32_bf16 v40, v84, s46, v40
    v_dot2_f32_bf16 v41, v85, s46, v41
    v_dot2_f32_bf16 v42, v86, s46, v42
    v_dot2_f32_bf16 v43, v87, s46, v43
    v_dot2_f32_bf16 v44, v88, s46, v44
    v_dot2_f32_bf16 v45, v89, s46, v45
    v_dot2_f32_bf16 v46, v90, s46, v46
    v_dot2_f32_bf16 v47, v91, s46, v47
    v_dot2_f32_bf16 v48, v92, s46, v48
    v_dot2_f32_bf16 v49, v93, s46, v49
    v_dot2_f32_bf16 v50, v94, s46, v50
    v_dot2_f32_bf16 v51, v95, s46, v51
    s_branch k1_qkv_kernel_csd1
k1_qkv_kernel_cs3:
    s_cmp_eq_u32 s3, 2
    s_cbranch_scc0 k1_qkv_kernel_cs4
    v_dot2_f32_bf16 v40, v100, s46, v40
    v_dot2_f32_bf16 v41, v101, s46, v41
    v_dot2_f32_bf16 v42, v102, s46, v42
    v_dot2_f32_bf16 v43, v103, s46, v43
    v_dot2_f32_bf16 v44, v104, s46, v44
    v_dot2_f32_bf16 v45, v105, s46, v45
    v_dot2_f32_bf16 v46, v106, s46, v46
    v_dot2_f32_bf16 v47, v107, s46, v47
    v_dot2_f32_bf16 v48, v108, s46, v48
    v_dot2_f32_bf16 v49, v109, s46, v49
    v_dot2_f32_bf16 v50, v110, s46, v50
    v_dot2_f32_bf16 v51, v111, s46, v51
    s_branch k1_qkv_kernel_csd1
k1_qkv_kernel_cs4:
    v_dot2_f32_bf16 v40, v116, s46, v40
    v_dot2_f32_bf16 v41, v117, s46, v41
    v_dot2_f32_bf16 v42, v118, s46, v42
    v_dot2_f32_bf16 v43, v119, s46, v43
    v_dot2_f32_bf16 v44, v120, s46, v44
    v_dot2_f32_bf16 v45, v121, s46, v45
    v_dot2_f32_bf16 v46, v122, s46, v46
    v_dot2_f32_bf16 v47, v123, s46, v47
    v_dot2_f32_bf16 v48, v124, s46, v48
    v_dot2_f32_bf16 v49, v125, s46, v49
    v_dot2_f32_bf16 v50, v126, s46, v50
    v_dot2_f32_bf16 v51, v127, s46, v51
k1_qkv_kernel_csd1:
    s_waitcnt vmcnt(7) lgkmcnt(0)
    s_barrier
    v_mfma_f32_32x32x16_bf16 v[192:207], v[132:135], v[128:131], v[192:207]
    s_add_u32 m0, s36, 129024
    s_add_u32 s39, s37, 0
    buffer_load_dwordx4 v4, s[8:11], s39 offen lds
    ds_read_b128 v[64:67], v20 offset:0
    ds_read_b64_tr_b16 v[68:69], v57 offset:16384
    ds_read_b64_tr_b16 v[70:71], v57 offset:16640
    v_mfma_f32_32x32x16_bf16 v[208:223], v[136:139], v[128:131], v[208:223]
    s_add_u32 m0, s36, 133120
    s_add_u32 s39, s37, 28672
    buffer_load_dwordx4 v4, s[8:11], s39 offen lds
    ds_read_b64_tr_b16 v[72:73], v29 offset:20480
    ds_read_b64_tr_b16 v[74:75], v29 offset:20736
    ds_read_b64_tr_b16 v[76:77], v29 offset:24576
    v_mfma_f32_32x32x16_bf16 v[224:239], v[128:131], v[140:143], v[224:239]
    s_add_u32 m0, s36, 137216
    s_add_u32 s39, s37, 57344
    buffer_load_dwordx4 v4, s[8:11], s39 offen lds
    ds_read_b64_tr_b16 v[78:79], v29 offset:24832
    ds_read_b128 v[80:83], v21 offset:0
    ds_read_b64_tr_b16 v[84:85], v57 offset:17408
    v_mfma_f32_32x32x16_bf16 v[192:207], v[148:151], v[144:147], v[192:207]
    s_add_u32 m0, s36, 141312
    s_add_u32 s39, s37, 86016
    buffer_load_dwordx4 v4, s[8:11], s39 offen lds
    ds_read_b64_tr_b16 v[86:87], v57 offset:17664
    ds_read_b64_tr_b16 v[88:89], v29 offset:21504
    ds_read_b64_tr_b16 v[90:91], v29 offset:21760
    v_mfma_f32_32x32x16_bf16 v[208:223], v[152:155], v[144:147], v[208:223]
    s_add_u32 m0, s36, 145408
    s_add_u32 s39, s38, 0
    buffer_load_dwordx4 v5, s[12:15], s39 offen lds
    ds_read_b64_tr_b16 v[92:93], v29 offset:25600
    ds_read_b64_tr_b16 v[94:95], v29 offset:25856
    ds_read_b128 v[96:99], v22 offset:0
    v_dot2_f32_bf16 v36, v128, v128, v36
    v_dot2_f32_bf16 v37, v129, v129, v37
    v_mfma_f32_32x32x16_bf16 v[224:239], v[144:147], v[156:159], v[224:239]
    s_add_u32 m0, s36, 149504
    s_add_u32 s39, s38, 896
    buffer_load_dwordx4 v5, s[12:15], s39 offen lds
    ds_read_b64_tr_b16 v[100:101], v57 offset:18432
    ds_read_b64_tr_b16 v[102:103], v57 offset:18688
    ds_read_b64_tr_b16 v[104:105], v29 offset:22528
    v_dot2_f32_bf16 v38, v130, v130, v38
    v_dot2_f32_bf16 v39, v131, v131, v39
    v_mfma_f32_32x32x16_bf16 v[192:207], v[164:167], v[160:163], v[192:207]
    s_add_u32 m0, s36, 153600
    s_add_u32 s39, s38, 1792
    buffer_load_dwordx4 v5, s[12:15], s39 offen lds
    s_add_u32 s37, s37, 128
    s_add_u32 s38, s38, 172032
    s_add_u32 s47, s47, 1
    s_cmp_eq_u32 s47, 7
    s_cselect_b32 s48, 896, 0
    s_cselect_b32 s49, 1204224, 0
    s_sub_u32 s37, s37, s48
    s_sub_u32 s38, s38, s49
    ds_read_b64_tr_b16 v[106:107], v29 offset:22784
    ds_read_b64_tr_b16 v[108:109], v29 offset:26624
    ds_read_b64_tr_b16 v[110:111], v29 offset:26880
    v_dot2_f32_bf16 v36, v144, v144, v36
    v_dot2_f32_bf16 v37, v145, v145, v37
    v_mfma_f32_32x32x16_bf16 v[208:223], v[168:171], v[160:163], v[208:223]
    ds_read_b128 v[112:115], v23 offset:0
    ds_read_b64_tr_b16 v[116:117], v57 offset:19456
    ds_read_b64_tr_b16 v[118:119], v57 offset:19712
    v_dot2_f32_bf16 v38, v146, v146, v38
    v_dot2_f32_bf16 v39, v147, v147, v39
    v_mfma_f32_32x32x16_bf16 v[224:239], v[160:163], v[172:175], v[224:239]
    ds_read_b64_tr_b16 v[120:121], v29 offset:23552
    ds_read_b64_tr_b16 v[122:123], v29 offset:23808
    ds_read_b64_tr_b16 v[124:125], v29 offset:27648
    v_dot2_f32_bf16 v36, v160, v160, v36
    v_dot2_f32_bf16 v37, v161, v161, v37
    v_mfma_f32_32x32x16_bf16 v[192:207], v[180:183], v[176:179], v[192:207]
    ds_read_b64_tr_b16 v[126:127], v29 offset:27904
    v_dot2_f32_bf16 v38, v162, v162, v38
    v_dot2_f32_bf16 v39, v163, v163, v39
    v_mfma_f32_32x32x16_bf16 v[208:223], v[184:187], v[176:179], v[208:223]
    v_dot2_f32_bf16 v36, v176, v176, v36
    v_dot2_f32_bf16 v37, v177, v177, v37
    v_mfma_f32_32x32x16_bf16 v[224:239], v[176:179], v[188:191], v[224:239]
    v_dot2_f32_bf16 v38, v178, v178, v38
    v_dot2_f32_bf16 v39, v179, v179, v39
    s_cmp_eq_u32 s3, 0
    s_cbranch_scc0 k1_qkv_kernel_cs7
    v_dot2_f32_bf16 v40, v132, s46, v40
    v_dot2_f32_bf16 v41, v133, s46, v41
    v_dot2_f32_bf16 v42, v134, s46, v42
    v_dot2_f32_bf16 v43, v135, s46, v43
    v_dot2_f32_bf16 v44, v136, s46, v44
    v_dot2_f32_bf16 v45, v137, s46, v45
    v_dot2_f32_bf16 v46, v138, s46, v46
    v_dot2_f32_bf16 v47, v139, s46, v47
    v_dot2_f32_bf16 v48, v140, s46, v48
    v_dot2_f32_bf16 v49, v141, s46, v49
    v_dot2_f32_bf16 v50, v142, s46, v50
    v_dot2_f32_bf16 v51, v143, s46, v51
    s_branch k1_qkv_kernel_csd6
k1_qkv_kernel_cs7:
    s_cmp_eq_u32 s3, 1
    s_cbranch_scc0 k1_qkv_kernel_cs8
    v_dot2_f32_bf16 v40, v148, s46, v40
    v_dot2_f32_bf16 v41, v149, s46, v41
    v_dot2_f32_bf16 v42, v150, s46, v42
    v_dot2_f32_bf16 v43, v151, s46, v43
    v_dot2_f32_bf16 v44, v152, s46, v44
    v_dot2_f32_bf16 v45, v153, s46, v45
    v_dot2_f32_bf16 v46, v154, s46, v46
    v_dot2_f32_bf16 v47, v155, s46, v47
    v_dot2_f32_bf16 v48, v156, s46, v48
    v_dot2_f32_bf16 v49, v157, s46, v49
    v_dot2_f32_bf16 v50, v158, s46, v50
    v_dot2_f32_bf16 v51, v159, s46, v51
    s_branch k1_qkv_kernel_csd6
k1_qkv_kernel_cs8:
    s_cmp_eq_u32 s3, 2
    s_cbranch_scc0 k1_qkv_kernel_cs9
    v_dot2_f32_bf16 v40, v164, s46, v40
    v_dot2_f32_bf16 v41, v165, s46, v41
    v_dot2_f32_bf16 v42, v166, s46, v42
    v_dot2_f32_bf16 v43, v167, s46, v43
    v_dot2_f32_bf16 v44, v168, s46, v44
    v_dot2_f32_bf16 v45, v169, s46, v45
    v_dot2_f32_bf16 v46, v170, s46, v46
    v_dot2_f32_bf16 v47, v171, s46, v47
    v_dot2_f32_bf16 v48, v172, s46, v48
    v_dot2_f32_bf16 v49, v173, s46, v49
    v_dot2_f32_bf16 v50, v174, s46, v50
    v_dot2_f32_bf16 v51, v175, s46, v51
    s_branch k1_qkv_kernel_csd6
k1_qkv_kernel_cs9:
    v_dot2_f32_bf16 v40, v180, s46, v40
    v_dot2_f32_bf16 v41, v181, s46, v41
    v_dot2_f32_bf16 v42, v182, s46, v42
    v_dot2_f32_bf16 v43, v183, s46, v43
    v_dot2_f32_bf16 v44, v184, s46, v44
    v_dot2_f32_bf16 v45, v185, s46, v45
    v_dot2_f32_bf16 v46, v186, s46, v46
    v_dot2_f32_bf16 v47, v187, s46, v47
    v_dot2_f32_bf16 v48, v188, s46, v48
    v_dot2_f32_bf16 v49, v189, s46, v49
    v_dot2_f32_bf16 v50, v190, s46, v50
    v_dot2_f32_bf16 v51, v191, s46, v51
k1_qkv_kernel_csd6:
    s_waitcnt vmcnt(7) lgkmcnt(0)
    s_barrier
    v_mfma_f32_32x32x16_bf16 v[192:207], v[68:71], v[64:67], v[192:207]
    s_add_u32 m0, s36, 0
    s_add_u32 s39, s37, 0
    buffer_load_dwordx4 v4, s[8:11], s39 offen lds
    ds_read_b128 v[128:131], v20 offset:32256
    ds_read_b64_tr_b16 v[132:133], v57 offset:48640
    ds_read_b64_tr_b16 v[134:135], v57 offset:48896
    v_mfma_f32_32x32x16_bf16 v[208:223], v[72:75], v[64:67], v[208:223]
    s_add_u32 m0, s36, 4096
    s_add_u32 s39, s37, 28672
    buffer_load_dwordx4 v4, s[8:11], s39 offen lds
    ds_read_b64_tr_b16 v[136:137], v29 offset:52736
    ds_read_b64_tr_b16 v[138:139], v29 offset:52992
    ds_read_b64_tr_b16 v[140:141], v29 offset:56832
    v_mfma_f32_32x32x16_bf16 v[224:239], v[64:67], v[76:79], v[224:239]
    s_add_u32 m0, s36, 8192
    s_add_u32 s39, s37, 57344
    buffer_load_dwordx4 v4, s[8:11], s39 offen lds
    ds_read_b64_tr_b16 v[142:143], v29 offset:57088
    ds_read_b128 v[144:147], v21 offset:32256
    ds_read_b64_tr_b16 v[148:149], v57 offset:49664
    v_mfma_f32_32x32x16_bf16 v[192:207], v[84:87], v[80:83], v[192:207]
    s_add_u32 m0, s36, 12288
    s_add_u32 s39, s37, 86016
    buffer_load_dwordx4 v4, s[8:11], s39 offen lds
    ds_read_b64_tr_b16 v[150:151], v57 offset:49920
    ds_read_b64_tr_b16 v[152:153], v29 offset:53760
    ds_read_b64_tr_b16 v[154:155], v29 offset:54016
    v_mfma_f32_32x32x16_bf16 v[208:223], v[88:91], v[80:83], v[208:223]
    s_add_u32 m0, s36, 16384
    s_add_u32 s39, s38, 0
    buffer_load_dwordx4 v5, s[12:15], s39 offen lds
    ds_read_b64_tr_b16 v[156:157], v29 offset:57856
    ds_read_b64_tr_b16 v[158:159], v29 offset:58112
    ds_read_b128 v[160:163], v22 offset:32256
    v_dot2_f32_bf16 v36, v64, v64, v36
    v_dot2_f32_bf16 v37, v65, v65, v37
    v_mfma_f32_32x32x16_bf16 v[224:239], v[80:83], v[92:95], v[224:239]
    s_add_u32 m0, s36, 20480
    s_add_u32 s39, s38, 896
    buffer_load_dwordx4 v5, s[12:15], s39 offen lds
    ds_read_b64_tr_b16 v[164:165], v57 offset:50688
    ds_read_b64_tr_b16 v[166:167], v57 offset:50944
    ds_read_b64_tr_b16 v[168:169], v29 offset:54784
    v_dot2_f32_bf16 v38, v66, v66, v38
    v_dot2_f32_bf16 v39, v67, v67, v39
    v_mfma_f32_32x32x16_bf16 v[192:207], v[100:103], v[96:99], v[192:207]
    s_add_u32 m0, s36, 24576
    s_add_u32 s39, s38, 1792
    buffer_load_dwordx4 v5, s[12:15], s39 offen lds
    s_add_u32 s37, s37, 128
    s_add_u32 s38, s38, 172032
    s_add_u32 s47, s47, 1
    s_cmp_eq_u32 s47, 7
    s_cselect_b32 s48, 896, 0
    s_cselect_b32 s49, 1204224, 0
    s_sub_u32 s37, s37, s48
    s_sub_u32 s38, s38, s49
    ds_read_b64_tr_b16 v[170:171], v29 offset:55040
    ds_read_b64_tr_b16 v[172:173], v29 offset:58880
    ds_read_b64_tr_b16 v[174:175], v29 offset:59136
    v_dot2_f32_bf16 v36, v80, v80, v36
    v_dot2_f32_bf16 v37, v81, v81, v37
    v_mfma_f32_32x32x16_bf16 v[208:223], v[104:107], v[96:99], v[208:223]
    ds_read_b128 v[176:179], v23 offset:32256
    ds_read_b64_tr_b16 v[180:181], v57 offset:51712
    ds_read_b64_tr_b16 v[182:183], v57 offset:51968
    v_dot2_f32_bf16 v38, v82, v82, v38
    v_dot2_f32_bf16 v39, v83, v83, v39
    v_mfma_f32_32x32x16_bf16 v[224:239], v[96:99], v[108:111], v[224:239]
    ds_read_b64_tr_b16 v[184:185], v29 offset:55808
    ds_read_b64_tr_b16 v[186:187], v29 offset:56064
    ds_read_b64_tr_b16 v[188:189], v29 offset:59904
    v_dot2_f32_bf16 v36, v96, v96, v36
    v_dot2_f32_bf16 v37, v97, v97, v37
    v_mfma_f32_32x32x16_bf16 v[192:207], v[116:119], v[112:115], v[192:207]
    ds_read_b64_tr_b16 v[190:191], v29 offset:60160
    v_dot2_f32_bf16 v38, v98, v98, v38
    v_dot2_f32_bf16 v39, v99, v99, v39
    v_mfma_f32_32x32x16_bf16 v[208:223], v[120:123], v[112:115], v[208:223]
    v_dot2_f32_bf16 v36, v112, v112, v36
    v_dot2_f32_bf16 v37, v113, v113, v37
    v_mfma_f32_32x32x16_bf16 v[224:239], v[112:115], v[124:127], v[224:239]
    v_dot2_f32_bf16 v38, v114, v114, v38
    v_dot2_f32_bf16 v39, v115, v115, v39
    s_cmp_eq_u32 s3, 0
    s_cbranch_scc0 k1_qkv_kernel_cs12
    v_dot2_f32_bf16 v40, v68, s46, v40
    v_dot2_f32_bf16 v41, v69, s46, v41
    v_dot2_f32_bf16 v42, v70, s46, v42
    v_dot2_f32_bf16 v43, v71, s46, v43
    v_dot2_f32_bf16 v44, v72, s46, v44
    v_dot2_f32_bf16 v45, v73, s46, v45
    v_dot2_f32_bf16 v46, v74, s46, v46
    v_dot2_f32_bf16 v47, v75, s46, v47
    v_dot2_f32_bf16 v48, v76, s46, v48
    v_dot2_f32_bf16 v49, v77, s46, v49
    v_dot2_f32_bf16 v50, v78, s46, v50
    v_dot2_f32_bf16 v51, v79, s46, v51
    s_branch k1_qkv_kernel_csd11
k1_qkv_kernel_cs12:
    s_cmp_eq_u32 s3, 1
    s_cbranch_scc0 k1_qkv_kernel_cs13
    v_dot2_f32_bf16 v40, v84, s46, v40
    v_dot2_f32_bf16 v41, v85, s46, v41
    v_dot2_f32_bf16 v42, v86, s46, v42
    v_dot2_f32_bf16 v43, v87, s46, v43
    v_dot2_f32_bf16 v44, v88, s46, v44
    v_dot2_f32_bf16 v45, v89, s46, v45
    v_dot2_f32_bf16 v46, v90, s46, v46
    v_dot2_f32_bf16 v47, v91, s46, v47
    v_dot2_f32_bf16 v48, v92, s46, v48
    v_dot2_f32_bf16 v49, v93, s46, v49
    v_dot2_f32_bf16 v50, v94, s46, v50
    v_dot2_f32_bf16 v51, v95, s46, v51
    s_branch k1_qkv_kernel_csd11
k1_qkv_kernel_cs13:
    s_cmp_eq_u32 s3, 2
    s_cbranch_scc0 k1_qkv_kernel_cs14
    v_dot2_f32_bf16 v40, v100, s46, v40
    v_dot2_f32_bf16 v41, v101, s46, v41
    v_dot2_f32_bf16 v42, v102, s46, v42
    v_dot2_f32_bf16 v43, v103, s46, v43
    v_dot2_f32_bf16 v44, v104, s46, v44
    v_dot2_f32_bf16 v45, v105, s46, v45
    v_dot2_f32_bf16 v46, v106, s46, v46
    v_dot2_f32_bf16 v47, v107, s46, v47
    v_dot2_f32_bf16 v48, v108, s46, v48
    v_dot2_f32_bf16 v49, v109, s46, v49
    v_dot2_f32_bf16 v50, v110, s46, v50
    v_dot2_f32_bf16 v51, v111, s46, v51
    s_branch k1_qkv_kernel_csd11
k1_qkv_kernel_cs14:
    v_dot2_f32_bf16 v40, v116, s46, v40
    v_dot2_f32_bf16 v41, v117, s46, v41
    v_dot2_f32_bf16 v42, v118, s46, v42
    v_dot2_f32_bf16 v43, v119, s46, v43
    v_dot2_f32_bf16 v44, v120, s46, v44
    v_dot2_f32_bf16 v45, v121, s46, v45
    v_dot2_f32_bf16 v46, v122, s46, v46
    v_dot2_f32_bf16 v47, v123, s46, v47
    v_dot2_f32_bf16 v48, v124, s46, v48
    v_dot2_f32_bf16 v49, v125, s46, v49
    v_dot2_f32_bf16 v50, v126, s46, v50
    v_dot2_f32_bf16 v51, v127, s46, v51
k1_qkv_kernel_csd11:
    s_waitcnt vmcnt(7) lgkmcnt(0)
    s_barrier
    v_mfma_f32_32x32x16_bf16 v[192:207], v[132:135], v[128:131], v[192:207]
    s_add_u32 m0, s36, 32256
    s_add_u32 s39, s37, 0
    buffer_load_dwordx4 v4, s[8:11], s39 offen lds
    ds_read_b128 v[64:67], v24 offset:0
    ds_read_b64_tr_b16 v[68:69], v58 offset:16384
    ds_read_b64_tr_b16 v[70:71], v58 offset:16640
    v_mfma_f32_32x32x16_bf16 v[208:223], v[136:139], v[128:131], v[208:223]
    s_add_u32 m0, s36, 36352
    s_add_u32 s39, s37, 28672
    buffer_load_dwordx4 v4, s[8:11], s39 offen lds
    ds_read_b64_tr_b16 v[72:73], v30 offset:20480
    ds_read_b64_tr_b16 v[74:75], v30 offset:20736
    ds_read_b64_tr_b16 v[76:77], v30 offset:24576
    v_mfma_f32_32x32x16_bf16 v[224:239], v[128:131], v[140:143], v[224:239]
    s_add_u32 m0, s36, 40448
    s_add_u32 s39, s37, 57344
    buffer_load_dwordx4 v4, s[8:11], s39 offen lds
    ds_read_b64_tr_b16 v[78:79], v30 offset:24832
    ds_read_b128 v[80:83], v25 offset:0
    ds_read_b64_tr_b16 v[84:85], v58 offset:17408
    v_mfma_f32_32x32x16_bf16 v[192:207], v[148:151], v[144:147], v[192:207]
    s_add_u32 m0, s36, 44544
    s_add_u32 s39, s37, 86016
    buffer_load_dwordx4 v4, s[8:11], s39 offen lds
    ds_read_b64_tr_b16 v[86:87], v58 offset:17664
    ds_read_b64_tr_b16 v[88:89], v30 offset:21504
    ds_read_b64_tr_b16 v[90:91], v30 offset:21760
    v_mfma_f32_32x32x16_bf16 v[208:223], v[152:155], v[144:147], v[208:223]
    s_add_u32 m0, s36, 48640
    s_add_u32 s39, s38, 0
    buffer_load_dwordx4 v5, s[12:15], s39 offen lds
    ds_read_b64_tr_b16 v[92:93], v30 offset:25600
    ds_read_b64_tr_b16 v[94:95], v30 offset:25856
    ds_read_b128 v[96:99], v26 offset:0
    v_dot2_f32_bf16 v36, v128, v128, v36
    v_dot2_f32_bf16 v37, v129, v129, v37
    v_mfma_f32_32x32x16_bf16 v[224:239], v[144:147], v[156:159], v[224:239]
    s_add_u32 m0, s36, 52736
    s_add_u32 s39, s38, 896
    buffer_load_dwordx4 v5, s[12:15], s39 offen lds
    ds_read_b64_tr_b16 v[100:101], v58 offset:18432
    ds_read_b64_tr_b16 v[102:103], v58 offset:18688
    ds_read_b64_tr_b16 v[104:105], v30 offset:22528
    v_dot2_f32_bf16 v38, v130, v130, v38
    v_dot2_f32_bf16 v39, v131, v131, v39
    v_mfma_f32_32x32x16_bf16 v[192:207], v[164:167], v[160:163], v[192:207]
    s_add_u32 m0, s36, 56832
    s_add_u32 s39, s38, 1792
    buffer_load_dwordx4 v5, s[12:15], s39 offen lds
    s_add_u32 s37, s37, 128
    s_add_u32 s38, s38, 172032
    s_add_u32 s47, s47, 1
    s_cmp_eq_u32 s47, 7
    s_cselect_b32 s48, 896, 0
    s_cselect_b32 s49, 1204224, 0
    s_sub_u32 s37, s37, s48
    s_sub_u32 s38, s38, s49
    ds_read_b64_tr_b16 v[106:107], v30 offset:22784
    ds_read_b64_tr_b16 v[108:109], v30 offset:26624
    ds_read_b64_tr_b16 v[110:111], v30 offset:26880
    v_dot2_f32_bf16 v36, v144, v144, v36
    v_dot2_f32_bf16 v37, v145, v145, v37
    v_mfma_f32_32x32x16_bf16 v[208:223], v[168:171], v[160:163], v[208:223]
    ds_read_b128 v[112:115], v27 offset:0
    ds_read_b64_tr_b16 v[116:117], v58 offset:19456
    ds_read_b64_tr_b16 v[118:119], v58 offset:19712
    v_dot2_f32_bf16 v38, v146, v146, v38
    v_dot2_f32_bf16 v39, v147, v147, v39
    v_mfma_f32_32x32x16_bf16 v[224:239], v[160:163], v[172:175], v[224:239]
    ds_read_b64_tr_b16 v[120:121], v30 offset:23552
    ds_read_b64_tr_b16 v[122:123], v30 offset:23808
    ds_read_b64_tr_b16 v[124:125], v30 offset:27648
    v_dot2_f32_bf16 v36, v160, v160, v36
    v_dot2_f32_bf16 v37, v161, v161, v37
    v_mfma_f32_32x32x16_bf16 v[192:207], v[180:183], v[176:179], v[192:207]
    ds_read_b64_tr_b16 v[126:127], v30 offset:27904
    v_dot2_f32_bf16 v38, v162, v162, v38
    v_dot2_f32_bf16 v39, v163, v163, v39
    v_mfma_f32_32x32x16_bf16 v[208:223], v[184:187], v[176:179], v[208:223]
    v_dot2_f32_bf16 v36, v176, v176, v36
    v_dot2_f32_bf16 v37, v177, v177, v37
    v_mfma_f32_32x32x16_bf16 v[224:239], v[176:179], v[188:191], v[224:239]
    v_dot2_f32_bf16 v38, v178, v178, v38
    v_dot2_f32_bf16 v39, v179, v179, v39
    s_cmp_eq_u32 s3, 0
    s_cbranch_scc0 k1_qkv_kernel_cs17
    v_dot2_f32_bf16 v40, v132, s46, v40
    v_dot2_f32_bf16 v41, v133, s46, v41
    v_dot2_f32_bf16 v42, v134, s46, v42
    v_dot2_f32_bf16 v43, v135, s46, v43
    v_dot2_f32_bf16 v44, v136, s46, v44
    v_dot2_f32_bf16 v45, v137, s46, v45
    v_dot2_f32_bf16 v46, v138, s46, v46
    v_dot2_f32_bf16 v47, v139, s46, v47
    v_dot2_f32_bf16 v48, v140, s46, v48
    v_dot2_f32_bf16 v49, v141, s46, v49
    v_dot2_f32_bf16 v50, v142, s46, v50
    v_dot2_f32_bf16 v51, v143, s46, v51
    s_branch k1_qkv_kernel_csd16
k1_qkv_kernel_cs17:
    s_cmp_eq_u32 s3, 1
    s_cbranch_scc0 k1_qkv_kernel_cs18
    v_dot2_f32_bf16 v40, v148, s46, v40
    v_dot2_f32_bf16 v41, v149, s46, v41
    v_dot2_f32_bf16 v42, v150, s46, v42
    v_dot2_f32_bf16 v43, v151, s46, v43
    v_dot2_f32_bf16 v44, v152, s46, v44
    v_dot2_f32_bf16 v45, v153, s46, v45
    v_dot2_f32_bf16 v46, v154, s46, v46
    v_dot2_f32_bf16 v47, v155, s46, v47
    v_dot2_f32_bf16 v48, v156, s46, v48
    v_dot2_f32_bf16 v49, v157, s46, v49
    v_dot2_f32_bf16 v50, v158, s46, v50
    v_dot2_f32_bf16 v51, v159, s46, v51
    s_branch k1_qkv_kernel_csd16
k1_qkv_kernel_cs18:
    s_cmp_eq_u32 s3, 2
    s_cbranch_scc0 k1_qkv_kernel_cs19
    v_dot2_f32_bf16 v40, v164, s46, v40
    v_dot2_f32_bf16 v41, v165, s46, v41
    v_dot2_f32_bf16 v42, v166, s46, v42
    v_dot2_f32_bf16 v43, v167, s46, v43
    v_dot2_f32_bf16 v44, v168, s46, v44
    v_dot2_f32_bf16 v45, v169, s46, v45
    v_dot2_f32_bf16 v46, v170, s46, v46
    v_dot2_f32_bf16 v47, v171, s46, v47
    v_dot2_f32_bf16 v48, v172, s46, v48
    v_dot2_f32_bf16 v49, v173, s46, v49
    v_dot2_f32_bf16 v50, v174, s46, v50
    v_dot2_f32_bf16 v51, v175, s46, v51
    s_branch k1_qkv_kernel_csd16
k1_qkv_kernel_cs19:
    v_dot2_f32_bf16 v40, v180, s46, v40
    v_dot2_f32_bf16 v41, v181, s46, v41
    v_dot2_f32_bf16 v42, v182, s46, v42
    v_dot2_f32_bf16 v43, v183, s46, v43
    v_dot2_f32_bf16 v44, v184, s46, v44
    v_dot2_f32_bf16 v45, v185, s46, v45
    v_dot2_f32_bf16 v46, v186, s46, v46
    v_dot2_f32_bf16 v47, v187, s46, v47
    v_dot2_f32_bf16 v48, v188, s46, v48
    v_dot2_f32_bf16 v49, v189, s46, v49
    v_dot2_f32_bf16 v50, v190, s46, v50
    v_dot2_f32_bf16 v51, v191, s46, v51
k1_qkv_kernel_csd16:
    s_waitcnt vmcnt(7) lgkmcnt(0)
    s_barrier
    v_mfma_f32_32x32x16_bf16 v[192:207], v[68:71], v[64:67], v[192:207]
    ds_read_b128 v[128:131], v16 offset:0
    ds_read_b64_tr_b16 v[132:133], v56 offset:16384
    ds_read_b64_tr_b16 v[134:135], v56 offset:16640
    v_mfma_f32_32x32x16_bf16 v[208:223], v[72:75], v[64:67], v[208:223]
    ds_read_b64_tr_b16 v[136:137], v28 offset:20480
    ds_read_b64_tr_b16 v[138:139], v28 offset:20736
    ds_read_b64_tr_b16 v[140:141], v28 offset:24576
    v_mfma_f32_32x32x16_bf16 v[224:239], v[64:67], v[76:79], v[224:239]
    ds_read_b64_tr_b16 v[142:143], v28 offset:24832
    ds_read_b128 v[144:147], v17 offset:0
    ds_read_b64_tr_b16 v[148:149], v56 offset:17408
    v_mfma_f32_32x32x16_bf16 v[192:207], v[84:87], v[80:83], v[192:207]
    ds_read_b64_tr_b16 v[150:151], v56 offset:17664
    ds_read_b64_tr_b16 v[152:153], v28 offset:21504
    ds_read_b64_tr_b16 v[154:155], v28 offset:21760
    v_mfma_f32_32x32x16_bf16 v[208:223], v[88:91], v[80:83], v[208:223]
    ds_read_b64_tr_b16 v[156:157], v28 offset:25600
    ds_read_b64_tr_b16 v[158:159], v28 offset:25856
    ds_read_b128 v[160:163], v18 offset:0
    v_dot2_f32_bf16 v36, v64, v64, v36
    v_dot2_f32_bf16 v37, v65, v65, v37
    v_mfma_f32_32x32x16_bf16 v[224:239], v[80:83], v[92:95], v[224:239]
    ds_read_b64_tr_b16 v[164:165], v56 offset:18432
    ds_read_b64_tr_b16 v[166:167], v56 offset:18688
    ds_read_b64_tr_b16 v[168:169], v28 offset:22528
    v_dot2_f32_bf16 v38, v66, v66, v38
    v_dot2_f32_bf16 v39, v67, v67, v39
    v_mfma_f32_32x32x16_bf16 v[192:207], v[100:103], v[96:99], v[192:207]
    ds_read_b64_tr_b16 v[170:171], v28 offset:22784
    ds_read_b64_tr_b16 v[172:173], v28 offset:26624
    ds_read_b64_tr_b16 v[174:175], v28 offset:26880
    v_dot2_f32_bf16 v36, v80, v80, v36
    v_dot2_f32_bf16 v37, v81, v81, v37
    v_mfma_f32_32x32x16_bf16 v[208:223], v[104:107], v[96:99], v[208:223]
    ds_read_b128 v[176:179], v19 offset:0
    ds_read_b64_tr_b16 v[180:181], v56 offset:19456
    ds_read_b64_tr_b16 v[182:183], v56 offset:19712
    v_dot2_f32_bf16 v38, v82, v82, v38
    v_dot2_f32_bf16 v39, v83, v83, v39
    v_mfma_f32_32x32x16_bf16 v[224:239], v[96:99], v[108:111], v[224:239]
    ds_read_b64_tr_b16 v[184:185], v28 offset:23552
    ds_read_b64_tr_b16 v[186:187], v28 offset:23808
    ds_read_b64_tr_b16 v[188:189], v28 offset:27648
    v_dot2_f32_bf16 v36, v96, v96, v36
    v_dot2_f32_bf16 v37, v97, v97, v37
    v_mfma_f32_32x32x16_bf16 v[192:207], v[116:119], v[112:115], v[192:207]
    ds_read_b64_tr_b16 v[190:191], v28 offset:27904
    v_dot2_f32_bf16 v38, v98, v98, v38
    v_dot2_f32_bf16 v39, v99, v99, v39
    v_mfma_f32_32x32x16_bf16 v[208:223], v[120:123], v[112:115], v[208:223]
    v_dot2_f32_bf16 v36, v112, v112, v36
    v_dot2_f32_bf16 v37, v113, v113, v37
    v_mfma_f32_32x32x16_bf16 v[224:239], v[112:115], v[124:127], v[224:239]
    v_dot2_f32_bf16 v38, v114, v114, v38
    v_dot2_f32_bf16 v39, v115, v115, v39
    s_cmp_eq_u32 s3, 0
    s_cbranch_scc0 k1_qkv_kernel_cs22
    v_dot2_f32_bf16 v40, v68, s46, v40
    v_dot2_f32_bf16 v41, v69, s46, v41
    v_dot2_f32_bf16 v42, v70, s46, v42
    v_dot2_f32_bf16 v43, v71, s46, v43
    v_dot2_f32_bf16 v44, v72, s46, v44
    v_dot2_f32_bf16 v45, v73, s46, v45
    v_dot2_f32_bf16 v46, v74, s46, v46
    v_dot2_f32_bf16 v47, v75, s46, v47
    v_dot2_f32_bf16 v48, v76, s46, v48
    v_dot2_f32_bf16 v49, v77, s46, v49
    v_dot2_f32_bf16 v50, v78, s46, v50
    v_dot2_f32_bf16 v51, v79, s46, v51
    s_branch k1_qkv_kernel_csd21
k1_qkv_kernel_cs22:
    s_cmp_eq_u32 s3, 1
    s_cbranch_scc0 k1_qkv_kernel_cs23
    v_dot2_f32_bf16 v40, v84, s46, v40
    v_dot2_f32_bf16 v41, v85, s46, v41
    v_dot2_f32_bf16 v42, v86, s46, v42
    v_dot2_f32_bf16 v43, v87, s46, v43
    v_dot2_f32_bf16 v44, v88, s46, v44
    v_dot2_f32_bf16 v45, v89, s46, v45
    v_dot2_f32_bf16 v46, v90, s46, v46
    v_dot2_f32_bf16 v47, v91, s46, v47
    v_dot2_f32_bf16 v48, v92, s46, v48
    v_dot2_f32_bf16 v49, v93, s46, v49
    v_dot2_f32_bf16 v50, v94, s46, v50
    v_dot2_f32_bf16 v51, v95, s46, v51
    s_branch k1_qkv_kernel_csd21
k1_qkv_kernel_cs23:
    s_cmp_eq_u32 s3, 2
    s_cbranch_scc0 k1_qkv_kernel_cs24
    v_dot2_f32_bf16 v40, v100, s46, v40
    v_dot2_f32_bf16 v41, v101, s46, v41
    v_dot2_f32_bf16 v42, v102, s46, v42
    v_dot2_f32_bf16 v43, v103, s46, v43
    v_dot2_f32_bf16 v44, v104, s46, v44
    v_dot2_f32_bf16 v45, v105, s46, v45
    v_dot2_f32_bf16 v46, v106, s46, v46
    v_dot2_f32_bf16 v47, v107, s46, v47
    v_dot2_f32_bf16 v48, v108, s46, v48
    v_dot2_f32_bf16 v49, v109, s46, v49
    v_dot2_f32_bf16 v50, v110, s46, v50
    v_dot2_f32_bf16 v51, v111, s46, v51
    s_branch k1_qkv_kernel_csd21
k1_qkv_kernel_cs24:
    v_dot2_f32_bf16 v40, v116, s46, v40
    v_dot2_f32_bf16 v41, v117, s46, v41
    v_dot2_f32_bf16 v42, v118, s46, v42
    v_dot2_f32_bf16 v43, v119, s46, v43
    v_dot2_f32_bf16 v44, v120, s46, v44
    v_dot2_f32_bf16 v45, v121, s46, v45
    v_dot2_f32_bf16 v46, v122, s46, v46
    v_dot2_f32_bf16 v47, v123, s46, v47
    v_dot2_f32_bf16 v48, v124, s46, v48
    v_dot2_f32_bf16 v49, v125, s46, v49
    v_dot2_f32_bf16 v50, v126, s46, v50
    v_dot2_f32_bf16 v51, v127, s46, v51
k1_qkv_kernel_csd21:
    s_waitcnt vmcnt(0) lgkmcnt(0)
    s_barrier
    v_mfma_f32_32x32x16_bf16 v[192:207], v[132:135], v[128:131], v[192:207]
    ds_read_b128 v[64:67], v16 offset:32256
    ds_read_b64_tr_b16 v[68:69], v56 offset:48640
    ds_read_b64_tr_b16 v[70:71], v56 offset:48896
    v_mfma_f32_32x32x16_bf16 v[208:223], v[136:139], v[128:131], v[208:223]
    ds_read_b64_tr_b16 v[72:73], v28 offset:52736
    ds_read_b64_tr_b16 v[74:75], v28 offset:52992
    ds_read_b64_tr_b16 v[76:77], v28 offset:56832
    v_mfma_f32_32x32x16_bf16 v[224:239], v[128:131], v[140:143], v[224:239]
    ds_read_b64_tr_b16 v[78:79], v28 offset:57088
    ds_read_b128 v[80:83], v17 offset:32256
    ds_read_b64_tr_b16 v[84:85], v56 offset:49664
    v_mfma_f32_32x32x16_bf16 v[192:207], v[148:151], v[144:147], v[192:207]
    ds_read_b64_tr_b16 v[86:87], v56 offset:49920
    ds_read_b64_tr_b16 v[88:89], v28 offset:53760
    ds_read_b64_tr_b16 v[90:91], v28 offset:54016
    v_mfma_f32_32x32x16_bf16 v[208:223], v[152:155], v[144:147], v[208:223]
    ds_read_b64_tr_b16 v[92:93], v28 offset:57856
    ds_read_b64_tr_b16 v[94:95], v28 offset:58112
    ds_read_b128 v[96:99], v18 offset:32256
    v_dot2_f32_bf16 v36, v128, v128, v36
    v_dot2_f32_bf16 v37, v129, v129, v37
    v_mfma_f32_32x32x16_bf16 v[224:239], v[144:147], v[156:159], v[224:239]
    ds_read_b64_tr_b16 v[100:101], v56 offset:50688
    ds_read_b64_tr_b16 v[102:103], v56 offset:50944
    ds_read_b64_tr_b16 v[104:105], v28 offset:54784
    v_dot2_f32_bf16 v38, v130, v130, v38
    v_dot2_f32_bf16 v39, v131, v131, v39
    v_mfma_f32_32x32x16_bf16 v[192:207], v[164:167], v[160:163], v[192:207]
    ds_read_b64_tr_b16 v[106:107], v28 offset:55040
    ds_read_b64_tr_b16 v[108:109], v28 offset:58880
    ds_read_b64_tr_b16 v[110:111], v28 offset:59136
    v_dot2_f32_bf16 v36, v144, v144, v36
    v_dot2_f32_bf16 v37, v145, v145, v37
    v_mfma_f32_32x32x16_bf16 v[208:223], v[168:171], v[160:163], v[208:223]
    ds_read_b128 v[112:115], v19 offset:32256
    ds_read_b64_tr_b16 v[116:117], v56 offset:51712
    ds_read_b64_tr_b16 v[118:119], v56 offset:51968
    v_dot2_f32_bf16 v38, v146, v146, v38
    v_dot2_f32_bf16 v39, v147, v147, v39
    v_mfma_f32_32x32x16_bf16 v[224:239], v[160:163], v[172:175], v[224:239]
    ds_read_b64_tr_b16 v[120:121], v28 offset:55808
    ds_read_b64_tr_b16 v[122:123], v28 offset:56064
    ds_read_b64_tr_b16 v[124:125], v28 offset:59904
    v_dot2_f32_bf16 v36, v160, v160, v36
    v_dot2_f32_bf16 v37, v161, v161, v37
    v_mfma_f32_32x32x16_bf16 v[192:207], v[180:183], v[176:179], v[192:207]
    ds_read_b64_tr_b16 v[126:127], v28 offset:60160
    v_dot2_f32_bf16 v38, v162, v162, v38
    v_dot2_f32_bf16 v39, v163, v163, v39
    v_mfma_f32_32x32x16_bf16 v[208:223], v[184:187], v[176:179], v[208:223]
    v_dot2_f32_bf16 v36, v176, v176, v36
    v_dot2_f32_bf16 v37, v177, v177, v37
    v_mfma_f32_32x32x16_bf16 v[224:239], v[176:179], v[188:191], v[224:239]
    v_dot2_f32_bf16 v38, v178, v178, v38
    v_dot2_f32_bf16 v39, v179, v179, v39
    s_cmp_eq_u32 s3, 0
    s_cbranch_scc0 k1_qkv_kernel_cs27
    v_dot2_f32_bf16 v40, v132, s46, v40
    v_dot2_f32_bf16 v41, v133, s46, v41
    v_dot2_f32_bf16 v42, v134, s46, v42
    v_dot2_f32_bf16 v43, v135, s46, v43
    v_dot2_f32_bf16 v44, v136, s46, v44
    v_dot2_f32_bf16 v45, v137, s46, v45
    v_dot2_f32_bf16 v46, v138, s46, v46
    v_dot2_f32_bf16 v47, v139, s46, v47
    v_dot2_f32_bf16 v48, v140, s46, v48
    v_dot2_f32_bf16 v49, v141, s46, v49
    v_dot2_f32_bf16 v50, v142, s46, v50
    v_dot2_f32_bf16 v51, v143, s46, v51
    s_branch k1_qkv_kernel_csd26
k1_qkv_kernel_cs27:
    s_cmp_eq_u32 s3, 1
    s_cbranch_scc0 k1_qkv_kernel_cs28
    v_dot2_f32_bf16 v40, v148, s46, v40
    v_dot2_f32_bf16 v41, v149, s46, v41
    v_dot2_f32_bf16 v42, v150, s46, v42
    v_dot2_f32_bf16 v43, v151, s46, v43
    v_dot2_f32_bf16 v44, v152, s46, v44
    v_dot2_f32_bf16 v45, v153, s46, v45
    v_dot2_f32_bf16 v46, v154, s46, v46
    v_dot2_f32_bf16 v47, v155, s46, v47
    v_dot2_f32_bf16 v48, v156, s46, v48
    v_dot2_f32_bf16 v49, v157, s46, v49
    v_dot2_f32_bf16 v50, v158, s46, v50
    v_dot2_f32_bf16 v51, v159, s46, v51
    s_branch k1_qkv_kernel_csd26
k1_qkv_kernel_cs28:
    s_cmp_eq_u32 s3, 2
    s_cbranch_scc0 k1_qkv_kernel_cs29
    v_dot2_f32_bf16 v40, v164, s46, v40
    v_dot2_f32_bf16 v41, v165, s46, v41
    v_dot2_f32_bf16 v42, v166, s46, v42
    v_dot2_f32_bf16 v43, v167, s46, v43
    v_dot2_f32_bf16 v44, v168, s46, v44
    v_dot2_f32_bf16 v45, v169, s46, v45
    v_dot2_f32_bf16 v46, v170, s46, v46
    v_dot2_f32_bf16 v47, v171, s46, v47
    v_dot2_f32_bf16 v48, v172, s46, v48
    v_dot2_f32_bf16 v49, v173, s46, v49
    v_dot2_f32_bf16 v50, v174, s46, v50
    v_dot2_f32_bf16 v51, v175, s46, v51
    s_branch k1_qkv_kernel_csd26
k1_qkv_kernel_cs29:
    v_dot2_f32_bf16 v40, v180, s46, v40
    v_dot2_f32_bf16 v41, v181, s46, v41
    v_dot2_f32_bf16 v42, v182, s46, v42
    v_dot2_f32_bf16 v43, v183, s46, v43
    v_dot2_f32_bf16 v44, v184, s46, v44
    v_dot2_f32_bf16 v45, v185, s46, v45
    v_dot2_f32_bf16 v46, v186, s46, v46
    v_dot2_f32_bf16 v47, v187, s46, v47
    v_dot2_f32_bf16 v48, v188, s46, v48
    v_dot2_f32_bf16 v49, v189, s46, v49
    v_dot2_f32_bf16 v50, v190, s46, v50
    v_dot2_f32_bf16 v51, v191, s46, v51
k1_qkv_kernel_csd26:
    s_waitcnt lgkmcnt(0)
    v_mfma_f32_32x32x16_bf16 v[192:207], v[68:71], v[64:67], v[192:207]
    v_mfma_f32_32x32x16_bf16 v[192:207], v[84:87], v[80:83], v[192:207]
    v_mfma_f32_32x32x16_bf16 v[192:207], v[100:103], v[96:99], v[192:207]
    v_mfma_f32_32x32x16_bf16 v[192:207], v[116:119], v[112:115], v[192:207]
    v_dot2_f32_bf16 v36, v64, v64, v36
    v_dot2_f32_bf16 v37, v65, v65, v37
    v_dot2_f32_bf16 v38, v66, v66, v38
    v_dot2_f32_bf16 v39, v67, v67, v39
    v_dot2_f32_bf16 v36, v80, v80, v36
    v_dot2_f32_bf16 v37, v81, v81, v37
    v_dot2_f32_bf16 v38, v82, v82, v38
    v_dot2_f32_bf16 v39, v83, v83, v39
    v_dot2_f32_bf16 v36, v96, v96, v36
    v_dot2_f32_bf16 v37, v97, v97, v37
    v_dot2_f32_bf16 v38, v98, v98, v38
    v_dot2_f32_bf16 v39, v99, v99, v39
    v_dot2_f32_bf16 v36, v112, v112, v36
    v_dot2_f32_bf16 v37, v113, v113, v37
    v_dot2_f32_bf16 v38, v114, v114, v38
    v_dot2_f32_bf16 v39, v115, v115, v39
    s_cmp_eq_u32 s3, 0
    s_cbranch_scc0 k1_qkv_kernel_cs32
    v_dot2_f32_bf16 v40, v68, s46, v40
    v_dot2_f32_bf16 v41, v69, s46, v41
    v_dot2_f32_bf16 v42, v70, s46, v42
    v_dot2_f32_bf16 v43, v71, s46, v43
    v_dot2_f32_bf16 v44, v72, s46, v44
    v_dot2_f32_bf16 v45, v73, s46, v45
    v_dot2_f32_bf16 v46, v74, s46, v46
    v_dot2_f32_bf16 v47, v75, s46, v47
    v_dot2_f32_bf16 v48, v76, s46, v48
    v_dot2_f32_bf16 v49, v77, s46, v49
    v_dot2_f32_bf16 v50, v78, s46, v50
    v_dot2_f32_bf16 v51, v79, s46, v51
    s_branch k1_qkv_kernel_csd31
k1_qkv_kernel_cs32:
    s_cmp_eq_u32 s3, 1
    s_cbranch_scc0 k1_qkv_kernel_cs33
    v_dot2_f32_bf16 v40, v84, s46, v40
    v_dot2_f32_bf16 v41, v85, s46, v41
    v_dot2_f32_bf16 v42, v86, s46, v42
    v_dot2_f32_bf16 v43, v87, s46, v43
    v_dot2_f32_bf16 v44, v88, s46, v44
    v_dot2_f32_bf16 v45, v89, s46, v45
    v_dot2_f32_bf16 v46, v90, s46, v46
    v_dot2_f32_bf16 v47, v91, s46, v47
    v_dot2_f32_bf16 v48, v92, s46, v48
    v_dot2_f32_bf16 v49, v93, s46, v49
    v_dot2_f32_bf16 v50, v94, s46, v50
    v_dot2_f32_bf16 v51, v95, s46, v51
    s_branch k1_qkv_kernel_csd31
k1_qkv_kernel_cs33:
    s_cmp_eq_u32 s3, 2
    s_cbranch_scc0 k1_qkv_kernel_cs34
    v_dot2_f32_bf16 v40, v100, s46, v40
    v_dot2_f32_bf16 v41, v101, s46, v41
    v_dot2_f32_bf16 v42, v102, s46, v42
    v_dot2_f32_bf16 v43, v103, s46, v43
    v_dot2_f32_bf16 v44, v104, s46, v44
    v_dot2_f32_bf16 v45, v105, s46, v45
    v_dot2_f32_bf16 v46, v106, s46, v46
    v_dot2_f32_bf16 v47, v107, s46, v47
    v_dot2_f32_bf16 v48, v108, s46, v48
    v_dot2_f32_bf16 v49, v109, s46, v49
    v_dot2_f32_bf16 v50, v110, s46, v50
    v_dot2_f32_bf16 v51, v111, s46, v51
    s_branch k1_qkv_kernel_csd31
k1_qkv_kernel_cs34:
    v_dot2_f32_bf16 v40, v116, s46, v40
    v_dot2_f32_bf16 v41, v117, s46, v41
    v_dot2_f32_bf16 v42, v118, s46, v42
    v_dot2_f32_bf16 v43, v119, s46, v43
    v_dot2_f32_bf16 v44, v120, s46, v44
    v_dot2_f32_bf16 v45, v121, s46, v45
    v_dot2_f32_bf16 v46, v122, s46, v46
    v_dot2_f32_bf16 v47, v123, s46, v47
    v_dot2_f32_bf16 v48, v124, s46, v48
    v_dot2_f32_bf16 v49, v125, s46, v49
    v_dot2_f32_bf16 v50, v126, s46, v50
    v_dot2_f32_bf16 v51, v127, s46, v51
k1_qkv_kernel_csd31:
    v_mfma_f32_32x32x16_bf16 v[208:223], v[72:75], v[64:67], v[208:223]
    v_cmp_le_u32 vcc, 32, v1
    v_add_f32 v36, v36, v37
    v_add_f32 v38, v38, v39
    v_cndmask_b32 v32, 0, v204, vcc
    v_add_f32 v36, v36, v38
    s_nop 1
    v_add_f32 v40, v40, v41
    v_mfma_f32_32x32x16_bf16 v[224:239], v[64:67], v[76:79], v[224:239]
    v_add_f32 v42, v42, v43
    v_add_f32 v40, v40, v42
    v_add_f32 v44, v44, v45
    v_add_f32 v46, v46, v47
    v_add_f32 v44, v44, v46
    v_add_f32 v48, v48, v49
    v_add_f32 v50, v50, v51
    v_mfma_f32_32x32x16_bf16 v[208:223], v[88:91], v[80:83], v[208:223]
    v_add_f32 v48, v48, v50
    v_mov_b32 v33, v32
    v_mov_b32 v37, v36
    s_lshl_b32 s40, s3, 3
    s_add_u32 s40, s40, 0
    v_lshlrev_b32 v13, 5, v12
    v_lshl_add_u32 v13, v8, 2, v13
    v_mfma_f32_32x32x16_bf16 v[224:239], v[80:83], v[92:95], v[224:239]
    v_add_u32 v13, s40, v13
    ds_write_b32 v13, v40 offset:0
    ds_write_b32 v13, v44 offset:1024
    ds_write_b32 v13, v48 offset:2048
    v_permlane32_swap_b32 v32, v33
    v_permlane32_swap_b32 v36, v37
    s_nop 1
    v_mfma_f32_32x32x16_bf16 v[208:223], v[104:107], v[96:99], v[208:223]
    v_add_f32 v32, v32, v33
    v_add_f32 v36, v36, v37
    s_mov_b32 s40, 0x3b124925
    v_mul_f32 v32, s40, v32
    v_mul_f32 v36, s40, v36
    v_fma_f32 v36, -v32, v32, v36
    v_max_f32 v36, 0, v36
    v_mfma_f32_32x32x16_bf16 v[224:239], v[96:99], v[108:111], v[224:239]
    v_add_f32 v36, 0x3727c5ac, v36
    v_rsq_f32 v33, v36
    s_nop 0
    v_mov_b32 v34, v32
    v_mov_b32 v35, v33
    s_lshl_b32 s40, s3, 8
    s_add_u32 s40, s40, 4096
    v_mfma_f32_32x32x16_bf16 v[208:223], v[120:123], v[112:115], v[208:223]
    v_lshl_add_u32 v14, v12, 3, s40
    ds_write_b64 v14, v[34:35]
    s_waitcnt lgkmcnt(0)
    s_barrier
    v_lshlrev_b32 v13, 5, v1
    v_add_u32 v13, 0, v13
    ds_read_b128 v[40:43], v13
    v_mfma_f32_32x32x16_bf16 v[224:239], v[112:115], v[124:127], v[224:239]
    ds_read_b128 v[44:47], v13 offset:16
    v_lshlrev_b32 v13, 5, v12
    v_add_u32 v13, 2048, v13
    ds_read_b128 v[48:51], v13
    ds_read_b128 v[52:55], v13 offset:16
    v_lshlrev_b32 v14, 5, v8
    v_add_u32 v14, s40, v14
    ds_read_b128 v[128:131], v14 offset:0
    ds_read_b128 v[132:135], v14 offset:16
    ds_read_b128 v[136:139], v14 offset:64
    ds_read_b128 v[140:143], v14 offset:80
    ds_read_b128 v[144:147], v14 offset:128
    ds_read_b128 v[148:151], v14 offset:144
    ds_read_b128 v[152:155], v14 offset:192
    ds_read_b128 v[156:159], v14 offset:208
    s_waitcnt lgkmcnt(8)
    v_add_f32 v40, v40, v41
    v_add_f32 v42, v42, v43
    v_add_f32 v44, v44, v45
    v_add_f32 v46, v46, v47
    v_add_f32 v40, v40, v42
    v_add_f32 v44, v44, v46
    v_add_f32 v40, v40, v44
    v_add_f32 v48, v48, v49
    v_add_f32 v50, v50, v51
    v_add_f32 v52, v52, v53
    v_add_f32 v54, v54, v55
    v_add_f32 v48, v48, v50
    v_add_f32 v52, v52, v54
    v_add_f32 v48, v48, v52
    s_lshl_b32 s41, s3, 8
    s_add_u32 s41, s41, 3072
    v_lshlrev_b32 v13, 2, v1
    v_add_u32 v13, s41, v13
    ds_write_b32 v13, v40
    v_lshlrev_b32 v13, 4, v8
    v_add_u32 v13, s41, v13
    s_waitcnt lgkmcnt(0)
    ds_read_b128 v[160:163], v13 offset:0
    ds_read_b128 v[164:167], v13 offset:32
    ds_read_b128 v[168:171], v13 offset:64
    ds_read_b128 v[172:175], v13 offset:96
    ds_read_b128 v[176:179], v13 offset:128
    ds_read_b128 v[180:183], v13 offset:160
    ds_read_b128 v[184:187], v13 offset:192
    ds_read_b128 v[188:191], v13 offset:224
    s_lshl_b32 s34, s30, 7
    s_lshl_b32 s35, s3, 5
    s_add_u32 s34, s34, s35
    s_lshl_b32 s36, s34, 6
    v_lshlrev_b32 v23, 4, v1
    v_add_u32 v23, s36, v23
    v_mul_f32 v34, 0x3e8b97f6, v33
    s_nop 15
    s_waitcnt lgkmcnt(0)
    v_fma_f32 v192, -v32, v160, v192
    v_mul_f32 v192, v34, v192
    v_fma_f32 v193, -v32, v161, v193
    v_mul_f32 v193, v34, v193
    v_fma_f32 v194, -v32, v162, v194
    v_mul_f32 v194, v34, v194
    v_fma_f32 v195, -v32, v163, v195
    v_mul_f32 v195, v34, v195
    v_fma_f32 v196, -v32, v164, v196
    v_mul_f32 v196, v34, v196
    v_fma_f32 v197, -v32, v165, v197
    v_mul_f32 v197, v34, v197
    v_fma_f32 v198, -v32, v166, v198
    v_mul_f32 v198, v34, v198
    v_fma_f32 v199, -v32, v167, v199
    v_mul_f32 v199, v34, v199
    v_fma_f32 v200, -v32, v168, v200
    v_mul_f32 v200, v34, v200
    v_fma_f32 v201, -v32, v169, v201
    v_mul_f32 v201, v34, v201
    v_fma_f32 v202, -v32, v170, v202
    v_mul_f32 v202, v34, v202
    v_fma_f32 v203, -v32, v171, v203
    v_mul_f32 v203, v34, v203
    v_fma_f32 v204, -v32, v172, v204
    v_mul_f32 v204, v34, v204
    v_fma_f32 v205, -v32, v173, v205
    v_mul_f32 v205, v34, v205
    v_fma_f32 v206, -v32, v174, v206
    v_mul_f32 v206, v34, v206
    v_fma_f32 v207, -v32, v175, v207
    v_mul_f32 v207, v34, v207
    v_cmp_gt_u32 vcc, 32, v1
    s_nop 1
    v_cndmask_b32 v204, 0, v204, vcc
    v_cndmask_b32 v205, 0, v205, vcc
    v_cndmask_b32 v206, 0, v206, vcc
    v_cndmask_b32 v207, 0, v207, vcc
    v_cvt_pk_bf16_f32 v96, v192, v193
    v_cvt_pk_bf16_f32 v97, v194, v195
    v_cvt_pk_bf16_f32 v98, v196, v197
    v_cvt_pk_bf16_f32 v99, v198, v199
    v_cvt_pk_bf16_f32 v100, v200, v201
    v_cvt_pk_bf16_f32 v101, v202, v203
    v_cvt_pk_bf16_f32 v102, v204, v205
    v_cvt_pk_bf16_f32 v103, v206, v207
    s_mov_b32 s37, 0x0
    buffer_store_dwordx4 v[96:99], v23, s[16:19], s37 offen offset:0 sc1
    buffer_store_dwordx4 v[100:103], v23, s[16:19], s37 offen offset:1024 sc1
    v_fma_f32 v208, -v32, v176, v208
    v_mul_f32 v208, v33, v208
    v_fma_f32 v209, -v32, v177, v209
    v_mul_f32 v209, v33, v209
    v_fma_f32 v210, -v32, v178, v210
    v_mul_f32 v210, v33, v210
    v_fma_f32 v211, -v32, v179, v211
    v_mul_f32 v211, v33, v211
    v_fma_f32 v212, -v32, v180, v212
    v_mul_f32 v212, v33, v212
    v_fma_f32 v213, -v32, v181, v213
    v_mul_f32 v213, v33, v213
    v_fma_f32 v214, -v32, v182, v214
    v_mul_f32 v214, v33, v214
    v_fma_f32 v215, -v32, v183, v215
    v_mul_f32 v215, v33, v215
    v_fma_f32 v216, -v32, v184, v216
    v_mul_f32 v216, v33, v216
    v_fma_f32 v217, -v32, v185, v217
    v_mul_f32 v217, v33, v217
    v_fma_f32 v218, -v32, v186, v218
    v_mul_f32 v218, v33, v218
    v_fma_f32 v219, -v32, v187, v219
    v_mul_f32 v219, v33, v219
    v_fma_f32 v220, -v32, v188, v220
    v_mul_f32 v220, v33, v220
    v_fma_f32 v221, -v32, v189, v221
    v_mul_f32 v221, v33, v221
    v_fma_f32 v222, -v32, v190, v222
    v_mul_f32 v222, v33, v222
    v_fma_f32 v223, -v32, v191, v223
    v_mul_f32 v223, v33, v223
    v_cmp_gt_u32 vcc, 32, v1
    s_nop 1
    v_cndmask_b32 v220, 1.0, v220, vcc
    v_cndmask_b32 v221, 0, v221, vcc
    v_cndmask_b32 v222, 0, v222, vcc
    v_cndmask_b32 v223, 0, v223, vcc
    v_cvt_pk_bf16_f32 v104, v208, v209
    v_cvt_pk_bf16_f32 v105, v210, v211
    v_cvt_pk_bf16_f32 v106, v212, v213
    v_cvt_pk_bf16_f32 v107, v214, v215
    v_cvt_pk_bf16_f32 v108, v216, v217
    v_cvt_pk_bf16_f32 v109, v218, v219
    v_cvt_pk_bf16_f32 v110, v220, v221
    v_cvt_pk_bf16_f32 v111, v222, v223
    s_mov_b32 s37, 0x200000
    buffer_store_dwordx4 v[104:107], v23, s[16:19], s37 offen offset:0 sc1
    buffer_store_dwordx4 v[108:111], v23, s[16:19], s37 offen offset:1024 sc1
    v_fma_f32 v224, -v128, v48, v224
    v_mul_f32 v224, v129, v224
    v_fma_f32 v225, -v130, v48, v225
    v_mul_f32 v225, v131, v225
    v_fma_f32 v226, -v132, v48, v226
    v_mul_f32 v226, v133, v226
    v_fma_f32 v227, -v134, v48, v227
    v_mul_f32 v227, v135, v227
    v_fma_f32 v228, -v136, v48, v228
    v_mul_f32 v228, v137, v228
    v_fma_f32 v229, -v138, v48, v229
    v_mul_f32 v229, v139, v229
    v_fma_f32 v230, -v140, v48, v230
    v_mul_f32 v230, v141, v230
    v_fma_f32 v231, -v142, v48, v231
    v_mul_f32 v231, v143, v231
    v_fma_f32 v232, -v144, v48, v232
    v_mul_f32 v232, v145, v232
    v_fma_f32 v233, -v146, v48, v233
    v_mul_f32 v233, v147, v233
    v_fma_f32 v234, -v148, v48, v234
    v_mul_f32 v234, v149, v234
    v_fma_f32 v235, -v150, v48, v235
    v_mul_f32 v235, v151, v235
    v_fma_f32 v236, -v152, v48, v236
    v_mul_f32 v236, v153, v236
    v_fma_f32 v237, -v154, v48, v237
    v_mul_f32 v237, v155, v237
    v_fma_f32 v238, -v156, v48, v238
    v_mul_f32 v238, v157, v238
    v_fma_f32 v239, -v158, v48, v239
    v_mul_f32 v239, v159, v239
    v_cmp_gt_u32 vcc, 28, v12
    v_cmp_eq_u32 s[38:39], 28, v12
    v_cndmask_b32 v27, 0, 1.0, s[38:39]
    s_nop 1
    v_cndmask_b32 v224, v27, v224, vcc
    v_cndmask_b32 v225, v27, v225, vcc
    v_cndmask_b32 v226, v27, v226, vcc
    v_cndmask_b32 v227, v27, v227, vcc
    v_cndmask_b32 v228, v27, v228, vcc
    v_cndmask_b32 v229, v27, v229, vcc
    v_cndmask_b32 v230, v27, v230, vcc
    v_cndmask_b32 v231, v27, v231, vcc
    v_cndmask_b32 v232, v27, v232, vcc
    v_cndmask_b32 v233, v27, v233, vcc
    v_cndmask_b32 v234, v27, v234, vcc
    v_cndmask_b32 v235, v27, v235, vcc
    v_cndmask_b32 v236, v27, v236, vcc
    v_cndmask_b32 v237, v27, v237, vcc
    v_cndmask_b32 v238, v27, v238, vcc
    v_cndmask_b32 v239, v27, v239, vcc
    v_cvt_pk_bf16_f32 v112, v224, v225
    v_cvt_pk_bf16_f32 v113, v226, v227
    v_cvt_pk_bf16_f32 v114, v228, v229
    v_cvt_pk_bf16_f32 v115, v230, v231
    v_cvt_pk_bf16_f32 v116, v232, v233
    v_cvt_pk_bf16_f32 v117, v234, v235
    v_cvt_pk_bf16_f32 v118, v236, v237
    v_cvt_pk_bf16_f32 v119, v238, v239
    s_mov_b32 s37, 0x400000
    buffer_store_dwordx4 v[112:115], v23, s[16:19], s37 offen offset:0 sc1
    buffer_store_dwordx4 v[116:119], v23, s[16:19], s37 offen offset:1024 sc1
k1_qkv_kernel_end:
    s_endpgm
.globl k2_attn_kernel
.p2align 8
.type k2_attn_kernel,@function
k2_attn_kernel:
    s_cmp_ge_u32 s2, 256
    s_cbranch_scc1 k2_attn_kernel_end
    s_load_dwordx2 s[28:29], s[0:1], 72
    v_and_b32 v1, 63, v0
    v_lshrrev_b32 v2, 6, v0
    s_load_dwordx2 s[48:49], s[0:1], 16
    s_load_dwordx2 s[50:51], s[0:1], 32
    s_load_dwordx2 s[52:53], s[0:1], 40
    s_load_dwordx2 s[54:55], s[0:1], 48
    s_and_b32 s31, s2, 7
    s_lshl_b32 s31, s31, 1
    s_lshr_b32 s30, s2, 7
    s_add_u32 s31, s31, s30
    s_bfe_u32 s30, s2, 0x40003
    v_readfirstlane_b32 s3, v2
    s_lshl_b32 s32, s31, 17
    s_and_b32 s33, s3, 3
    s_lshr_b32 s44, s3, 2
    s_waitcnt lgkmcnt(0)
    s_add_u32 s8, s28, s32
    s_addc_u32 s9, s29, 0
    s_mov_b32 s10, 0x420000
    s_mov_b32 s11, 0x00020000
    s_add_u32 s16, s28, 0x600000
    s_addc_u32 s17, s29, 0
    s_mov_b32 s18, 0x200000
    s_mov_b32 s19, 0x00020000
    s_lshl_b32 s34, s30, 2
    s_add_u32 s34, s34, s33
    s_lshl_b32 s34, s34, 5
    v_and_b32 v25, 31, v1
    v_lshrrev_b32 v26, 5, v1
    s_lshl_b32 s45, s34, 6
    v_lshlrev_b32 v4, 4, v1
    v_add_u32 v3, s45, v4
    buffer_load_dwordx4 v[8:11], v3, s[8:11], 0 offen
    buffer_load_dwordx4 v[12:15], v3, s[8:11], 0 offen offset:1024
    s_lshl_b32 s45, s44, 13
    v_add_u32 v18, s45, v4
    v_add_u32 v42, 0x10000, v18
    s_lshl_b32 s43, s3, 11
    s_mov_b32 s46, 0
    s_mov_b32 s47, -1
    s_add_u32 m0, s43, 0
    s_add_u32 s35, s43, 0x200000
    buffer_load_dwordx4 v4, s[8:11], s35 offen lds
    buffer_load_dwordx4 v4, s[8:11], s35 offen offset:1024 lds
    s_barrier
    s_add_u32 m0, s43, 16384
    s_add_u32 s35, s43, 0x400000
    buffer_load_dwordx4 v4, s[8:11], s35 offen lds
    buffer_load_dwordx4 v4, s[8:11], s35 offen offset:1024 lds
    s_add_u32 m0, s43, 32768
    s_add_u32 s35, s43, 0x204000
    buffer_load_dwordx4 v4, s[8:11], s35 offen lds
    buffer_load_dwordx4 v4, s[8:11], s35 offen offset:1024 lds
    s_add_u32 m0, s43, 49152
    s_add_u32 s35, s43, 0x404000
    buffer_load_dwordx4 v4, s[8:11], s35 offen lds
    buffer_load_dwordx4 v4, s[8:11], s35 offen offset:1024 lds
    s_waitcnt vmcnt(6)
    s_barrier
    ds_read_b128 v[128:131], v18 offset:0
    ds_read_b128 v[132:135], v18 offset:1024
    ds_read_b128 v[136:139], v18 offset:2048
    ds_read_b128 v[140:143], v18 offset:3072
    ds_read_b128 v[144:147], v18 offset:4096
    ds_read_b128 v[148:151], v18 offset:5120
    ds_read_b128 v[152:155], v18 offset:6144
    ds_read_b128 v[156:159], v18 offset:7168
    s_waitcnt lgkmcnt(6)
    v_mfma_f32_32x32x16_bf16 v[64:79], v[128:131], v[8:11], 0
    v_mfma_f32_32x32x16_bf16 v[64:79], v[132:135], v[12:15], v[64:79]
    s_waitcnt lgkmcnt(4)
    v_mfma_f32_32x32x16_bf16 v[80:95], v[136:139], v[8:11], 0
    v_mfma_f32_32x32x16_bf16 v[80:95], v[140:143], v[12:15], v[80:95]
    s_waitcnt lgkmcnt(2)
    v_mfma_f32_32x32x16_bf16 v[96:111], v[144:147], v[8:11], 0
    v_mfma_f32_32x32x16_bf16 v[96:111], v[148:151], v[12:15], v[96:111]
    s_waitcnt lgkmcnt(0)
    v_mfma_f32_32x32x16_bf16 v[112:127], v[152:155], v[8:11], 0
    v_mfma_f32_32x32x16_bf16 v[112:127], v[156:159], v[12:15], v[112:127]
    ds_read_b128 v[112:115], v18 offset:0
    ds_read_b128 v[116:119], v18 offset:1024
    ds_read_b128 v[120:123], v18 offset:2048
    ds_read_b128 v[124:127], v18 offset:3072
    s_add_u32 m0, s43, 65536
    s_add_u32 s35, s43, 0x208000
    buffer_load_dwordx4 v4, s[8:11], s35 offen lds
    buffer_load_dwordx4 v4, s[8:11], s35 offen offset:1024 lds
    s_add_u32 m0, s43, 81920
    s_add_u32 s35, s43, 0x408000
    buffer_load_dwordx4 v4, s[8:11], s35 offen lds
    buffer_load_dwordx4 v4, s[8:11], s35 offen offset:1024 lds
    s_nop 11
    v_max3_f32 v21, v64, v65, v66
    v_max3_f32 v21, v21, v67, v68
    v_max3_f32 v21, v21, v69, v70
    v_max3_f32 v21, v21, v71, v72
    v_max3_f32 v21, v21, v73, v74
    v_max3_f32 v21, v21, v75, v76
    v_max3_f32 v21, v21, v77, v78
    v_max3_f32 v21, v21, v79, v80
    v_max3_f32 v21, v21, v81, v82
    v_max3_f32 v21, v21, v83, v84
    v_max3_f32 v21, v21, v85, v86
    v_max3_f32 v21, v21, v87, v88
    v_max3_f32 v21, v21, v89, v90
    v_max3_f32 v21, v21, v91, v92
    v_max3_f32 v21, v21, v93, v94
    v_max3_f32 v21, v21, v95, v96
    v_max3_f32 v21, v21, v97, v98
    v_max3_f32 v21, v21, v99, v100
    v_max3_f32 v21, v21, v101, v102
    v_max3_f32 v21, v21, v103, v104
    v_max3_f32 v21, v21, v105, v106
    v_max3_f32 v21, v21, v107, v108
    v_max3_f32 v21, v21, v109, v110
    v_max3_f32 v21, v21, v111, v112
    v_max3_f32 v21, v21, v113, v114
    v_max3_f32 v21, v21, v115, v116
    v_max3_f32 v21, v21, v117, v118
    v_max3_f32 v21, v21, v119, v120
    v_max3_f32 v21, v21, v121, v122
    v_max3_f32 v21, v21, v123, v124
    v_max3_f32 v21, v21, v125, v126
    v_max_f32 v21, v21, v127
    v_mov_b32 v22, v21
    s_nop 1
    v_permlane32_swap_b32 v21, v22
    s_nop 1
    v_max_f32 v21, v21, v22
    v_cvt_pk_bf16_f32 v23, v21, v21
    v_lshlrev_b32 v20, 16, v23
    v_xor_b32 v23, 0x8000, v23
    v_and_b32 v23, 0xffff, v23
    v_cndmask_b32 v14, v14, v23, s[46:47]
    s_waitcnt lgkmcnt(0)
    s_nop 1
    v_mfma_f32_32x32x16_bf16 v[64:79], v[112:115], v[8:11], 0
    v_mfma_f32_32x32x16_bf16 v[64:79], v[116:119], v[12:15], v[64:79]
    s_nop 15
    s_waitcnt vmcnt(8)
    s_barrier
    ds_read_b128 v[112:115], v18 offset:4096
    ds_read_b128 v[116:119], v18 offset:5120
    ds_read_b128 v[128:131], v18 offset:16384
    ds_read_b128 v[132:135], v18 offset:17408
    s_waitcnt lgkmcnt(4)
    v_mfma_f32_32x32x16_bf16 v[80:95], v[120:123], v[8:11], 0
    v_exp_f32 v64, v64
    v_exp_f32 v65, v65
    v_exp_f32 v66, v66
    v_exp_f32 v67, v67
    v_mfma_f32_32x32x16_bf16 v[80:95], v[124:127], v[12:15], v[80:95]
    v_exp_f32 v68, v68
    v_exp_f32 v69, v69
    v_exp_f32 v70, v70
    v_exp_f32 v71, v71
    v_cvt_pk_bf16_f32 v96, v64, v65
    v_cvt_pk_bf16_f32 v97, v66, v67
    v_exp_f32 v72, v72
    v_exp_f32 v73, v73
    v_exp_f32 v74, v74
    v_exp_f32 v75, v75
    v_cvt_pk_bf16_f32 v98, v68, v69
    v_cvt_pk_bf16_f32 v99, v70, v71
    v_exp_f32 v76, v76
    v_exp_f32 v77, v77
    v_exp_f32 v78, v78
    v_exp_f32 v79, v79
    v_cvt_pk_bf16_f32 v100, v72, v73
    v_cvt_pk_bf16_f32 v101, v74, v75
    v_cvt_pk_bf16_f32 v102, v76, v77
    v_cvt_pk_bf16_f32 v103, v78, v79
    s_waitcnt vmcnt(4)
    s_barrier
    ds_read_b128 v[120:123], v18 offset:6144
    ds_read_b128 v[124:127], v18 offset:7168
    ds_read_b128 v[136:139], v18 offset:18432
    ds_read_b128 v[140:143], v18 offset:19456
    s_waitcnt lgkmcnt(4)
    v_mfma_f32_32x32x16_bf16 v[64:79], v[112:115], v[8:11], 0
    v_exp_f32 v80, v80
    v_exp_f32 v81, v81
    v_exp_f32 v82, v82
    v_exp_f32 v83, v83
    v_mfma_f32_32x32x16_bf16 v[64:79], v[116:119], v[12:15], v[64:79]
    v_exp_f32 v84, v84
    v_exp_f32 v85, v85
    v_exp_f32 v86, v86
    v_exp_f32 v87, v87
    v_cvt_pk_bf16_f32 v104, v80, v81
    v_cvt_pk_bf16_f32 v105, v82, v83
    v_mfma_f32_32x32x16_bf16 v[144:159], v[128:131], v[96:99], 0
    v_exp_f32 v88, v88
    v_exp_f32 v89, v89
    v_exp_f32 v90, v90
    v_exp_f32 v91, v91
    v_cvt_pk_bf16_f32 v106, v84, v85
    v_cvt_pk_bf16_f32 v107, v86, v87
    v_mfma_f32_32x32x16_bf16 v[144:159], v[132:135], v[100:103], v[144:159]
    v_exp_f32 v92, v92
    v_exp_f32 v93, v93
    v_exp_f32 v94, v94
    v_exp_f32 v95, v95
    v_cvt_pk_bf16_f32 v108, v88, v89
    v_cvt_pk_bf16_f32 v109, v90, v91
    v_cvt_pk_bf16_f32 v110, v92, v93
    v_cvt_pk_bf16_f32 v111, v94, v95
    s_add_u32 m0, s43, 98304
    s_add_u32 s35, s43, 0x20c000
    buffer_load_dwordx4 v4, s[8:11], s35 offen lds
    buffer_load_dwordx4 v4, s[8:11], s35 offen offset:1024 lds
    ds_read_b128 v[112:115], v18 offset:32768
    ds_read_b128 v[116:119], v18 offset:33792
    ds_read_b128 v[128:131], v18 offset:20480
    ds_read_b128 v[132:135], v18 offset:21504
    s_waitcnt lgkmcnt(4)
    v_mfma_f32_32x32x16_bf16 v[80:95], v[120:123], v[8:11], 0
    v_exp_f32 v64, v64
    v_exp_f32 v65, v65
    v_exp_f32 v66, v66
    v_exp_f32 v67, v67
    v_mfma_f32_32x32x16_bf16 v[80:95], v[124:127], v[12:15], v[80:95]
    v_exp_f32 v68, v68
    v_exp_f32 v69, v69
    v_exp_f32 v70, v70
    v_exp_f32 v71, v71
    v_cvt_pk_bf16_f32 v96, v64, v65
    v_cvt_pk_bf16_f32 v97, v66, v67
    v_mfma_f32_32x32x16_bf16 v[144:159], v[136:139], v[104:107], v[144:159]
    v_exp_f32 v72, v72
    v_exp_f32 v73, v73
    v_exp_f32 v74, v74
    v_exp_f32 v75, v75
    v_cvt_pk_bf16_f32 v98, v68, v69
    v_cvt_pk_bf16_f32 v99, v70, v71
    v_mfma_f32_32x32x16_bf16 v[144:159], v[140:143], v[108:111], v[144:159]
    v_exp_f32 v76, v76
    v_exp_f32 v77, v77
    v_exp_f32 v78, v78
    v_exp_f32 v79, v79
    v_cvt_pk_bf16_f32 v100, v72, v73
    v_cvt_pk_bf16_f32 v101, v74, v75
    v_cvt_pk_bf16_f32 v102, v76, v77
    v_cvt_pk_bf16_f32 v103, v78, v79
    s_add_u32 m0, s43, 114688
    s_add_u32 s35, s43, 0x40c000
    buffer_load_dwordx4 v4, s[8:11], s35 offen lds
    buffer_load_dwordx4 v4, s[8:11], s35 offen offset:1024 lds
    ds_read_b128 v[120:123], v18 offset:34816
    ds_read_b128 v[124:127], v18 offset:35840
    ds_read_b128 v[136:139], v18 offset:22528
    ds_read_b128 v[140:143], v18 offset:23552
    s_waitcnt lgkmcnt(4)
    v_mfma_f32_32x32x16_bf16 v[64:79], v[112:115], v[8:11], 0
    v_exp_f32 v80, v80
    v_exp_f32 v81, v81
    v_exp_f32 v82, v82
    v_exp_f32 v83, v83
    v_mfma_f32_32x32x16_bf16 v[64:79], v[116:119], v[12:15], v[64:79]
    v_exp_f32 v84, v84
    v_exp_f32 v85, v85
    v_exp_f32 v86, v86
    v_exp_f32 v87, v87
    v_cvt_pk_bf16_f32 v104, v80, v81
    v_cvt_pk_bf16_f32 v105, v82, v83
    v_mfma_f32_32x32x16_bf16 v[144:159], v[128:131], v[96:99], v[144:159]
    v_exp_f32 v88, v88
    v_exp_f32 v89, v89
    v_exp_f32 v90, v90
    v_exp_f32 v91, v91
    v_cvt_pk_bf16_f32 v106, v84, v85
    v_cvt_pk_bf16_f32 v107, v86, v87
    v_mfma_f32_32x32x16_bf16 v[144:159], v[132:135], v[100:103], v[144:159]
    v_exp_f32 v92, v92
    v_exp_f32 v93, v93
    v_exp_f32 v94, v94
    v_exp_f32 v95, v95
    v_cvt_pk_bf16_f32 v108, v88, v89
    v_cvt_pk_bf16_f32 v109, v90, v91
    v_cvt_pk_bf16_f32 v110, v92, v93
    v_cvt_pk_bf16_f32 v111, v94, v95
    ds_read_b128 v[112:115], v18 offset:36864
    ds_read_b128 v[116:119], v18 offset:37888
    ds_read_b128 v[128:131], v18 offset:49152
    ds_read_b128 v[132:135], v18 offset:50176
    s_waitcnt lgkmcnt(4)
    v_mfma_f32_32x32x16_bf16 v[80:95], v[120:123], v[8:11], 0
    v_exp_f32 v64, v64
    v_exp_f32 v65, v65
    v_exp_f32 v66, v66
    v_exp_f32 v67, v67
    v_mfma_f32_32x32x16_bf16 v[80:95], v[124:127], v[12:15], v[80:95]
    v_exp_f32 v68, v68
    v_exp_f32 v69, v69
    v_exp_f32 v70, v70
    v_exp_f32 v71, v71
    v_cvt_pk_bf16_f32 v96, v64, v65
    v_cvt_pk_bf16_f32 v97, v66, v67
    v_mfma_f32_32x32x16_bf16 v[144:159], v[136:139], v[104:107], v[144:159]
    v_exp_f32 v72, v72
    v_exp_f32 v73, v73
    v_exp_f32 v74, v74
    v_exp_f32 v75, v75
    v_cvt_pk_bf16_f32 v98, v68, v69
    v_cvt_pk_bf16_f32 v99, v70, v71
    v_mfma_f32_32x32x16_bf16 v[144:159], v[140:143], v[108:111], v[144:159]
    v_exp_f32 v76, v76
    v_exp_f32 v77, v77
    v_exp_f32 v78, v78
    v_exp_f32 v79, v79
    v_cvt_pk_bf16_f32 v100, v72, v73
    v_cvt_pk_bf16_f32 v101, v74, v75
    v_cvt_pk_bf16_f32 v102, v76, v77
    v_cvt_pk_bf16_f32 v103, v78, v79
    s_waitcnt vmcnt(4)
    s_barrier
    ds_read_b128 v[120:123], v18 offset:38912
    ds_read_b128 v[124:127], v18 offset:39936
    ds_read_b128 v[136:139], v18 offset:51200
    ds_read_b128 v[140:143], v18 offset:52224
    s_waitcnt lgkmcnt(4)
    v_mfma_f32_32x32x16_bf16 v[64:79], v[112:115], v[8:11], 0
    v_exp_f32 v80, v80
    v_exp_f32 v81, v81
    v_exp_f32 v82, v82
    v_exp_f32 v83, v83
    v_mfma_f32_32x32x16_bf16 v[64:79], v[116:119], v[12:15], v[64:79]
    v_exp_f32 v84, v84
    v_exp_f32 v85, v85
    v_exp_f32 v86, v86
    v_exp_f32 v87, v87
    v_cvt_pk_bf16_f32 v104, v80, v81
    v_cvt_pk_bf16_f32 v105, v82, v83
    v_mfma_f32_32x32x16_bf16 v[144:159], v[128:131], v[96:99], v[144:159]
    v_exp_f32 v88, v88
    v_exp_f32 v89, v89
    v_exp_f32 v90, v90
    v_exp_f32 v91, v91
    v_cvt_pk_bf16_f32 v106, v84, v85
    v_cvt_pk_bf16_f32 v107, v86, v87
    v_mfma_f32_32x32x16_bf16 v[144:159], v[132:135], v[100:103], v[144:159]
    v_exp_f32 v92, v92
    v_exp_f32 v93, v93
    v_exp_f32 v94, v94
    v_exp_f32 v95, v95
    v_cvt_pk_bf16_f32 v108, v88, v89
    v_cvt_pk_bf16_f32 v109, v90, v91
    v_cvt_pk_bf16_f32 v110, v92, v93
    v_cvt_pk_bf16_f32 v111, v94, v95
    s_add_u32 m0, s43, 0
    s_add_u32 s35, s43, 0x210000
    buffer_load_dwordx4 v4, s[8:11], s35 offen lds
    buffer_load_dwordx4 v4, s[8:11], s35 offen offset:1024 lds
    ds_read_b128 v[112:115], v42 offset:0
    ds_read_b128 v[116:119], v42 offset:1024
    ds_read_b128 v[128:131], v18 offset:53248
    ds_read_b128 v[132:135], v18 offset:54272
    s_waitcnt lgkmcnt(4)
    v_mfma_f32_32x32x16_bf16 v[80:95], v[120:123], v[8:11], 0
    v_exp_f32 v64, v64
    v_exp_f32 v65, v65
    v_exp_f32 v66, v66
    v_exp_f32 v67, v67
    v_mfma_f32_32x32x16_bf16 v[80:95], v[124:127], v[12:15], v[80:95]
    v_exp_f32 v68, v68
    v_exp_f32 v69, v69
    v_exp_f32 v70, v70
    v_exp_f32 v71, v71
    v_cvt_pk_bf16_f32 v96, v64, v65
    v_cvt_pk_bf16_f32 v97, v66, v67
    v_mfma_f32_32x32x16_bf16 v[144:159], v[136:139], v[104:107], v[144:159]
    v_exp_f32 v72, v72
    v_exp_f32 v73, v73
    v_exp_f32 v74, v74
    v_exp_f32 v75, v75
    v_cvt_pk_bf16_f32 v98, v68, v69
    v_cvt_pk_bf16_f32 v99, v70, v71
    v_mfma_f32_32x32x16_bf16 v[144:159], v[140:143], v[108:111], v[144:159]
    v_exp_f32 v76, v76
    v_exp_f32 v77, v77
    v_exp_f32 v78, v78
    v_exp_f32 v79, v79
    v_cvt_pk_bf16_f32 v100, v72, v73
    v_cvt_pk_bf16_f32 v101, v74, v75
    v_cvt_pk_bf16_f32 v102, v76, v77
    v_cvt_pk_bf16_f32 v103, v78, v79
    s_add_u32 m0, s43, 16384
    s_add_u32 s35, s43, 0x410000
    buffer_load_dwordx4 v4, s[8:11], s35 offen lds
    buffer_load_dwordx4 v4, s[8:11], s35 offen offset:1024 lds
    ds_read_b128 v[120:123], v42 offset:2048
    ds_read_b128 v[124:127], v42 offset:3072
    ds_read_b128 v[136:139], v18 offset:55296
    ds_read_b128 v[140:143], v18 offset:56320
    s_waitcnt lgkmcnt(4)
    v_mfma_f32_32x32x16_bf16 v[64:79], v[112:115], v[8:11], 0
    v_exp_f32 v80, v80
    v_exp_f32 v81, v81
    v_exp_f32 v82, v82
    v_exp_f32 v83, v83
    v_mfma_f32_32x32x16_bf16 v[64:79], v[116:119], v[12:15], v[64:79]
    v_exp_f32 v84, v84
    v_exp_f32 v85, v85
    v_exp_f32 v86, v86
    v_exp_f32 v87, v87
    v_cvt_pk_bf16_f32 v104, v80, v81
    v_cvt_pk_bf16_f32 v105, v82, v83
    v_mfma_f32_32x32x16_bf16 v[144:159], v[128:131], v[96:99], v[144:159]
    v_exp_f32 v88, v88
    v_exp_f32 v89, v89
    v_exp_f32 v90, v90
    v_exp_f32 v91, v91
    v_cvt_pk_bf16_f32 v106, v84, v85
    v_cvt_pk_bf16_f32 v107, v86, v87
    v_mfma_f32_32x32x16_bf16 v[144:159], v[132:135], v[100:103], v[144:159]
    v_exp_f32 v92, v92
    v_exp_f32 v93, v93
    v_exp_f32 v94, v94
    v_exp_f32 v95, v95
    v_cvt_pk_bf16_f32 v108, v88, v89
    v_cvt_pk_bf16_f32 v109, v90, v91
    v_cvt_pk_bf16_f32 v110, v92, v93
    v_cvt_pk_bf16_f32 v111, v94, v95
    ds_read_b128 v[112:115], v42 offset:4096
    ds_read_b128 v[116:119], v42 offset:5120
    ds_read_b128 v[128:131], v42 offset:16384
    ds_read_b128 v[132:135], v42 offset:17408
    s_waitcnt lgkmcnt(4)
    v_mfma_f32_32x32x16_bf16 v[80:95], v[120:123], v[8:11], 0
    v_exp_f32 v64, v64
    v_exp_f32 v65, v65
    v_exp_f32 v66, v66
    v_exp_f32 v67, v67
    v_mfma_f32_32x32x16_bf16 v[80:95], v[124:127], v[12:15], v[80:95]
    v_exp_f32 v68, v68
    v_exp_f32 v69, v69
    v_exp_f32 v70, v70
    v_exp_f32 v71, v71
    v_cvt_pk_bf16_f32 v96, v64, v65
    v_cvt_pk_bf16_f32 v97, v66, v67
    v_mfma_f32_32x32x16_bf16 v[144:159], v[136:139], v[104:107], v[144:159]
    v_exp_f32 v72, v72
    v_exp_f32 v73, v73
    v_exp_f32 v74, v74
    v_exp_f32 v75, v75
    v_cvt_pk_bf16_f32 v98, v68, v69
    v_cvt_pk_bf16_f32 v99, v70, v71
    v_mfma_f32_32x32x16_bf16 v[144:159], v[140:143], v[108:111], v[144:159]
    v_exp_f32 v76, v76
    v_exp_f32 v77, v77
    v_exp_f32 v78, v78
    v_exp_f32 v79, v79
    v_cvt_pk_bf16_f32 v100, v72, v73
    v_cvt_pk_bf16_f32 v101, v74, v75
    v_cvt_pk_bf16_f32 v102, v76, v77
    v_cvt_pk_bf16_f32 v103, v78, v79
    s_waitcnt vmcnt(4)
    s_barrier
    ds_read_b128 v[120:123], v42 offset:6144
    ds_read_b128 v[124:127], v42 offset:7168
    ds_read_b128 v[136:139], v42 offset:18432
    ds_read_b128 v[140:143], v42 offset:19456
    s_waitcnt lgkmcnt(4)
    v_mfma_f32_32x32x16_bf16 v[64:79], v[112:115], v[8:11], 0
    v_exp_f32 v80, v80
    v_exp_f32 v81, v81
    v_exp_f32 v82, v82
    v_exp_f32 v83, v83
    v_mfma_f32_32x32x16_bf16 v[64:79], v[116:119], v[12:15], v[64:79]
    v_exp_f32 v84, v84
    v_exp_f32 v85, v85
    v_exp_f32 v86, v86
    v_exp_f32 v87, v87
    v_cvt_pk_bf16_f32 v104, v80, v81
    v_cvt_pk_bf16_f32 v105, v82, v83
    v_mfma_f32_32x32x16_bf16 v[144:159], v[128:131], v[96:99], v[144:159]
    v_exp_f32 v88, v88
    v_exp_f32 v89, v89
    v_exp_f32 v90, v90
    v_exp_f32 v91, v91
    v_cvt_pk_bf16_f32 v106, v84, v85
    v_cvt_pk_bf16_f32 v107, v86, v87
    v_mfma_f32_32x32x16_bf16 v[144:159], v[132:135], v[100:103], v[144:159]
    v_exp_f32 v92, v92
    v_exp_f32 v93, v93
    v_exp_f32 v94, v94
    v_exp_f32 v95, v95
    v_cvt_pk_bf16_f32 v108, v88, v89
    v_cvt_pk_bf16_f32 v109, v90, v91
    v_cvt_pk_bf16_f32 v110, v92, v93
    v_cvt_pk_bf16_f32 v111, v94, v95
    s_add_u32 m0, s43, 32768
    s_add_u32 s35, s43, 0x214000
    buffer_load_dwordx4 v4, s[8:11], s35 offen lds
    buffer_load_dwordx4 v4, s[8:11], s35 offen offset:1024 lds
    ds_read_b128 v[112:115], v42 offset:32768
    ds_read_b128 v[116:119], v42 offset:33792
    ds_read_b128 v[128:131], v42 offset:20480
    ds_read_b128 v[132:135], v42 offset:21504
    s_waitcnt lgkmcnt(4)
    v_mfma_f32_32x32x16_bf16 v[80:95], v[120:123], v[8:11], 0
    v_exp_f32 v64, v64
    v_exp_f32 v65, v65
    v_exp_f32 v66, v66
    v_exp_f32 v67, v67
    v_mfma_f32_32x32x16_bf16 v[80:95], v[124:127], v[12:15], v[80:95]
    v_exp_f32 v68, v68
    v_exp_f32 v69, v69
    v_exp_f32 v70, v70
    v_exp_f32 v71, v71
    v_cvt_pk_bf16_f32 v96, v64, v65
    v_cvt_pk_bf16_f32 v97, v66, v67
    v_mfma_f32_32x32x16_bf16 v[144:159], v[136:139], v[104:107], v[144:159]
    v_exp_f32 v72, v72
    v_exp_f32 v73, v73
    v_exp_f32 v74, v74
    v_exp_f32 v75, v75
    v_cvt_pk_bf16_f32 v98, v68, v69
    v_cvt_pk_bf16_f32 v99, v70, v71
    v_mfma_f32_32x32x16_bf16 v[144:159], v[140:143], v[108:111], v[144:159]
    v_exp_f32 v76, v76
    v_exp_f32 v77, v77
    v_exp_f32 v78, v78
    v_exp_f32 v79, v79
    v_cvt_pk_bf16_f32 v100, v72, v73
    v_cvt_pk_bf16_f32 v101, v74, v75
    v_cvt_pk_bf16_f32 v102, v76, v77
    v_cvt_pk_bf16_f32 v103, v78, v79
    s_add_u32 m0, s43, 49152
    s_add_u32 s35, s43, 0x414000
    buffer_load_dwordx4 v4, s[8:11], s35 offen lds
    buffer_load_dwordx4 v4, s[8:11], s35 offen offset:1024 lds
    ds_read_b128 v[120:123], v42 offset:34816
    ds_read_b128 v[124:127], v42 offset:35840
    ds_read_b128 v[136:139], v42 offset:22528
    ds_read_b128 v[140:143], v42 offset:23552
    s_waitcnt lgkmcnt(4)
    v_mfma_f32_32x32x16_bf16 v[64:79], v[112:115], v[8:11], 0
    v_exp_f32 v80, v80
    v_exp_f32 v81, v81
    v_exp_f32 v82, v82
    v_exp_f32 v83, v83
    v_mfma_f32_32x32x16_bf16 v[64:79], v[116:119], v[12:15], v[64:79]
    v_exp_f32 v84, v84
    v_exp_f32 v85, v85
    v_exp_f32 v86, v86
    v_exp_f32 v87, v87
    v_cvt_pk_bf16_f32 v104, v80, v81
    v_cvt_pk_bf16_f32 v105, v82, v83
    v_mfma_f32_32x32x16_bf16 v[144:159], v[128:131], v[96:99], v[144:159]
    v_exp_f32 v88, v88
    v_exp_f32 v89, v89
    v_exp_f32 v90, v90
    v_exp_f32 v91, v91
    v_cvt_pk_bf16_f32 v106, v84, v85
    v_cvt_pk_bf16_f32 v107, v86, v87
    v_mfma_f32_32x32x16_bf16 v[144:159], v[132:135], v[100:103], v[144:159]
    v_exp_f32 v92, v92
    v_exp_f32 v93, v93
    v_exp_f32 v94, v94
    v_exp_f32 v95, v95
    v_cvt_pk_bf16_f32 v108, v88, v89
    v_cvt_pk_bf16_f32 v109, v90, v91
    v_cvt_pk_bf16_f32 v110, v92, v93
    v_cvt_pk_bf16_f32 v111, v94, v95
    ds_read_b128 v[112:115], v42 offset:36864
    ds_read_b128 v[116:119], v42 offset:37888
    ds_read_b128 v[128:131], v42 offset:49152
    ds_read_b128 v[132:135], v42 offset:50176
    s_waitcnt lgkmcnt(4)
    v_mfma_f32_32x32x16_bf16 v[80:95], v[120:123], v[8:11], 0
    v_exp_f32 v64, v64
    v_exp_f32 v65, v65
    v_exp_f32 v66, v66
    v_exp_f32 v67, v67
    v_mfma_f32_32x32x16_bf16 v[80:95], v[124:127], v[12:15], v[80:95]
    v_exp_f32 v68, v68
    v_exp_f32 v69, v69
    v_exp_f32 v70, v70
    v_exp_f32 v71, v71
    v_cvt_pk_bf16_f32 v96, v64, v65
    v_cvt_pk_bf16_f32 v97, v66, v67
    v_mfma_f32_32x32x16_bf16 v[144:159], v[136:139], v[104:107], v[144:159]
    v_exp_f32 v72, v72
    v_exp_f32 v73, v73
    v_exp_f32 v74, v74
    v_exp_f32 v75, v75
    v_cvt_pk_bf16_f32 v98, v68, v69
    v_cvt_pk_bf16_f32 v99, v70, v71
    v_mfma_f32_32x32x16_bf16 v[144:159], v[140:143], v[108:111], v[144:159]
    v_exp_f32 v76, v76
    v_exp_f32 v77, v77
    v_exp_f32 v78, v78
    v_exp_f32 v79, v79
    v_cvt_pk_bf16_f32 v100, v72, v73
    v_cvt_pk_bf16_f32 v101, v74, v75
    v_cvt_pk_bf16_f32 v102, v76, v77
    v_cvt_pk_bf16_f32 v103, v78, v79
    s_waitcnt vmcnt(4)
    s_barrier
    ds_read_b128 v[120:123], v42 offset:38912
    ds_read_b128 v[124:127], v42 offset:39936
    ds_read_b128 v[136:139], v42 offset:51200
    ds_read_b128 v[140:143], v42 offset:52224
    s_waitcnt lgkmcnt(4)
    v_mfma_f32_32x32x16_bf16 v[64:79], v[112:115], v[8:11], 0
    v_exp_f32 v80, v80
    v_exp_f32 v81, v81
    v_exp_f32 v82, v82
    v_exp_f32 v83, v83
    v_mfma_f32_32x32x16_bf16 v[64:79], v[116:119], v[12:15], v[64:79]
    v_exp_f32 v84, v84
    v_exp_f32 v85, v85
    v_exp_f32 v86, v86
    v_exp_f32 v87, v87
    v_cvt_pk_bf16_f32 v104, v80, v81
    v_cvt_pk_bf16_f32 v105, v82, v83
    v_mfma_f32_32x32x16_bf16 v[144:159], v[128:131], v[96:99], v[144:159]
    v_exp_f32 v88, v88
    v_exp_f32 v89, v89
    v_exp_f32 v90, v90
    v_exp_f32 v91, v91
    v_cvt_pk_bf16_f32 v106, v84, v85
    v_cvt_pk_bf16_f32 v107, v86, v87
    v_mfma_f32_32x32x16_bf16 v[144:159], v[132:135], v[100:103], v[144:159]
    v_exp_f32 v92, v92
    v_exp_f32 v93, v93
    v_exp_f32 v94, v94
    v_exp_f32 v95, v95
    v_cvt_pk_bf16_f32 v108, v88, v89
    v_cvt_pk_bf16_f32 v109, v90, v91
    v_cvt_pk_bf16_f32 v110, v92, v93
    v_cvt_pk_bf16_f32 v111, v94, v95
    s_add_u32 m0, s43, 65536
    s_add_u32 s35, s43, 0x218000
    buffer_load_dwordx4 v4, s[8:11], s35 offen lds
    buffer_load_dwordx4 v4, s[8:11], s35 offen offset:1024 lds
    ds_read_b128 v[112:115], v18 offset:0
    ds_read_b128 v[116:119], v18 offset:1024
    ds_read_b128 v[128:131], v42 offset:53248
    ds_read_b128 v[132:135], v42 offset:54272
    s_waitcnt lgkmcnt(4)
    v_mfma_f32_32x32x16_bf16 v[80:95], v[120:123], v[8:11], 0
    v_exp_f32 v64, v64
    v_exp_f32 v65, v65
    v_exp_f32 v66, v66
    v_exp_f32 v67, v67
    v_mfma_f32_32x32x16_bf16 v[80:95], v[124:127], v[12:15], v[80:95]
    v_exp_f32 v68, v68
    v_exp_f32 v69, v69
    v_exp_f32 v70, v70
    v_exp_f32 v71, v71
    v_cvt_pk_bf16_f32 v96, v64, v65
    v_cvt_pk_bf16_f32 v97, v66, v67
    v_mfma_f32_32x32x16_bf16 v[144:159], v[136:139], v[104:107], v[144:159]
    v_exp_f32 v72, v72
    v_exp_f32 v73, v73
    v_exp_f32 v74, v74
    v_exp_f32 v75, v75
    v_cvt_pk_bf16_f32 v98, v68, v69
    v_cvt_pk_bf16_f32 v99, v70, v71
    v_mfma_f32_32x32x16_bf16 v[144:159], v[140:143], v[108:111], v[144:159]
    v_exp_f32 v76, v76
    v_exp_f32 v77, v77
    v_exp_f32 v78, v78
    v_exp_f32 v79, v79
    v_cvt_pk_bf16_f32 v100, v72, v73
    v_cvt_pk_bf16_f32 v101, v74, v75
    v_cvt_pk_bf16_f32 v102, v76, v77
    v_cvt_pk_bf16_f32 v103, v78, v79
    s_add_u32 m0, s43, 81920
    s_add_u32 s35, s43, 0x418000
    buffer_load_dwordx4 v4, s[8:11], s35 offen lds
    buffer_load_dwordx4 v4, s[8:11], s35 offen offset:1024 lds
    ds_read_b128 v[120:123], v18 offset:2048
    ds_read_b128 v[124:127], v18 offset:3072
    ds_read_b128 v[136:139], v42 offset:55296
    ds_read_b128 v[140:143], v42 offset:56320
    s_waitcnt lgkmcnt(4)
    v_mfma_f32_32x32x16_bf16 v[64:79], v[112:115], v[8:11], 0
    v_exp_f32 v80, v80
    v_exp_f32 v81, v81
    v_exp_f32 v82, v82
    v_exp_f32 v83, v83
    v_mfma_f32_32x32x16_bf16 v[64:79], v[116:119], v[12:15], v[64:79]
    v_exp_f32 v84, v84
    v_exp_f32 v85, v85
    v_exp_f32 v86, v86
    v_exp_f32 v87, v87
    v_cvt_pk_bf16_f32 v104, v80, v81
    v_cvt_pk_bf16_f32 v105, v82, v83
    v_mfma_f32_32x32x16_bf16 v[144:159], v[128:131], v[96:99], v[144:159]
    v_exp_f32 v88, v88
    v_exp_f32 v89, v89
    v_exp_f32 v90, v90
    v_exp_f32 v91, v91
    v_cvt_pk_bf16_f32 v106, v84, v85
    v_cvt_pk_bf16_f32 v107, v86, v87
    v_mfma_f32_32x32x16_bf16 v[144:159], v[132:135], v[100:103], v[144:159]
    v_exp_f32 v92, v92
    v_exp_f32 v93, v93
    v_exp_f32 v94, v94
    v_exp_f32 v95, v95
    v_cvt_pk_bf16_f32 v108, v88, v89
    v_cvt_pk_bf16_f32 v109, v90, v91
    v_cvt_pk_bf16_f32 v110, v92, v93
    v_cvt_pk_bf16_f32 v111, v94, v95
    ds_read_b128 v[112:115], v18 offset:4096
    ds_read_b128 v[116:119], v18 offset:5120
    ds_read_b128 v[128:131], v18 offset:16384
    ds_read_b128 v[132:135], v18 offset:17408
    s_waitcnt lgkmcnt(4)
    v_mfma_f32_32x32x16_bf16 v[80:95], v[120:123], v[8:11], 0
    v_exp_f32 v64, v64
    v_exp_f32 v65, v65
    v_exp_f32 v66, v66
    v_exp_f32 v67, v67
    v_mfma_f32_32x32x16_bf16 v[80:95], v[124:127], v[12:15], v[80:95]
    v_exp_f32 v68, v68
    v_exp_f32 v69, v69
    v_exp_f32 v70, v70
    v_exp_f32 v71, v71
    v_cvt_pk_bf16_f32 v96, v64, v65
    v_cvt_pk_bf16_f32 v97, v66, v67
    v_mfma_f32_32x32x16_bf16 v[144:159], v[136:139], v[104:107], v[144:159]
    v_exp_f32 v72, v72
    v_exp_f32 v73, v73
    v_exp_f32 v74, v74
    v_exp_f32 v75, v75
    v_cvt_pk_bf16_f32 v98, v68, v69
    v_cvt_pk_bf16_f32 v99, v70, v71
    v_mfma_f32_32x32x16_bf16 v[144:159], v[140:143], v[108:111], v[144:159]
    v_exp_f32 v76, v76
    v_exp_f32 v77, v77
    v_exp_f32 v78, v78
    v_exp_f32 v79, v79
    v_cvt_pk_bf16_f32 v100, v72, v73
    v_cvt_pk_bf16_f32 v101, v74, v75
    v_cvt_pk_bf16_f32 v102, v76, v77
    v_cvt_pk_bf16_f32 v103, v78, v79
    s_waitcnt vmcnt(4)
    s_barrier
    ds_read_b128 v[120:123], v18 offset:6144
    ds_read_b128 v[124:127], v18 offset:7168
    ds_read_b128 v[136:139], v18 offset:18432
    ds_read_b128 v[140:143], v18 offset:19456
    s_waitcnt lgkmcnt(4)
    v_mfma_f32_32x32x16_bf16 v[64:79], v[112:115], v[8:11], 0
    v_exp_f32 v80, v80
    v_exp_f32 v81, v81
    v_exp_f32 v82, v82
    v_exp_f32 v83, v83
    v_mfma_f32_32x32x16_bf16 v[64:79], v[116:119], v[12:15], v[64:79]
    v_exp_f32 v84, v84
    v_exp_f32 v85, v85
    v_exp_f32 v86, v86
    v_exp_f32 v87, v87
    v_cvt_pk_bf16_f32 v104, v80, v81
    v_cvt_pk_bf16_f32 v105, v82, v83
    v_mfma_f32_32x32x16_bf16 v[144:159], v[128:131], v[96:99], v[144:159]
    v_exp_f32 v88, v88
    v_exp_f32 v89, v89
    v_exp_f32 v90, v90
    v_exp_f32 v91, v91
    v_cvt_pk_bf16_f32 v106, v84, v85
    v_cvt_pk_bf16_f32 v107, v86, v87
    v_mfma_f32_32x32x16_bf16 v[144:159], v[132:135], v[100:103], v[144:159]
    v_exp_f32 v92, v92
    v_exp_f32 v93, v93
    v_exp_f32 v94, v94
    v_exp_f32 v95, v95
    v_cvt_pk_bf16_f32 v108, v88, v89
    v_cvt_pk_bf16_f32 v109, v90, v91
    v_cvt_pk_bf16_f32 v110, v92, v93
    v_cvt_pk_bf16_f32 v111, v94, v95
    s_add_u32 m0, s43, 98304
    s_add_u32 s35, s43, 0x21c000
    buffer_load_dwordx4 v4, s[8:11], s35 offen lds
    buffer_load_dwordx4 v4, s[8:11], s35 offen offset:1024 lds
    ds_read_b128 v[112:115], v18 offset:32768
    ds_read_b128 v[116:119], v18 offset:33792
    ds_read_b128 v[128:131], v18 offset:20480
    ds_read_b128 v[132:135], v18 offset:21504
    s_waitcnt lgkmcnt(4)
    v_mfma_f32_32x32x16_bf16 v[80:95], v[120:123], v[8:11], 0
    v_exp_f32 v64, v64
    v_exp_f32 v65, v65
    v_exp_f32 v66, v66
    v_exp_f32 v67, v67
    v_mfma_f32_32x32x16_bf16 v[80:95], v[124:127], v[12:15], v[80:95]
    v_exp_f32 v68, v68
    v_exp_f32 v69, v69
    v_exp_f32 v70, v70
    v_exp_f32 v71, v71
    v_cvt_pk_bf16_f32 v96, v64, v65
    v_cvt_pk_bf16_f32 v97, v66, v67
    v_mfma_f32_32x32x16_bf16 v[144:159], v[136:139], v[104:107], v[144:159]
    v_exp_f32 v72, v72
    v_exp_f32 v73, v73
    v_exp_f32 v74, v74
    v_exp_f32 v75, v75
    v_cvt_pk_bf16_f32 v98, v68, v69
    v_cvt_pk_bf16_f32 v99, v70, v71
    v_mfma_f32_32x32x16_bf16 v[144:159], v[140:143], v[108:111], v[144:159]
    v_exp_f32 v76, v76
    v_exp_f32 v77, v77
    v_exp_f32 v78, v78
    v_exp_f32 v79, v79
    v_cvt_pk_bf16_f32 v100, v72, v73
    v_cvt_pk_bf16_f32 v101, v74, v75
    v_cvt_pk_bf16_f32 v102, v76, v77
    v_cvt_pk_bf16_f32 v103, v78, v79
    s_add_u32 m0, s43, 114688
    s_add_u32 s35, s43, 0x41c000
    buffer_load_dwordx4 v4, s[8:11], s35 offen lds
    buffer_load_dwordx4 v4, s[8:11], s35 offen offset:1024 lds
    ds_read_b128 v[120:123], v18 offset:34816
    ds_read_b128 v[124:127], v18 offset:35840
    ds_read_b128 v[136:139], v18 offset:22528
    ds_read_b128 v[140:143], v18 offset:23552
    s_waitcnt lgkmcnt(4)
    v_mfma_f32_32x32x16_bf16 v[64:79], v[112:115], v[8:11], 0
    v_exp_f32 v80, v80
    v_exp_f32 v81, v81
    v_exp_f32 v82, v82
    v_exp_f32 v83, v83
    v_mfma_f32_32x32x16_bf16 v[64:79], v[116:119], v[12:15], v[64:79]
    v_exp_f32 v84, v84
    v_exp_f32 v85, v85
    v_exp_f32 v86, v86
    v_exp_f32 v87, v87
    v_cvt_pk_bf16_f32 v104, v80, v81
    v_cvt_pk_bf16_f32 v105, v82, v83
    v_mfma_f32_32x32x16_bf16 v[144:159], v[128:131], v[96:99], v[144:159]
    v_exp_f32 v88, v88
    v_exp_f32 v89, v89
    v_exp_f32 v90, v90
    v_exp_f32 v91, v91
    v_cvt_pk_bf16_f32 v106, v84, v85
    v_cvt_pk_bf16_f32 v107, v86, v87
    v_mfma_f32_32x32x16_bf16 v[144:159], v[132:135], v[100:103], v[144:159]
    v_exp_f32 v92, v92
    v_exp_f32 v93, v93
    v_exp_f32 v94, v94
    v_exp_f32 v95, v95
    v_cvt_pk_bf16_f32 v108, v88, v89
    v_cvt_pk_bf16_f32 v109, v90, v91
    v_cvt_pk_bf16_f32 v110, v92, v93
    v_cvt_pk_bf16_f32 v111, v94, v95
    ds_read_b128 v[112:115], v18 offset:36864
    ds_read_b128 v[116:119], v18 offset:37888
    ds_read_b128 v[128:131], v18 offset:49152
    ds_read_b128 v[132:135], v18 offset:50176
    s_waitcnt lgkmcnt(4)
    v_mfma_f32_32x32x16_bf16 v[80:95], v[120:123], v[8:11], 0
    v_exp_f32 v64, v64
    v_exp_f32 v65, v65
    v_exp_f32 v66, v66
    v_exp_f32 v67, v67
    v_mfma_f32_32x32x16_bf16 v[80:95], v[124:127], v[12:15], v[80:95]
    v_exp_f32 v68, v68
    v_exp_f32 v69, v69
    v_exp_f32 v70, v70
    v_exp_f32 v71, v71
    v_cvt_pk_bf16_f32 v96, v64, v65
    v_cvt_pk_bf16_f32 v97, v66, v67
    v_mfma_f32_32x32x16_bf16 v[144:159], v[136:139], v[104:107], v[144:159]
    v_exp_f32 v72, v72
    v_exp_f32 v73, v73
    v_exp_f32 v74, v74
    v_exp_f32 v75, v75
    v_cvt_pk_bf16_f32 v98, v68, v69
    v_cvt_pk_bf16_f32 v99, v70, v71
    v_mfma_f32_32x32x16_bf16 v[144:159], v[140:143], v[108:111], v[144:159]
    v_exp_f32 v76, v76
    v_exp_f32 v77, v77
    v_exp_f32 v78, v78
    v_exp_f32 v79, v79
    v_cvt_pk_bf16_f32 v100, v72, v73
    v_cvt_pk_bf16_f32 v101, v74, v75
    v_cvt_pk_bf16_f32 v102, v76, v77
    v_cvt_pk_bf16_f32 v103, v78, v79
    s_waitcnt vmcnt(4)
    s_barrier
    ds_read_b128 v[120:123], v18 offset:38912
    ds_read_b128 v[124:127], v18 offset:39936
    ds_read_b128 v[136:139], v18 offset:51200
    ds_read_b128 v[140:143], v18 offset:52224
    s_waitcnt lgkmcnt(4)
    v_mfma_f32_32x32x16_bf16 v[64:79], v[112:115], v[8:11], 0
    v_exp_f32 v80, v80
    v_exp_f32 v81, v81
    v_exp_f32 v82, v82
    v_exp_f32 v83, v83
    v_mfma_f32_32x32x16_bf16 v[64:79], v[116:119], v[12:15], v[64:79]
    v_exp_f32 v84, v84
    v_exp_f32 v85, v85
    v_exp_f32 v86, v86
    v_exp_f32 v87, v87
    v_cvt_pk_bf16_f32 v104, v80, v81
    v_cvt_pk_bf16_f32 v105, v82, v83
    v_mfma_f32_32x32x16_bf16 v[144:159], v[128:131], v[96:99], v[144:159]
    v_exp_f32 v88, v88
    v_exp_f32 v89, v89
    v_exp_f32 v90, v90
    v_exp_f32 v91, v91
    v_cvt_pk_bf16_f32 v106, v84, v85
    v_cvt_pk_bf16_f32 v107, v86, v87
    v_mfma_f32_32x32x16_bf16 v[144:159], v[132:135], v[100:103], v[144:159]
    v_exp_f32 v92, v92
    v_exp_f32 v93, v93
    v_exp_f32 v94, v94
    v_exp_f32 v95, v95
    v_cvt_pk_bf16_f32 v108, v88, v89
    v_cvt_pk_bf16_f32 v109, v90, v91
    v_cvt_pk_bf16_f32 v110, v92, v93
    v_cvt_pk_bf16_f32 v111, v94, v95
    ds_read_b128 v[112:115], v42 offset:0
    ds_read_b128 v[116:119], v42 offset:1024
    ds_read_b128 v[128:131], v18 offset:53248
    ds_read_b128 v[132:135], v18 offset:54272
    s_waitcnt lgkmcnt(4)
    v_mfma_f32_32x32x16_bf16 v[80:95], v[120:123], v[8:11], 0
    v_exp_f32 v64, v64
    v_exp_f32 v65, v65
    v_exp_f32 v66, v66
    v_exp_f32 v67, v67
    v_mfma_f32_32x32x16_bf16 v[80:95], v[124:127], v[12:15], v[80:95]
    v_exp_f32 v68, v68
    v_exp_f32 v69, v69
    v_exp_f32 v70, v70
    v_exp_f32 v71, v71
    v_cvt_pk_bf16_f32 v96, v64, v65
    v_cvt_pk_bf16_f32 v97, v66, v67
    v_mfma_f32_32x32x16_bf16 v[144:159], v[136:139], v[104:107], v[144:159]
    v_exp_f32 v72, v72
    v_exp_f32 v73, v73
    v_exp_f32 v74, v74
    v_exp_f32 v75, v75
    v_cvt_pk_bf16_f32 v98, v68, v69
    v_cvt_pk_bf16_f32 v99, v70, v71
    v_mfma_f32_32x32x16_bf16 v[144:159], v[140:143], v[108:111], v[144:159]
    v_exp_f32 v76, v76
    v_exp_f32 v77, v77
    v_exp_f32 v78, v78
    v_exp_f32 v79, v79
    v_cvt_pk_bf16_f32 v100, v72, v73
    v_cvt_pk_bf16_f32 v101, v74, v75
    v_cvt_pk_bf16_f32 v102, v76, v77
    v_cvt_pk_bf16_f32 v103, v78, v79
    s_and_b32 s80, s2, 7
    s_lshr_b32 s81, s2, 3
    v_lshrrev_b32 v244, 4, v1
    s_lshl_b32 s82, s33, 2
    v_add_u32 v244, s82, v244
    v_min_u32 v244, 13, v244
    s_mul_i32 s82, s81, 14
    v_add_u32 v244, s82, v244
    s_movk_i32 s82, 3584
    v_mul_u32_u24 v244, s82, v244
    v_and_b32 v245, 15, v1
    v_min_u32 v245, 13, v245
    v_lshl_add_u32 v244, v245, 7, v244
    s_lshr_b32 s82, s80, 2
    s_mul_i32 s82, s82, 1792
    s_cmp_eq_u32 s44, 0
    s_cselect_b32 s84, s50, s52
    s_cselect_b32 s85, s51, s53
    s_mov_b32 s86, 1605632
    s_mov_b32 s87, 0x00020000
    buffer_load_dword v240, v244, s[84:87], s82 offen
    v_min_u32 v245, 97, v0
    v_lshlrev_b32 v245, 7, v245
    s_mul_i32 s82, s81, 12544
    s_mov_b32 s84, s48
    s_mov_b32 s85, s49
    s_mov_b32 s86, 0x62000
    s_mov_b32 s87, 0x00020000
    buffer_load_dword v241, v245, s[84:87], s82 offen
    v_min_u32 v246, 391, v0
    v_lshlrev_b32 v246, 7, v246
    s_mul_i32 s82, s81, 50176
    s_mov_b32 s84, s54
    s_mov_b32 s85, s55
    s_mov_b32 s86, 0x188000
    s_mov_b32 s87, 0x00020000
    ds_read_b128 v[120:123], v42 offset:2048
    ds_read_b128 v[124:127], v42 offset:3072
    ds_read_b128 v[136:139], v18 offset:55296
    ds_read_b128 v[140:143], v18 offset:56320
    s_waitcnt lgkmcnt(4)
    v_mfma_f32_32x32x16_bf16 v[64:79], v[112:115], v[8:11], 0
    v_exp_f32 v80, v80
    v_exp_f32 v81, v81
    v_exp_f32 v82, v82
    v_exp_f32 v83, v83
    v_mfma_f32_32x32x16_bf16 v[64:79], v[116:119], v[12:15], v[64:79]
    v_exp_f32 v84, v84
    v_exp_f32 v85, v85
    v_exp_f32 v86, v86
    v_exp_f32 v87, v87
    v_cvt_pk_bf16_f32 v104, v80, v81
    v_cvt_pk_bf16_f32 v105, v82, v83
    v_mfma_f32_32x32x16_bf16 v[144:159], v[128:131], v[96:99], v[144:159]
    v_exp_f32 v88, v88
    v_exp_f32 v89, v89
    v_exp_f32 v90, v90
    v_exp_f32 v91, v91
    v_cvt_pk_bf16_f32 v106, v84, v85
    v_cvt_pk_bf16_f32 v107, v86, v87
    v_mfma_f32_32x32x16_bf16 v[144:159], v[132:135], v[100:103], v[144:159]
    v_exp_f32 v92, v92
    v_exp_f32 v93, v93
    v_exp_f32 v94, v94
    v_exp_f32 v95, v95
    v_cvt_pk_bf16_f32 v108, v88, v89
    v_cvt_pk_bf16_f32 v109, v90, v91
    v_cvt_pk_bf16_f32 v110, v92, v93
    v_cvt_pk_bf16_f32 v111, v94, v95
    ds_read_b128 v[112:115], v42 offset:4096
    ds_read_b128 v[116:119], v42 offset:5120
    ds_read_b128 v[128:131], v42 offset:16384
    ds_read_b128 v[132:135], v42 offset:17408
    s_waitcnt lgkmcnt(4)
    v_mfma_f32_32x32x16_bf16 v[80:95], v[120:123], v[8:11], 0
    v_exp_f32 v64, v64
    v_exp_f32 v65, v65
    v_exp_f32 v66, v66
    v_exp_f32 v67, v67
    v_mfma_f32_32x32x16_bf16 v[80:95], v[124:127], v[12:15], v[80:95]
    v_exp_f32 v68, v68
    v_exp_f32 v69, v69
    v_exp_f32 v70, v70
    v_exp_f32 v71, v71
    v_cvt_pk_bf16_f32 v96, v64, v65
    v_cvt_pk_bf16_f32 v97, v66, v67
    v_mfma_f32_32x32x16_bf16 v[144:159], v[136:139], v[104:107], v[144:159]
    v_exp_f32 v72, v72
    v_exp_f32 v73, v73
    v_exp_f32 v74, v74
    v_exp_f32 v75, v75
    v_cvt_pk_bf16_f32 v98, v68, v69
    v_cvt_pk_bf16_f32 v99, v70, v71
    v_mfma_f32_32x32x16_bf16 v[144:159], v[140:143], v[108:111], v[144:159]
    v_exp_f32 v76, v76
    v_exp_f32 v77, v77
    v_exp_f32 v78, v78
    v_exp_f32 v79, v79
    v_cvt_pk_bf16_f32 v100, v72, v73
    v_cvt_pk_bf16_f32 v101, v74, v75
    v_cvt_pk_bf16_f32 v102, v76, v77
    v_cvt_pk_bf16_f32 v103, v78, v79
    s_waitcnt vmcnt(2)
    s_barrier
    ds_read_b128 v[120:123], v42 offset:6144
    ds_read_b128 v[124:127], v42 offset:7168
    ds_read_b128 v[136:139], v42 offset:18432
    ds_read_b128 v[140:143], v42 offset:19456
    s_waitcnt lgkmcnt(4)
    v_mfma_f32_32x32x16_bf16 v[64:79], v[112:115], v[8:11], 0
    v_exp_f32 v80, v80
    v_exp_f32 v81, v81
    v_exp_f32 v82, v82
    v_exp_f32 v83, v83
    v_mfma_f32_32x32x16_bf16 v[64:79], v[116:119], v[12:15], v[64:79]
    v_exp_f32 v84, v84
    v_exp_f32 v85, v85
    v_exp_f32 v86, v86
    v_exp_f32 v87, v87
    v_cvt_pk_bf16_f32 v104, v80, v81
    v_cvt_pk_bf16_f32 v105, v82, v83
    v_mfma_f32_32x32x16_bf16 v[144:159], v[128:131], v[96:99], v[144:159]
    v_exp_f32 v88, v88
    v_exp_f32 v89, v89
    v_exp_f32 v90, v90
    v_exp_f32 v91, v91
    v_cvt_pk_bf16_f32 v106, v84, v85
    v_cvt_pk_bf16_f32 v107, v86, v87
    v_mfma_f32_32x32x16_bf16 v[144:159], v[132:135], v[100:103], v[144:159]
    v_exp_f32 v92, v92
    v_exp_f32 v93, v93
    v_exp_f32 v94, v94
    v_exp_f32 v95, v95
    v_cvt_pk_bf16_f32 v108, v88, v89
    v_cvt_pk_bf16_f32 v109, v90, v91
    v_cvt_pk_bf16_f32 v110, v92, v93
    v_cvt_pk_bf16_f32 v111, v94, v95
    ds_read_b128 v[112:115], v42 offset:32768
    ds_read_b128 v[116:119], v42 offset:33792
    ds_read_b128 v[128:131], v42 offset:20480
    ds_read_b128 v[132:135], v42 offset:21504
    s_waitcnt lgkmcnt(4)
    v_mfma_f32_32x32x16_bf16 v[80:95], v[120:123], v[8:11], 0
    v_exp_f32 v64, v64
    v_exp_f32 v65, v65
    v_exp_f32 v66, v66
    v_exp_f32 v67, v67
    v_mfma_f32_32x32x16_bf16 v[80:95], v[124:127], v[12:15], v[80:95]
    v_exp_f32 v68, v68
    v_exp_f32 v69, v69
    v_exp_f32 v70, v70
    v_exp_f32 v71, v71
    v_cvt_pk_bf16_f32 v96, v64, v65
    v_cvt_pk_bf16_f32 v97, v66, v67
    v_mfma_f32_32x32x16_bf16 v[144:159], v[136:139], v[104:107], v[144:159]
    v_exp_f32 v72, v72
    v_exp_f32 v73, v73
    v_exp_f32 v74, v74
    v_exp_f32 v75, v75
    v_cvt_pk_bf16_f32 v98, v68, v69
    v_cvt_pk_bf16_f32 v99, v70, v71
    v_mfma_f32_32x32x16_bf16 v[144:159], v[140:143], v[108:111], v[144:159]
    v_exp_f32 v76, v76
    v_exp_f32 v77, v77
    v_exp_f32 v78, v78
    v_exp_f32 v79, v79
    v_cvt_pk_bf16_f32 v100, v72, v73
    v_cvt_pk_bf16_f32 v101, v74, v75
    v_cvt_pk_bf16_f32 v102, v76, v77
    v_cvt_pk_bf16_f32 v103, v78, v79
    ds_read_b128 v[120:123], v42 offset:34816
    ds_read_b128 v[124:127], v42 offset:35840
    ds_read_b128 v[136:139], v42 offset:22528
    ds_read_b128 v[140:143], v42 offset:23552
    s_waitcnt lgkmcnt(4)
    v_mfma_f32_32x32x16_bf16 v[64:79], v[112:115], v[8:11], 0
    v_exp_f32 v80, v80
    v_exp_f32 v81, v81
    v_exp_f32 v82, v82
    v_exp_f32 v83, v83
    v_mfma_f32_32x32x16_bf16 v[64:79], v[116:119], v[12:15], v[64:79]
    v_exp_f32 v84, v84
    v_exp_f32 v85, v85
    v_exp_f32 v86, v86
    v_exp_f32 v87, v87
    v_cvt_pk_bf16_f32 v104, v80, v81
    v_cvt_pk_bf16_f32 v105, v82, v83
    v_mfma_f32_32x32x16_bf16 v[144:159], v[128:131], v[96:99], v[144:159]
    v_exp_f32 v88, v88
    v_exp_f32 v89, v89
    v_exp_f32 v90, v90
    v_exp_f32 v91, v91
    v_cvt_pk_bf16_f32 v106, v84, v85
    v_cvt_pk_bf16_f32 v107, v86, v87
    v_mfma_f32_32x32x16_bf16 v[144:159], v[132:135], v[100:103], v[144:159]
    v_exp_f32 v92, v92
    v_exp_f32 v93, v93
    v_exp_f32 v94, v94
    v_exp_f32 v95, v95
    v_cvt_pk_bf16_f32 v108, v88, v89
    v_cvt_pk_bf16_f32 v109, v90, v91
    v_cvt_pk_bf16_f32 v110, v92, v93
    v_cvt_pk_bf16_f32 v111, v94, v95
    ds_read_b128 v[112:115], v42 offset:36864
    ds_read_b128 v[116:119], v42 offset:37888
    ds_read_b128 v[128:131], v42 offset:49152
    ds_read_b128 v[132:135], v42 offset:50176
    s_waitcnt lgkmcnt(4)
    v_mfma_f32_32x32x16_bf16 v[80:95], v[120:123], v[8:11], 0
    v_exp_f32 v64, v64
    v_exp_f32 v65, v65
    v_exp_f32 v66, v66
    v_exp_f32 v67, v67
    v_mfma_f32_32x32x16_bf16 v[80:95], v[124:127], v[12:15], v[80:95]
    v_exp_f32 v68, v68
    v_exp_f32 v69, v69
    v_exp_f32 v70, v70
    v_exp_f32 v71, v71
    v_cvt_pk_bf16_f32 v96, v64, v65
    v_cvt_pk_bf16_f32 v97, v66, v67
    v_mfma_f32_32x32x16_bf16 v[144:159], v[136:139], v[104:107], v[144:159]
    v_exp_f32 v72, v72
    v_exp_f32 v73, v73
    v_exp_f32 v74, v74
    v_exp_f32 v75, v75
    v_cvt_pk_bf16_f32 v98, v68, v69
    v_cvt_pk_bf16_f32 v99, v70, v71
    v_mfma_f32_32x32x16_bf16 v[144:159], v[140:143], v[108:111], v[144:159]
    v_exp_f32 v76, v76
    v_exp_f32 v77, v77
    v_exp_f32 v78, v78
    v_exp_f32 v79, v79
    v_cvt_pk_bf16_f32 v100, v72, v73
    v_cvt_pk_bf16_f32 v101, v74, v75
    v_cvt_pk_bf16_f32 v102, v76, v77
    v_cvt_pk_bf16_f32 v103, v78, v79
    s_barrier
    ds_read_b128 v[120:123], v42 offset:38912
    ds_read_b128 v[124:127], v42 offset:39936
    ds_read_b128 v[136:139], v42 offset:51200
    ds_read_b128 v[140:143], v42 offset:52224
    s_waitcnt lgkmcnt(4)
    v_mfma_f32_32x32x16_bf16 v[64:79], v[112:115], v[8:11], 0
    v_exp_f32 v80, v80
    v_exp_f32 v81, v81
    v_exp_f32 v82, v82
    v_exp_f32 v83, v83
    v_mfma_f32_32x32x16_bf16 v[64:79], v[116:119], v[12:15], v[64:79]
    v_exp_f32 v84, v84
    v_exp_f32 v85, v85
    v_exp_f32 v86, v86
    v_exp_f32 v87, v87
    v_cvt_pk_bf16_f32 v104, v80, v81
    v_cvt_pk_bf16_f32 v105, v82, v83
    v_mfma_f32_32x32x16_bf16 v[144:159], v[128:131], v[96:99], v[144:159]
    v_exp_f32 v88, v88
    v_exp_f32 v89, v89
    v_exp_f32 v90, v90
    v_exp_f32 v91, v91
    v_cvt_pk_bf16_f32 v106, v84, v85
    v_cvt_pk_bf16_f32 v107, v86, v87
    v_mfma_f32_32x32x16_bf16 v[144:159], v[132:135], v[100:103], v[144:159]
    v_exp_f32 v92, v92
    v_exp_f32 v93, v93
    v_exp_f32 v94, v94
    v_exp_f32 v95, v95
    v_cvt_pk_bf16_f32 v108, v88, v89
    v_cvt_pk_bf16_f32 v109, v90, v91
    v_cvt_pk_bf16_f32 v110, v92, v93
    v_cvt_pk_bf16_f32 v111, v94, v95
    ds_read_b128 v[128:131], v42 offset:53248
    ds_read_b128 v[132:135], v42 offset:54272
    s_waitcnt lgkmcnt(2)
    v_mfma_f32_32x32x16_bf16 v[80:95], v[120:123], v[8:11], 0
    v_exp_f32 v64, v64
    v_exp_f32 v65, v65
    v_exp_f32 v66, v66
    v_exp_f32 v67, v67
    v_mfma_f32_32x32x16_bf16 v[80:95], v[124:127], v[12:15], v[80:95]
    v_exp_f32 v68, v68
    v_exp_f32 v69, v69
    v_exp_f32 v70, v70
    v_exp_f32 v71, v71
    v_cvt_pk_bf16_f32 v96, v64, v65
    v_cvt_pk_bf16_f32 v97, v66, v67
    v_mfma_f32_32x32x16_bf16 v[144:159], v[136:139], v[104:107], v[144:159]
    v_exp_f32 v72, v72
    v_exp_f32 v73, v73
    v_exp_f32 v74, v74
    v_exp_f32 v75, v75
    v_cvt_pk_bf16_f32 v98, v68, v69
    v_cvt_pk_bf16_f32 v99, v70, v71
    v_mfma_f32_32x32x16_bf16 v[144:159], v[140:143], v[108:111], v[144:159]
    v_exp_f32 v76, v76
    v_exp_f32 v77, v77
    v_exp_f32 v78, v78
    v_exp_f32 v79, v79
    v_cvt_pk_bf16_f32 v100, v72, v73
    v_cvt_pk_bf16_f32 v101, v74, v75
    v_cvt_pk_bf16_f32 v102, v76, v77
    v_cvt_pk_bf16_f32 v103, v78, v79
    ds_read_b128 v[136:139], v42 offset:55296
    ds_read_b128 v[140:143], v42 offset:56320
    s_waitcnt lgkmcnt(2)
    v_exp_f32 v80, v80
    v_exp_f32 v81, v81
    v_exp_f32 v82, v82
    v_exp_f32 v83, v83
    v_exp_f32 v84, v84
    v_exp_f32 v85, v85
    v_exp_f32 v86, v86
    v_exp_f32 v87, v87
    v_cvt_pk_bf16_f32 v104, v80, v81
    v_cvt_pk_bf16_f32 v105, v82, v83
    v_mfma_f32_32x32x16_bf16 v[144:159], v[128:131], v[96:99], v[144:159]
    v_exp_f32 v88, v88
    v_exp_f32 v89, v89
    v_exp_f32 v90, v90
    v_exp_f32 v91, v91
    v_cvt_pk_bf16_f32 v106, v84, v85
    v_cvt_pk_bf16_f32 v107, v86, v87
    v_mfma_f32_32x32x16_bf16 v[144:159], v[132:135], v[100:103], v[144:159]
    v_exp_f32 v92, v92
    v_exp_f32 v93, v93
    v_exp_f32 v94, v94
    v_exp_f32 v95, v95
    v_cvt_pk_bf16_f32 v108, v88, v89
    v_cvt_pk_bf16_f32 v109, v90, v91
    v_cvt_pk_bf16_f32 v110, v92, v93
    v_cvt_pk_bf16_f32 v111, v94, v95
    s_waitcnt lgkmcnt(0)
    s_nop 1
    v_mfma_f32_32x32x16_bf16 v[144:159], v[136:139], v[104:107], v[144:159]
    v_mfma_f32_32x32x16_bf16 v[144:159], v[140:143], v[108:111], v[144:159]
    s_nop 15
    v_mov_b32 v128, v144
    v_mov_b32 v129, v145
    v_mov_b32 v130, v146
    v_mov_b32 v131, v147
    v_mov_b32 v132, v148
    v_mov_b32 v133, v149
    v_mov_b32 v134, v150
    v_mov_b32 v135, v151
    v_mov_b32 v136, v152
    v_mov_b32 v137, v153
    v_mov_b32 v138, v154
    v_mov_b32 v139, v155
    v_mov_b32 v140, v156
    v_mov_b32 v141, v157
    v_mov_b32 v142, v158
    v_mov_b32 v143, v159
    s_mov_b32 s38, 0x53800000
    v_cmp_nlt_f32 vcc, v156, s38
    s_and_b64 vcc, vcc, s[46:47]
    s_cmp_lg_u64 vcc, 0
    s_cselect_b32 s38, 1, 0
    v_mov_b32 v21, s38
    v_lshlrev_b32 v22, 2, v2
    v_add_u32 v22, 131072, v22
    ds_write_b32 v22, v21
    s_waitcnt lgkmcnt(0)
    s_barrier
    v_and_b32 v22, 7, v1
    v_lshlrev_b32 v22, 2, v22
    v_add_u32 v22, 131072, v22
    ds_read_b32 v21, v22
    s_waitcnt lgkmcnt(0)
    v_cmp_ne_u32 vcc, 0, v21
    s_cbranch_vccz k2_attn_kernel_combine1
    v_cndmask_b32 v14, v14, 0, s[46:47]
    s_waitcnt vmcnt(0)
    s_barrier
    s_add_u32 s35, s43, 0x200000
    s_add_u32 m0, s43, 0
    s_add_u32 s36, s35, 0x200000
    buffer_load_dwordx4 v4, s[8:11], s35 offen lds
    buffer_load_dwordx4 v4, s[8:11], s35 offen offset:1024 lds
    s_add_u32 m0, s43, 16384
    s_add_u32 s35, s35, 16384
    buffer_load_dwordx4 v4, s[8:11], s36 offen lds
    buffer_load_dwordx4 v4, s[8:11], s36 offen offset:1024 lds
    v_mov_b32 v128, 0
    v_mov_b32 v129, 0
    v_mov_b32 v130, 0
    v_mov_b32 v131, 0
    v_mov_b32 v132, 0
    v_mov_b32 v133, 0
    v_mov_b32 v134, 0
    v_mov_b32 v135, 0
    v_mov_b32 v136, 0
    v_mov_b32 v137, 0
    v_mov_b32 v138, 0
    v_mov_b32 v139, 0
    v_mov_b32 v140, 0
    v_mov_b32 v141, 0
    v_mov_b32 v142, 0
    v_mov_b32 v143, 0
    v_mov_b32 v20, 0
    s_mov_b32 s38, 0x40c00000
    s_waitcnt vmcnt(0)
    s_barrier
    s_cmp_ge_u32 s35, 0x220000
    s_cbranch_scc1 k2_attn_kernel_skip2
    s_add_u32 m0, s43, 32768
    s_add_u32 s36, s35, 0x200000
    buffer_load_dwordx4 v4, s[8:11], s35 offen lds
    buffer_load_dwordx4 v4, s[8:11], s35 offen offset:1024 lds
    s_add_u32 m0, s43, 49152
    s_add_u32 s35, s35, 16384
    buffer_load_dwordx4 v4, s[8:11], s36 offen lds
    buffer_load_dwordx4 v4, s[8:11], s36 offen offset:1024 lds
k2_attn_kernel_skip2:
    ds_read_b128 v[176:179], v18 offset:0
    ds_read_b128 v[180:183], v18 offset:1024
    ds_read_b128 v[184:187], v18 offset:2048
    ds_read_b128 v[188:191], v18 offset:3072
    s_waitcnt lgkmcnt(2)
    v_mfma_f32_32x32x16_bf16 v[64:79], v[176:179], v[8:11], 0
    v_mfma_f32_32x32x16_bf16 v[64:79], v[180:183], v[12:15], v[64:79]
    ds_read_b128 v[176:179], v18 offset:4096
    ds_read_b128 v[180:183], v18 offset:5120
    s_waitcnt lgkmcnt(2)
    v_mfma_f32_32x32x16_bf16 v[80:95], v[184:187], v[8:11], 0
    v_mfma_f32_32x32x16_bf16 v[80:95], v[188:191], v[12:15], v[80:95]
    ds_read_b128 v[184:187], v18 offset:6144
    ds_read_b128 v[188:191], v18 offset:7168
    s_waitcnt lgkmcnt(2)
    v_mfma_f32_32x32x16_bf16 v[96:111], v[176:179], v[8:11], 0
    v_mfma_f32_32x32x16_bf16 v[96:111], v[180:183], v[12:15], v[96:111]
    s_waitcnt lgkmcnt(0)
    v_mfma_f32_32x32x16_bf16 v[112:127], v[184:187], v[8:11], 0
    v_mfma_f32_32x32x16_bf16 v[112:127], v[188:191], v[12:15], v[112:127]
    ds_read_b128 v[192:195], v18 offset:16384
    ds_read_b128 v[196:199], v18 offset:17408
    ds_read_b128 v[200:203], v18 offset:18432
    ds_read_b128 v[204:207], v18 offset:19456
    ds_read_b128 v[208:211], v18 offset:20480
    ds_read_b128 v[212:215], v18 offset:21504
    ds_read_b128 v[216:219], v18 offset:22528
    ds_read_b128 v[220:223], v18 offset:23552
    s_nop 11
    v_max3_f32 v21, v64, v65, v66
    v_max3_f32 v21, v21, v67, v68
    v_max3_f32 v21, v21, v69, v70
    v_max3_f32 v21, v21, v71, v72
    v_max3_f32 v21, v21, v73, v74
    v_max3_f32 v21, v21, v75, v76
    v_max3_f32 v21, v21, v77, v78
    v_max3_f32 v21, v21, v79, v80
    v_max3_f32 v21, v21, v81, v82
    v_max3_f32 v21, v21, v83, v84
    v_max3_f32 v21, v21, v85, v86
    v_max3_f32 v21, v21, v87, v88
    v_max3_f32 v21, v21, v89, v90
    v_max3_f32 v21, v21, v91, v92
    v_max3_f32 v21, v21, v93, v94
    v_max3_f32 v21, v21, v95, v96
    v_max3_f32 v21, v21, v97, v98
    v_max3_f32 v21, v21, v99, v100
    v_max3_f32 v21, v21, v101, v102
    v_max3_f32 v21, v21, v103, v104
    v_max3_f32 v21, v21, v105, v106
    v_max3_f32 v21, v21, v107, v108
    v_max3_f32 v21, v21, v109, v110
    v_max3_f32 v21, v21, v111, v112
    v_max3_f32 v21, v21, v113, v114
    v_max3_f32 v21, v21, v115, v116
    v_max3_f32 v21, v21, v117, v118
    v_max3_f32 v21, v21, v119, v120
    v_max3_f32 v21, v21, v121, v122
    v_max3_f32 v21, v21, v123, v124
    v_max3_f32 v21, v21, v125, v126
    v_max_f32 v21, v21, v127
    v_mov_b32 v22, v21
    s_nop 1
    v_permlane32_swap_b32 v21, v22
    s_nop 1
    v_max_f32 v21, v21, v22
    v_add_f32 v22, v20, v21
    v_cvt_pk_bf16_f32 v23, v22, v22
    v_lshlrev_b32 v22, 16, v23
    v_sub_f32 v21, v22, v20
    v_mov_b32 v20, v22
    v_sub_f32 v64, v64, v21
    v_sub_f32 v65, v65, v21
    v_sub_f32 v66, v66, v21
    v_sub_f32 v67, v67, v21
    v_sub_f32 v68, v68, v21
    v_sub_f32 v69, v69, v21
    v_sub_f32 v70, v70, v21
    v_sub_f32 v71, v71, v21
    v_sub_f32 v72, v72, v21
    v_sub_f32 v73, v73, v21
    v_sub_f32 v74, v74, v21
    v_sub_f32 v75, v75, v21
    v_sub_f32 v76, v76, v21
    v_sub_f32 v77, v77, v21
    v_sub_f32 v78, v78, v21
    v_sub_f32 v79, v79, v21
    v_sub_f32 v80, v80, v21
    v_sub_f32 v81, v81, v21
    v_sub_f32 v82, v82, v21
    v_sub_f32 v83, v83, v21
    v_sub_f32 v84, v84, v21
    v_sub_f32 v85, v85, v21
    v_sub_f32 v86, v86, v21
    v_sub_f32 v87, v87, v21
    v_sub_f32 v88, v88, v21
    v_sub_f32 v89, v89, v21
    v_sub_f32 v90, v90, v21
    v_sub_f32 v91, v91, v21
    v_sub_f32 v92, v92, v21
    v_sub_f32 v93, v93, v21
    v_sub_f32 v94, v94, v21
    v_sub_f32 v95, v95, v21
    v_sub_f32 v96, v96, v21
    v_sub_f32 v97, v97, v21
    v_sub_f32 v98, v98, v21
    v_sub_f32 v99, v99, v21
    v_sub_f32 v100, v100, v21
    v_sub_f32 v101, v101, v21
    v_sub_f32 v102, v102, v21
    v_sub_f32 v103, v103, v21
    v_sub_f32 v104, v104, v21
    v_sub_f32 v105, v105, v21
    v_sub_f32 v106, v106, v21
    v_sub_f32 v107, v107, v21
    v_sub_f32 v108, v108, v21
    v_sub_f32 v109, v109, v21
    v_sub_f32 v110, v110, v21
    v_sub_f32 v111, v111, v21
    v_sub_f32 v112, v112, v21
    v_sub_f32 v113, v113, v21
    v_sub_f32 v114, v114, v21
    v_sub_f32 v115, v115, v21
    v_sub_f32 v116, v116, v21
    v_sub_f32 v117, v117, v21
    v_sub_f32 v118, v118, v21
    v_sub_f32 v119, v119, v21
    v_sub_f32 v120, v120, v21
    v_sub_f32 v121, v121, v21
    v_sub_f32 v122, v122, v21
    v_sub_f32 v123, v123, v21
    v_sub_f32 v124, v124, v21
    v_sub_f32 v125, v125, v21
    v_sub_f32 v126, v126, v21
    v_sub_f32 v127, v127, v21
    v_xor_b32 v23, 0x8000, v23
    v_and_b32 v23, 0xffff, v23
    v_cndmask_b32 v14, v14, v23, s[46:47]
k2_attn_kernel_fast3:
    v_exp_f32 v64, v64
    v_exp_f32 v65, v65
    v_exp_f32 v66, v66
    v_exp_f32 v67, v67
    v_exp_f32 v68, v68
    v_exp_f32 v69, v69
    v_exp_f32 v70, v70
    v_exp_f32 v71, v71
    v_exp_f32 v72, v72
    v_exp_f32 v73, v73
    v_exp_f32 v74, v74
    v_exp_f32 v75, v75
    v_exp_f32 v76, v76
    v_exp_f32 v77, v77
    v_exp_f32 v78, v78
    v_exp_f32 v79, v79
    v_exp_f32 v80, v80
    v_exp_f32 v81, v81
    v_exp_f32 v82, v82
    v_exp_f32 v83, v83
    v_exp_f32 v84, v84
    v_exp_f32 v85, v85
    v_exp_f32 v86, v86
    v_exp_f32 v87, v87
    v_exp_f32 v88, v88
    v_exp_f32 v89, v89
    v_exp_f32 v90, v90
    v_exp_f32 v91, v91
    v_exp_f32 v92, v92
    v_exp_f32 v93, v93
    v_exp_f32 v94, v94
    v_exp_f32 v95, v95
    v_exp_f32 v96, v96
    v_exp_f32 v97, v97
    v_exp_f32 v98, v98
    v_exp_f32 v99, v99
    v_exp_f32 v100, v100
    v_exp_f32 v101, v101
    v_exp_f32 v102, v102
    v_exp_f32 v103, v103
    v_exp_f32 v104, v104
    v_exp_f32 v105, v105
    v_exp_f32 v106, v106
    v_exp_f32 v107, v107
    v_exp_f32 v108, v108
    v_exp_f32 v109, v109
    v_exp_f32 v110, v110
    v_exp_f32 v111, v111
    v_exp_f32 v112, v112
    v_exp_f32 v113, v113
    v_exp_f32 v114, v114
    v_exp_f32 v115, v115
    v_exp_f32 v116, v116
    v_exp_f32 v117, v117
    v_exp_f32 v118, v118
    v_exp_f32 v119, v119
    v_exp_f32 v120, v120
    v_exp_f32 v121, v121
    v_exp_f32 v122, v122
    v_exp_f32 v123, v123
    v_exp_f32 v124, v124
    v_exp_f32 v125, v125
    v_exp_f32 v126, v126
    v_exp_f32 v127, v127
    s_nop 0
    v_cvt_pk_bf16_f32 v144, v64, v65
    v_cvt_pk_bf16_f32 v145, v66, v67
    v_cvt_pk_bf16_f32 v146, v68, v69
    v_cvt_pk_bf16_f32 v147, v70, v71
    v_cvt_pk_bf16_f32 v148, v72, v73
    v_cvt_pk_bf16_f32 v149, v74, v75
    v_cvt_pk_bf16_f32 v150, v76, v77
    v_cvt_pk_bf16_f32 v151, v78, v79
    v_cvt_pk_bf16_f32 v152, v80, v81
    v_cvt_pk_bf16_f32 v153, v82, v83
    v_cvt_pk_bf16_f32 v154, v84, v85
    v_cvt_pk_bf16_f32 v155, v86, v87
    v_cvt_pk_bf16_f32 v156, v88, v89
    v_cvt_pk_bf16_f32 v157, v90, v91
    v_cvt_pk_bf16_f32 v158, v92, v93
    v_cvt_pk_bf16_f32 v159, v94, v95
    v_cvt_pk_bf16_f32 v160, v96, v97
    v_cvt_pk_bf16_f32 v161, v98, v99
    v_cvt_pk_bf16_f32 v162, v100, v101
    v_cvt_pk_bf16_f32 v163, v102, v103
    v_cvt_pk_bf16_f32 v164, v104, v105
    v_cvt_pk_bf16_f32 v165, v106, v107
    v_cvt_pk_bf16_f32 v166, v108, v109
    v_cvt_pk_bf16_f32 v167, v110, v111
    v_cvt_pk_bf16_f32 v168, v112, v113
    v_cvt_pk_bf16_f32 v169, v114, v115
    v_cvt_pk_bf16_f32 v170, v116, v117
    v_cvt_pk_bf16_f32 v171, v118, v119
    v_cvt_pk_bf16_f32 v172, v120, v121
    v_cvt_pk_bf16_f32 v173, v122, v123
    v_cvt_pk_bf16_f32 v174, v124, v125
    v_cvt_pk_bf16_f32 v175, v126, v127
    s_waitcnt lgkmcnt(0)
    s_nop 1
    v_mfma_f32_32x32x16_bf16 v[128:143], v[192:195], v[144:147], v[128:143]
    v_mfma_f32_32x32x16_bf16 v[128:143], v[196:199], v[148:151], v[128:143]
    v_mfma_f32_32x32x16_bf16 v[128:143], v[200:203], v[152:155], v[128:143]
    v_mfma_f32_32x32x16_bf16 v[128:143], v[204:207], v[156:159], v[128:143]
    v_mfma_f32_32x32x16_bf16 v[128:143], v[208:211], v[160:163], v[128:143]
    v_mfma_f32_32x32x16_bf16 v[128:143], v[212:215], v[164:167], v[128:143]
    v_mfma_f32_32x32x16_bf16 v[128:143], v[216:219], v[168:171], v[128:143]
    v_mfma_f32_32x32x16_bf16 v[128:143], v[220:223], v[172:175], v[128:143]
    s_waitcnt vmcnt(0)
    s_barrier
    s_cmp_ge_u32 s35, 0x220000
    s_cbranch_scc1 k2_attn_kernel_skip4
    s_add_u32 m0, s43, 0
    s_add_u32 s36, s35, 0x200000
    buffer_load_dwordx4 v4, s[8:11], s35 offen lds
    buffer_load_dwordx4 v4, s[8:11], s35 offen offset:1024 lds
    s_add_u32 m0, s43, 16384
    s_add_u32 s35, s35, 16384
    buffer_load_dwordx4 v4, s[8:11], s36 offen lds
    buffer_load_dwordx4 v4, s[8:11], s36 offen offset:1024 lds
k2_attn_kernel_skip4:
    ds_read_b128 v[176:179], v18 offset:32768
    ds_read_b128 v[180:183], v18 offset:33792
    ds_read_b128 v[184:187], v18 offset:34816
    ds_read_b128 v[188:191], v18 offset:35840
    s_waitcnt lgkmcnt(2)
    v_mfma_f32_32x32x16_bf16 v[64:79], v[176:179], v[8:11], 0
    v_mfma_f32_32x32x16_bf16 v[64:79], v[180:183], v[12:15], v[64:79]
    ds_read_b128 v[176:179], v18 offset:36864
    ds_read_b128 v[180:183], v18 offset:37888
    s_waitcnt lgkmcnt(2)
    v_mfma_f32_32x32x16_bf16 v[80:95], v[184:187], v[8:11], 0
    v_mfma_f32_32x32x16_bf16 v[80:95], v[188:191], v[12:15], v[80:95]
    ds_read_b128 v[184:187], v18 offset:38912
    ds_read_b128 v[188:191], v18 offset:39936
    s_waitcnt lgkmcnt(2)
    v_mfma_f32_32x32x16_bf16 v[96:111], v[176:179], v[8:11], 0
    v_mfma_f32_32x32x16_bf16 v[96:111], v[180:183], v[12:15], v[96:111]
    s_waitcnt lgkmcnt(0)
    v_mfma_f32_32x32x16_bf16 v[112:127], v[184:187], v[8:11], 0
    v_mfma_f32_32x32x16_bf16 v[112:127], v[188:191], v[12:15], v[112:127]
    ds_read_b128 v[192:195], v18 offset:49152
    ds_read_b128 v[196:199], v18 offset:50176
    ds_read_b128 v[200:203], v18 offset:51200
    ds_read_b128 v[204:207], v18 offset:52224
    ds_read_b128 v[208:211], v18 offset:53248
    ds_read_b128 v[212:215], v18 offset:54272
    ds_read_b128 v[216:219], v18 offset:55296
    ds_read_b128 v[220:223], v18 offset:56320
    s_nop 11
    v_max3_f32 v21, v64, v65, v66
    v_max3_f32 v21, v21, v67, v68
    v_max3_f32 v21, v21, v69, v70
    v_max3_f32 v21, v21, v71, v72
    v_max3_f32 v21, v21, v73, v74
    v_max3_f32 v21, v21, v75, v76
    v_max3_f32 v21, v21, v77, v78
    v_max3_f32 v21, v21, v79, v80
    v_max3_f32 v21, v21, v81, v82
    v_max3_f32 v21, v21, v83, v84
    v_max3_f32 v21, v21, v85, v86
    v_max3_f32 v21, v21, v87, v88
    v_max3_f32 v21, v21, v89, v90
    v_max3_f32 v21, v21, v91, v92
    v_max3_f32 v21, v21, v93, v94
    v_max3_f32 v21, v21, v95, v96
    v_max3_f32 v21, v21, v97, v98
    v_max3_f32 v21, v21, v99, v100
    v_max3_f32 v21, v21, v101, v102
    v_max3_f32 v21, v21, v103, v104
    v_max3_f32 v21, v21, v105, v106
    v_max3_f32 v21, v21, v107, v108
    v_max3_f32 v21, v21, v109, v110
    v_max3_f32 v21, v21, v111, v112
    v_max3_f32 v21, v21, v113, v114
    v_max3_f32 v21, v21, v115, v116
    v_max3_f32 v21, v21, v117, v118
    v_max3_f32 v21, v21, v119, v120
    v_max3_f32 v21, v21, v121, v122
    v_max3_f32 v21, v21, v123, v124
    v_max3_f32 v21, v21, v125, v126
    v_max_f32 v21, v21, v127
    v_cmp_lt_f32 vcc, s38, v21
    s_cbranch_vccz k2_attn_kernel_fast5
    v_mov_b32 v22, v21
    s_nop 1
    v_permlane32_swap_b32 v21, v22
    s_nop 1
    v_max_f32 v21, v21, v22
    v_max_f32 v21, 0, v21
    v_add_f32 v22, v20, v21
    v_cvt_pk_bf16_f32 v23, v22, v22
    v_lshlrev_b32 v22, 16, v23
    v_sub_f32 v21, v22, v20
    v_mov_b32 v20, v22
    v_sub_f32 v64, v64, v21
    v_sub_f32 v65, v65, v21
    v_sub_f32 v66, v66, v21
    v_sub_f32 v67, v67, v21
    v_sub_f32 v68, v68, v21
    v_sub_f32 v69, v69, v21
    v_sub_f32 v70, v70, v21
    v_sub_f32 v71, v71, v21
    v_sub_f32 v72, v72, v21
    v_sub_f32 v73, v73, v21
    v_sub_f32 v74, v74, v21
    v_sub_f32 v75, v75, v21
    v_sub_f32 v76, v76, v21
    v_sub_f32 v77, v77, v21
    v_sub_f32 v78, v78, v21
    v_sub_f32 v79, v79, v21
    v_sub_f32 v80, v80, v21
    v_sub_f32 v81, v81, v21
    v_sub_f32 v82, v82, v21
    v_sub_f32 v83, v83, v21
    v_sub_f32 v84, v84, v21
    v_sub_f32 v85, v85, v21
    v_sub_f32 v86, v86, v21
    v_sub_f32 v87, v87, v21
    v_sub_f32 v88, v88, v21
    v_sub_f32 v89, v89, v21
    v_sub_f32 v90, v90, v21
    v_sub_f32 v91, v91, v21
    v_sub_f32 v92, v92, v21
    v_sub_f32 v93, v93, v21
    v_sub_f32 v94, v94, v21
    v_sub_f32 v95, v95, v21
    v_sub_f32 v96, v96, v21
    v_sub_f32 v97, v97, v21
    v_sub_f32 v98, v98, v21
    v_sub_f32 v99, v99, v21
    v_sub_f32 v100, v100, v21
    v_sub_f32 v101, v101, v21
    v_sub_f32 v102, v102, v21
    v_sub_f32 v103, v103, v21
    v_sub_f32 v104, v104, v21
    v_sub_f32 v105, v105, v21
    v_sub_f32 v106, v106, v21
    v_sub_f32 v107, v107, v21
    v_sub_f32 v108, v108, v21
    v_sub_f32 v109, v109, v21
    v_sub_f32 v110, v110, v21
    v_sub_f32 v111, v111, v21
    v_sub_f32 v112, v112, v21
    v_sub_f32 v113, v113, v21
    v_sub_f32 v114, v114, v21
    v_sub_f32 v115, v115, v21
    v_sub_f32 v116, v116, v21
    v_sub_f32 v117, v117, v21
    v_sub_f32 v118, v118, v21
    v_sub_f32 v119, v119, v21
    v_sub_f32 v120, v120, v21
    v_sub_f32 v121, v121, v21
    v_sub_f32 v122, v122, v21
    v_sub_f32 v123, v123, v21
    v_sub_f32 v124, v124, v21
    v_sub_f32 v125, v125, v21
    v_sub_f32 v126, v126, v21
    v_sub_f32 v127, v127, v21
    v_exp_f32 v24, -v21
    s_nop 0
    v_mul_f32 v128, v128, v24
    v_mul_f32 v129, v129, v24
    v_mul_f32 v130, v130, v24
    v_mul_f32 v131, v131, v24
    v_mul_f32 v132, v132, v24
    v_mul_f32 v133, v133, v24
    v_mul_f32 v134, v134, v24
    v_mul_f32 v135, v135, v24
    v_mul_f32 v136, v136, v24
    v_mul_f32 v137, v137, v24
    v_mul_f32 v138, v138, v24
    v_mul_f32 v139, v139, v24
    v_mul_f32 v140, v140, v24
    v_mul_f32 v141, v141, v24
    v_mul_f32 v142, v142, v24
    v_mul_f32 v143, v143, v24
    v_xor_b32 v23, 0x8000, v23
    v_and_b32 v23, 0xffff, v23
    v_cndmask_b32 v14, v14, v23, s[46:47]
k2_attn_kernel_fast5:
    v_exp_f32 v64, v64
    v_exp_f32 v65, v65
    v_exp_f32 v66, v66
    v_exp_f32 v67, v67
    v_exp_f32 v68, v68
    v_exp_f32 v69, v69
    v_exp_f32 v70, v70
    v_exp_f32 v71, v71
    v_exp_f32 v72, v72
    v_exp_f32 v73, v73
    v_exp_f32 v74, v74
    v_exp_f32 v75, v75
    v_exp_f32 v76, v76
    v_exp_f32 v77, v77
    v_exp_f32 v78, v78
    v_exp_f32 v79, v79
    v_exp_f32 v80, v80
    v_exp_f32 v81, v81
    v_exp_f32 v82, v82
    v_exp_f32 v83, v83
    v_exp_f32 v84, v84
    v_exp_f32 v85, v85
    v_exp_f32 v86, v86
    v_exp_f32 v87, v87
    v_exp_f32 v88, v88
    v_exp_f32 v89, v89
    v_exp_f32 v90, v90
    v_exp_f32 v91, v91
    v_exp_f32 v92, v92
    v_exp_f32 v93, v93
    v_exp_f32 v94, v94
    v_exp_f32 v95, v95
    v_exp_f32 v96, v96
    v_exp_f32 v97, v97
    v_exp_f32 v98, v98
    v_exp_f32 v99, v99
    v_exp_f32 v100, v100
    v_exp_f32 v101, v101
    v_exp_f32 v102, v102
    v_exp_f32 v103, v103
    v_exp_f32 v104, v104
    v_exp_f32 v105, v105
    v_exp_f32 v106, v106
    v_exp_f32 v107, v107
    v_exp_f32 v108, v108
    v_exp_f32 v109, v109
    v_exp_f32 v110, v110
    v_exp_f32 v111, v111
    v_exp_f32 v112, v112
    v_exp_f32 v113, v113
    v_exp_f32 v114, v114
    v_exp_f32 v115, v115
    v_exp_f32 v116, v116
    v_exp_f32 v117, v117
    v_exp_f32 v118, v118
    v_exp_f32 v119, v119
    v_exp_f32 v120, v120
    v_exp_f32 v121, v121
    v_exp_f32 v122, v122
    v_exp_f32 v123, v123
    v_exp_f32 v124, v124
    v_exp_f32 v125, v125
    v_exp_f32 v126, v126
    v_exp_f32 v127, v127
    s_nop 0
    v_cvt_pk_bf16_f32 v144, v64, v65
    v_cvt_pk_bf16_f32 v145, v66, v67
    v_cvt_pk_bf16_f32 v146, v68, v69
    v_cvt_pk_bf16_f32 v147, v70, v71
    v_cvt_pk_bf16_f32 v148, v72, v73
    v_cvt_pk_bf16_f32 v149, v74, v75
    v_cvt_pk_bf16_f32 v150, v76, v77
    v_cvt_pk_bf16_f32 v151, v78, v79
    v_cvt_pk_bf16_f32 v152, v80, v81
    v_cvt_pk_bf16_f32 v153, v82, v83
    v_cvt_pk_bf16_f32 v154, v84, v85
    v_cvt_pk_bf16_f32 v155, v86, v87
    v_cvt_pk_bf16_f32 v156, v88, v89
    v_cvt_pk_bf16_f32 v157, v90, v91
    v_cvt_pk_bf16_f32 v158, v92, v93
    v_cvt_pk_bf16_f32 v159, v94, v95
    v_cvt_pk_bf16_f32 v160, v96, v97
    v_cvt_pk_bf16_f32 v161, v98, v99
    v_cvt_pk_bf16_f32 v162, v100, v101
    v_cvt_pk_bf16_f32 v163, v102, v103
    v_cvt_pk_bf16_f32 v164, v104, v105
    v_cvt_pk_bf16_f32 v165, v106, v107
    v_cvt_pk_bf16_f32 v166, v108, v109
    v_cvt_pk_bf16_f32 v167, v110, v111
    v_cvt_pk_bf16_f32 v168, v112, v113
    v_cvt_pk_bf16_f32 v169, v114, v115
    v_cvt_pk_bf16_f32 v170, v116, v117
    v_cvt_pk_bf16_f32 v171, v118, v119
    v_cvt_pk_bf16_f32 v172, v120, v121
    v_cvt_pk_bf16_f32 v173, v122, v123
    v_cvt_pk_bf16_f32 v174, v124, v125
    v_cvt_pk_bf16_f32 v175, v126, v127
    s_waitcnt lgkmcnt(0)
    s_nop 1
    v_mfma_f32_32x32x16_bf16 v[128:143], v[192:195], v[144:147], v[128:143]
    v_mfma_f32_32x32x16_bf16 v[128:143], v[196:199], v[148:151], v[128:143]
    v_mfma_f32_32x32x16_bf16 v[128:143], v[200:203], v[152:155], v[128:143]
    v_mfma_f32_32x32x16_bf16 v[128:143], v[204:207], v[156:159], v[128:143]
    v_mfma_f32_32x32x16_bf16 v[128:143], v[208:211], v[160:163], v[128:143]
    v_mfma_f32_32x32x16_bf16 v[128:143], v[212:215], v[164:167], v[128:143]
    v_mfma_f32_32x32x16_bf16 v[128:143], v[216:219], v[168:171], v[128:143]
    v_mfma_f32_32x32x16_bf16 v[128:143], v[220:223], v[172:175], v[128:143]
    s_mov_b32 s39, 0
k2_attn_kernel_loop6:
    s_waitcnt vmcnt(0)
    s_barrier
    s_cmp_ge_u32 s35, 0x220000
    s_cbranch_scc1 k2_attn_kernel_skip7
    s_add_u32 m0, s43, 32768
    s_add_u32 s36, s35, 0x200000
    buffer_load_dwordx4 v4, s[8:11], s35 offen lds
    buffer_load_dwordx4 v4, s[8:11], s35 offen offset:1024 lds
    s_add_u32 m0, s43, 49152
    s_add_u32 s35, s35, 16384
    buffer_load_dwordx4 v4, s[8:11], s36 offen lds
    buffer_load_dwordx4 v4, s[8:11], s36 offen offset:1024 lds
k2_attn_kernel_skip7:
    ds_read_b128 v[176:179], v18 offset:0
    ds_read_b128 v[180:183], v18 offset:1024
    ds_read_b128 v[184:187], v18 offset:2048
    ds_read_b128 v[188:191], v18 offset:3072
    s_waitcnt lgkmcnt(2)
    v_mfma_f32_32x32x16_bf16 v[64:79], v[176:179], v[8:11], 0
    v_mfma_f32_32x32x16_bf16 v[64:79], v[180:183], v[12:15], v[64:79]
    ds_read_b128 v[176:179], v18 offset:4096
    ds_read_b128 v[180:183], v18 offset:5120
    s_waitcnt lgkmcnt(2)
    v_mfma_f32_32x32x16_bf16 v[80:95], v[184:187], v[8:11], 0
    v_mfma_f32_32x32x16_bf16 v[80:95], v[188:191], v[12:15], v[80:95]
    ds_read_b128 v[184:187], v18 offset:6144
    ds_read_b128 v[188:191], v18 offset:7168
    s_waitcnt lgkmcnt(2)
    v_mfma_f32_32x32x16_bf16 v[96:111], v[176:179], v[8:11], 0
    v_mfma_f32_32x32x16_bf16 v[96:111], v[180:183], v[12:15], v[96:111]
    s_waitcnt lgkmcnt(0)
    v_mfma_f32_32x32x16_bf16 v[112:127], v[184:187], v[8:11], 0
    v_mfma_f32_32x32x16_bf16 v[112:127], v[188:191], v[12:15], v[112:127]
    ds_read_b128 v[192:195], v18 offset:16384
    ds_read_b128 v[196:199], v18 offset:17408
    ds_read_b128 v[200:203], v18 offset:18432
    ds_read_b128 v[204:207], v18 offset:19456
    ds_read_b128 v[208:211], v18 offset:20480
    ds_read_b128 v[212:215], v18 offset:21504
    ds_read_b128 v[216:219], v18 offset:22528
    ds_read_b128 v[220:223], v18 offset:23552
    s_nop 11
    v_max3_f32 v21, v64, v65, v66
    v_max3_f32 v21, v21, v67, v68
    v_max3_f32 v21, v21, v69, v70
    v_max3_f32 v21, v21, v71, v72
    v_max3_f32 v21, v21, v73, v74
    v_max3_f32 v21, v21, v75, v76
    v_max3_f32 v21, v21, v77, v78
    v_max3_f32 v21, v21, v79, v80
    v_max3_f32 v21, v21, v81, v82
    v_max3_f32 v21, v21, v83, v84
    v_max3_f32 v21, v21, v85, v86
    v_max3_f32 v21, v21, v87, v88
    v_max3_f32 v21, v21, v89, v90
    v_max3_f32 v21, v21, v91, v92
    v_max3_f32 v21, v21, v93, v94
    v_max3_f32 v21, v21, v95, v96
    v_max3_f32 v21, v21, v97, v98
    v_max3_f32 v21, v21, v99, v100
    v_max3_f32 v21, v21, v101, v102
    v_max3_f32 v21, v21, v103, v104
    v_max3_f32 v21, v21, v105, v106
    v_max3_f32 v21, v21, v107, v108
    v_max3_f32 v21, v21, v109, v110
    v_max3_f32 v21, v21, v111, v112
    v_max3_f32 v21, v21, v113, v114
    v_max3_f32 v21, v21, v115, v116
    v_max3_f32 v21, v21, v117, v118
    v_max3_f32 v21, v21, v119, v120
    v_max3_f32 v21, v21, v121, v122
    v_max3_f32 v21, v21, v123, v124
    v_max3_f32 v21, v21, v125, v126
    v_max_f32 v21, v21, v127
    v_cmp_lt_f32 vcc, s38, v21
    s_cbranch_vccz k2_attn_kernel_fast8
    v_mov_b32 v22, v21
    s_nop 1
    v_permlane32_swap_b32 v21, v22
    s_nop 1
    v_max_f32 v21, v21, v22
    v_max_f32 v21, 0, v21
    v_add_f32 v22, v20, v21
    v_cvt_pk_bf16_f32 v23, v22, v22
    v_lshlrev_b32 v22, 16, v23
    v_sub_f32 v21, v22, v20
    v_mov_b32 v20, v22
    v_sub_f32 v64, v64, v21
    v_sub_f32 v65, v65, v21
    v_sub_f32 v66, v66, v21
    v_sub_f32 v67, v67, v21
    v_sub_f32 v68, v68, v21
    v_sub_f32 v69, v69, v21
    v_sub_f32 v70, v70, v21
    v_sub_f32 v71, v71, v21
    v_sub_f32 v72, v72, v21
    v_sub_f32 v73, v73, v21
    v_sub_f32 v74, v74, v21
    v_sub_f32 v75, v75, v21
    v_sub_f32 v76, v76, v21
    v_sub_f32 v77, v77, v21
    v_sub_f32 v78, v78, v21
    v_sub_f32 v79, v79, v21
    v_sub_f32 v80, v80, v21
    v_sub_f32 v81, v81, v21
    v_sub_f32 v82, v82, v21
    v_sub_f32 v83, v83, v21
    v_sub_f32 v84, v84, v21
    v_sub_f32 v85, v85, v21
    v_sub_f32 v86, v86, v21
    v_sub_f32 v87, v87, v21
    v_sub_f32 v88, v88, v21
    v_sub_f32 v89, v89, v21
    v_sub_f32 v90, v90, v21
    v_sub_f32 v91, v91, v21
    v_sub_f32 v92, v92, v21
    v_sub_f32 v93, v93, v21
    v_sub_f32 v94, v94, v21
    v_sub_f32 v95, v95, v21
    v_sub_f32 v96, v96, v21
    v_sub_f32 v97, v97, v21
    v_sub_f32 v98, v98, v21
    v_sub_f32 v99, v99, v21
    v_sub_f32 v100, v100, v21
    v_sub_f32 v101, v101, v21
    v_sub_f32 v102, v102, v21
    v_sub_f32 v103, v103, v21
    v_sub_f32 v104, v104, v21
    v_sub_f32 v105, v105, v21
    v_sub_f32 v106, v106, v21
    v_sub_f32 v107, v107, v21
    v_sub_f32 v108, v108, v21
    v_sub_f32 v109, v109, v21
    v_sub_f32 v110, v110, v21
    v_sub_f32 v111, v111, v21
    v_sub_f32 v112, v112, v21
    v_sub_f32 v113, v113, v21
    v_sub_f32 v114, v114, v21
    v_sub_f32 v115, v115, v21
    v_sub_f32 v116, v116, v21
    v_sub_f32 v117, v117, v21
    v_sub_f32 v118, v118, v21
    v_sub_f32 v119, v119, v21
    v_sub_f32 v120, v120, v21
    v_sub_f32 v121, v121, v21
    v_sub_f32 v122, v122, v21
    v_sub_f32 v123, v123, v21
    v_sub_f32 v124, v124, v21
    v_sub_f32 v125, v125, v21
    v_sub_f32 v126, v126, v21
    v_sub_f32 v127, v127, v21
    v_exp_f32 v24, -v21
    s_nop 0
    v_mul_f32 v128, v128, v24
    v_mul_f32 v129, v129, v24
    v_mul_f32 v130, v130, v24
    v_mul_f32 v131, v131, v24
    v_mul_f32 v132, v132, v24
    v_mul_f32 v133, v133, v24
    v_mul_f32 v134, v134, v24
    v_mul_f32 v135, v135, v24
    v_mul_f32 v136, v136, v24
    v_mul_f32 v137, v137, v24
    v_mul_f32 v138, v138, v24
    v_mul_f32 v139, v139, v24
    v_mul_f32 v140, v140, v24
    v_mul_f32 v141, v141, v24
    v_mul_f32 v142, v142, v24
    v_mul_f32 v143, v143, v24
    v_xor_b32 v23, 0x8000, v23
    v_and_b32 v23, 0xffff, v23
    v_cndmask_b32 v14, v14, v23, s[46:47]
k2_attn_kernel_fast8:
    v_exp_f32 v64, v64
    v_exp_f32 v65, v65
    v_exp_f32 v66, v66
    v_exp_f32 v67, v67
    v_exp_f32 v68, v68
    v_exp_f32 v69, v69
    v_exp_f32 v70, v70
    v_exp_f32 v71, v71
    v_exp_f32 v72, v72
    v_exp_f32 v73, v73
    v_exp_f32 v74, v74
    v_exp_f32 v75, v75
    v_exp_f32 v76, v76
    v_exp_f32 v77, v77
    v_exp_f32 v78, v78
    v_exp_f32 v79, v79
    v_exp_f32 v80, v80
    v_exp_f32 v81, v81
    v_exp_f32 v82, v82
    v_exp_f32 v83, v83
    v_exp_f32 v84, v84
    v_exp_f32 v85, v85
    v_exp_f32 v86, v86
    v_exp_f32 v87, v87
    v_exp_f32 v88, v88
    v_exp_f32 v89, v89
    v_exp_f32 v90, v90
    v_exp_f32 v91, v91
    v_exp_f32 v92, v92
    v_exp_f32 v93, v93
    v_exp_f32 v94, v94
    v_exp_f32 v95, v95
    v_exp_f32 v96, v96
    v_exp_f32 v97, v97
    v_exp_f32 v98, v98
    v_exp_f32 v99, v99
    v_exp_f32 v100, v100
    v_exp_f32 v101, v101
    v_exp_f32 v102, v102
    v_exp_f32 v103, v103
    v_exp_f32 v104, v104
    v_exp_f32 v105, v105
    v_exp_f32 v106, v106
    v_exp_f32 v107, v107
    v_exp_f32 v108, v108
    v_exp_f32 v109, v109
    v_exp_f32 v110, v110
    v_exp_f32 v111, v111
    v_exp_f32 v112, v112
    v_exp_f32 v113, v113
    v_exp_f32 v114, v114
    v_exp_f32 v115, v115
    v_exp_f32 v116, v116
    v_exp_f32 v117, v117
    v_exp_f32 v118, v118
    v_exp_f32 v119, v119
    v_exp_f32 v120, v120
    v_exp_f32 v121, v121
    v_exp_f32 v122, v122
    v_exp_f32 v123, v123
    v_exp_f32 v124, v124
    v_exp_f32 v125, v125
    v_exp_f32 v126, v126
    v_exp_f32 v127, v127
    s_nop 0
    v_cvt_pk_bf16_f32 v144, v64, v65
    v_cvt_pk_bf16_f32 v145, v66, v67
    v_cvt_pk_bf16_f32 v146, v68, v69
    v_cvt_pk_bf16_f32 v147, v70, v71
    v_cvt_pk_bf16_f32 v148, v72, v73
    v_cvt_pk_bf16_f32 v149, v74, v75
    v_cvt_pk_bf16_f32 v150, v76, v77
    v_cvt_pk_bf16_f32 v151, v78, v79
    v_cvt_pk_bf16_f32 v152, v80, v81
    v_cvt_pk_bf16_f32 v153, v82, v83
    v_cvt_pk_bf16_f32 v154, v84, v85
    v_cvt_pk_bf16_f32 v155, v86, v87
    v_cvt_pk_bf16_f32 v156, v88, v89
    v_cvt_pk_bf16_f32 v157, v90, v91
    v_cvt_pk_bf16_f32 v158, v92, v93
    v_cvt_pk_bf16_f32 v159, v94, v95
    v_cvt_pk_bf16_f32 v160, v96, v97
    v_cvt_pk_bf16_f32 v161, v98, v99
    v_cvt_pk_bf16_f32 v162, v100, v101
    v_cvt_pk_bf16_f32 v163, v102, v103
    v_cvt_pk_bf16_f32 v164, v104, v105
    v_cvt_pk_bf16_f32 v165, v106, v107
    v_cvt_pk_bf16_f32 v166, v108, v109
    v_cvt_pk_bf16_f32 v167, v110, v111
    v_cvt_pk_bf16_f32 v168, v112, v113
    v_cvt_pk_bf16_f32 v169, v114, v115
    v_cvt_pk_bf16_f32 v170, v116, v117
    v_cvt_pk_bf16_f32 v171, v118, v119
    v_cvt_pk_bf16_f32 v172, v120, v121
    v_cvt_pk_bf16_f32 v173, v122, v123
    v_cvt_pk_bf16_f32 v174, v124, v125
    v_cvt_pk_bf16_f32 v175, v126, v127
    s_waitcnt lgkmcnt(0)
    s_nop 1
    v_mfma_f32_32x32x16_bf16 v[128:143], v[192:195], v[144:147], v[128:143]
    v_mfma_f32_32x32x16_bf16 v[128:143], v[196:199], v[148:151], v[128:143]
    v_mfma_f32_32x32x16_bf16 v[128:143], v[200:203], v[152:155], v[128:143]
    v_mfma_f32_32x32x16_bf16 v[128:143], v[204:207], v[156:159], v[128:143]
    v_mfma_f32_32x32x16_bf16 v[128:143], v[208:211], v[160:163], v[128:143]
    v_mfma_f32_32x32x16_bf16 v[128:143], v[212:215], v[164:167], v[128:143]
    v_mfma_f32_32x32x16_bf16 v[128:143], v[216:219], v[168:171], v[128:143]
    v_mfma_f32_32x32x16_bf16 v[128:143], v[220:223], v[172:175], v[128:143]
    s_waitcnt vmcnt(0)
    s_barrier
    s_cmp_ge_u32 s35, 0x220000
    s_cbranch_scc1 k2_attn_kernel_skip9
    s_add_u32 m0, s43, 0
    s_add_u32 s36, s35, 0x200000
    buffer_load_dwordx4 v4, s[8:11], s35 offen lds
    buffer_load_dwordx4 v4, s[8:11], s35 offen offset:1024 lds
    s_add_u32 m0, s43, 16384
    s_add_u32 s35, s35, 16384
    buffer_load_dwordx4 v4, s[8:11], s36 offen lds
    buffer_load_dwordx4 v4, s[8:11], s36 offen offset:1024 lds
k2_attn_kernel_skip9:
    ds_read_b128 v[176:179], v18 offset:32768
    ds_read_b128 v[180:183], v18 offset:33792
    ds_read_b128 v[184:187], v18 offset:34816
    ds_read_b128 v[188:191], v18 offset:35840
    s_waitcnt lgkmcnt(2)
    v_mfma_f32_32x32x16_bf16 v[64:79], v[176:179], v[8:11], 0
    v_mfma_f32_32x32x16_bf16 v[64:79], v[180:183], v[12:15], v[64:79]
    ds_read_b128 v[176:179], v18 offset:36864
    ds_read_b128 v[180:183], v18 offset:37888
    s_waitcnt lgkmcnt(2)
    v_mfma_f32_32x32x16_bf16 v[80:95], v[184:187], v[8:11], 0
    v_mfma_f32_32x32x16_bf16 v[80:95], v[188:191], v[12:15], v[80:95]
    ds_read_b128 v[184:187], v18 offset:38912
    ds_read_b128 v[188:191], v18 offset:39936
    s_waitcnt lgkmcnt(2)
    v_mfma_f32_32x32x16_bf16 v[96:111], v[176:179], v[8:11], 0
    v_mfma_f32_32x32x16_bf16 v[96:111], v[180:183], v[12:15], v[96:111]
    s_waitcnt lgkmcnt(0)
    v_mfma_f32_32x32x16_bf16 v[112:127], v[184:187], v[8:11], 0
    v_mfma_f32_32x32x16_bf16 v[112:127], v[188:191], v[12:15], v[112:127]
    ds_read_b128 v[192:195], v18 offset:49152
    ds_read_b128 v[196:199], v18 offset:50176
    ds_read_b128 v[200:203], v18 offset:51200
    ds_read_b128 v[204:207], v18 offset:52224
    ds_read_b128 v[208:211], v18 offset:53248
    ds_read_b128 v[212:215], v18 offset:54272
    ds_read_b128 v[216:219], v18 offset:55296
    ds_read_b128 v[220:223], v18 offset:56320
    s_nop 11
    v_max3_f32 v21, v64, v65, v66
    v_max3_f32 v21, v21, v67, v68
    v_max3_f32 v21, v21, v69, v70
    v_max3_f32 v21, v21, v71, v72
    v_max3_f32 v21, v21, v73, v74
    v_max3_f32 v21, v21, v75, v76
    v_max3_f32 v21, v21, v77, v78
    v_max3_f32 v21, v21, v79, v80
    v_max3_f32 v21, v21, v81, v82
    v_max3_f32 v21, v21, v83, v84
    v_max3_f32 v21, v21, v85, v86
    v_max3_f32 v21, v21, v87, v88
    v_max3_f32 v21, v21, v89, v90
    v_max3_f32 v21, v21, v91, v92
    v_max3_f32 v21, v21, v93, v94
    v_max3_f32 v21, v21, v95, v96
    v_max3_f32 v21, v21, v97, v98
    v_max3_f32 v21, v21, v99, v100
    v_max3_f32 v21, v21, v101, v102
    v_max3_f32 v21, v21, v103, v104
    v_max3_f32 v21, v21, v105, v106
    v_max3_f32 v21, v21, v107, v108
    v_max3_f32 v21, v21, v109, v110
    v_max3_f32 v21, v21, v111, v112
    v_max3_f32 v21, v21, v113, v114
    v_max3_f32 v21, v21, v115, v116
    v_max3_f32 v21, v21, v117, v118
    v_max3_f32 v21, v21, v119, v120
    v_max3_f32 v21, v21, v121, v122
    v_max3_f32 v21, v21, v123, v124
    v_max3_f32 v21, v21, v125, v126
    v_max_f32 v21, v21, v127
    v_cmp_lt_f32 vcc, s38, v21
    s_cbranch_vccz k2_attn_kernel_fast10
    v_mov_b32 v22, v21
    s_nop 1
    v_permlane32_swap_b32 v21, v22
    s_nop 1
    v_max_f32 v21, v21, v22
    v_max_f32 v21, 0, v21
    v_add_f32 v22, v20, v21
    v_cvt_pk_bf16_f32 v23, v22, v22
    v_lshlrev_b32 v22, 16, v23
    v_sub_f32 v21, v22, v20
    v_mov_b32 v20, v22
    v_sub_f32 v64, v64, v21
    v_sub_f32 v65, v65, v21
    v_sub_f32 v66, v66, v21
    v_sub_f32 v67, v67, v21
    v_sub_f32 v68, v68, v21
    v_sub_f32 v69, v69, v21
    v_sub_f32 v70, v70, v21
    v_sub_f32 v71, v71, v21
    v_sub_f32 v72, v72, v21
    v_sub_f32 v73, v73, v21
    v_sub_f32 v74, v74, v21
    v_sub_f32 v75, v75, v21
    v_sub_f32 v76, v76, v21
    v_sub_f32 v77, v77, v21
    v_sub_f32 v78, v78, v21
    v_sub_f32 v79, v79, v21
    v_sub_f32 v80, v80, v21
    v_sub_f32 v81, v81, v21
    v_sub_f32 v82, v82, v21
    v_sub_f32 v83, v83, v21
    v_sub_f32 v84, v84, v21
    v_sub_f32 v85, v85, v21
    v_sub_f32 v86, v86, v21
    v_sub_f32 v87, v87, v21
    v_sub_f32 v88, v88, v21
    v_sub_f32 v89, v89, v21
    v_sub_f32 v90, v90, v21
    v_sub_f32 v91, v91, v21
    v_sub_f32 v92, v92, v21
    v_sub_f32 v93, v93, v21
    v_sub_f32 v94, v94, v21
    v_sub_f32 v95, v95, v21
    v_sub_f32 v96, v96, v21
    v_sub_f32 v97, v97, v21
    v_sub_f32 v98, v98, v21
    v_sub_f32 v99, v99, v21
    v_sub_f32 v100, v100, v21
    v_sub_f32 v101, v101, v21
    v_sub_f32 v102, v102, v21
    v_sub_f32 v103, v103, v21
    v_sub_f32 v104, v104, v21
    v_sub_f32 v105, v105, v21
    v_sub_f32 v106, v106, v21
    v_sub_f32 v107, v107, v21
    v_sub_f32 v108, v108, v21
    v_sub_f32 v109, v109, v21
    v_sub_f32 v110, v110, v21
    v_sub_f32 v111, v111, v21
    v_sub_f32 v112, v112, v21
    v_sub_f32 v113, v113, v21
    v_sub_f32 v114, v114, v21
    v_sub_f32 v115, v115, v21
    v_sub_f32 v116, v116, v21
    v_sub_f32 v117, v117, v21
    v_sub_f32 v118, v118, v21
    v_sub_f32 v119, v119, v21
    v_sub_f32 v120, v120, v21
    v_sub_f32 v121, v121, v21
    v_sub_f32 v122, v122, v21
    v_sub_f32 v123, v123, v21
    v_sub_f32 v124, v124, v21
    v_sub_f32 v125, v125, v21
    v_sub_f32 v126, v126, v21
    v_sub_f32 v127, v127, v21
    v_exp_f32 v24, -v21
    s_nop 0
    v_mul_f32 v128, v128, v24
    v_mul_f32 v129, v129, v24
    v_mul_f32 v130, v130, v24
    v_mul_f32 v131, v131, v24
    v_mul_f32 v132, v132, v24
    v_mul_f32 v133, v133, v24
    v_mul_f32 v134, v134, v24
    v_mul_f32 v135, v135, v24
    v_mul_f32 v136, v136, v24
    v_mul_f32 v137, v137, v24
    v_mul_f32 v138, v138, v24
    v_mul_f32 v139, v139, v24
    v_mul_f32 v140, v140, v24
    v_mul_f32 v141, v141, v24
    v_mul_f32 v142, v142, v24
    v_mul_f32 v143, v143, v24
    v_xor_b32 v23, 0x8000, v23
    v_and_b32 v23, 0xffff, v23
    v_cndmask_b32 v14, v14, v23, s[46:47]
k2_attn_kernel_fast10:
    v_exp_f32 v64, v64
    v_exp_f32 v65, v65
    v_exp_f32 v66, v66
    v_exp_f32 v67, v67
    v_exp_f32 v68, v68
    v_exp_f32 v69, v69
    v_exp_f32 v70, v70
    v_exp_f32 v71, v71
    v_exp_f32 v72, v72
    v_exp_f32 v73, v73
    v_exp_f32 v74, v74
    v_exp_f32 v75, v75
    v_exp_f32 v76, v76
    v_exp_f32 v77, v77
    v_exp_f32 v78, v78
    v_exp_f32 v79, v79
    v_exp_f32 v80, v80
    v_exp_f32 v81, v81
    v_exp_f32 v82, v82
    v_exp_f32 v83, v83
    v_exp_f32 v84, v84
    v_exp_f32 v85, v85
    v_exp_f32 v86, v86
    v_exp_f32 v87, v87
    v_exp_f32 v88, v88
    v_exp_f32 v89, v89
    v_exp_f32 v90, v90
    v_exp_f32 v91, v91
    v_exp_f32 v92, v92
    v_exp_f32 v93, v93
    v_exp_f32 v94, v94
    v_exp_f32 v95, v95
    v_exp_f32 v96, v96
    v_exp_f32 v97, v97
    v_exp_f32 v98, v98
    v_exp_f32 v99, v99
    v_exp_f32 v100, v100
    v_exp_f32 v101, v101
    v_exp_f32 v102, v102
    v_exp_f32 v103, v103
    v_exp_f32 v104, v104
    v_exp_f32 v105, v105
    v_exp_f32 v106, v106
    v_exp_f32 v107, v107
    v_exp_f32 v108, v108
    v_exp_f32 v109, v109
    v_exp_f32 v110, v110
    v_exp_f32 v111, v111
    v_exp_f32 v112, v112
    v_exp_f32 v113, v113
    v_exp_f32 v114, v114
    v_exp_f32 v115, v115
    v_exp_f32 v116, v116
    v_exp_f32 v117, v117
    v_exp_f32 v118, v118
    v_exp_f32 v119, v119
    v_exp_f32 v120, v120
    v_exp_f32 v121, v121
    v_exp_f32 v122, v122
    v_exp_f32 v123, v123
    v_exp_f32 v124, v124
    v_exp_f32 v125, v125
    v_exp_f32 v126, v126
    v_exp_f32 v127, v127
    s_nop 0
    v_cvt_pk_bf16_f32 v144, v64, v65
    v_cvt_pk_bf16_f32 v145, v66, v67
    v_cvt_pk_bf16_f32 v146, v68, v69
    v_cvt_pk_bf16_f32 v147, v70, v71
    v_cvt_pk_bf16_f32 v148, v72, v73
    v_cvt_pk_bf16_f32 v149, v74, v75
    v_cvt_pk_bf16_f32 v150, v76, v77
    v_cvt_pk_bf16_f32 v151, v78, v79
    v_cvt_pk_bf16_f32 v152, v80, v81
    v_cvt_pk_bf16_f32 v153, v82, v83
    v_cvt_pk_bf16_f32 v154, v84, v85
    v_cvt_pk_bf16_f32 v155, v86, v87
    v_cvt_pk_bf16_f32 v156, v88, v89
    v_cvt_pk_bf16_f32 v157, v90, v91
    v_cvt_pk_bf16_f32 v158, v92, v93
    v_cvt_pk_bf16_f32 v159, v94, v95
    v_cvt_pk_bf16_f32 v160, v96, v97
    v_cvt_pk_bf16_f32 v161, v98, v99
    v_cvt_pk_bf16_f32 v162, v100, v101
    v_cvt_pk_bf16_f32 v163, v102, v103
    v_cvt_pk_bf16_f32 v164, v104, v105
    v_cvt_pk_bf16_f32 v165, v106, v107
    v_cvt_pk_bf16_f32 v166, v108, v109
    v_cvt_pk_bf16_f32 v167, v110, v111
    v_cvt_pk_bf16_f32 v168, v112, v113
    v_cvt_pk_bf16_f32 v169, v114, v115
    v_cvt_pk_bf16_f32 v170, v116, v117
    v_cvt_pk_bf16_f32 v171, v118, v119
    v_cvt_pk_bf16_f32 v172, v120, v121
    v_cvt_pk_bf16_f32 v173, v122, v123
    v_cvt_pk_bf16_f32 v174, v124, v125
    v_cvt_pk_bf16_f32 v175, v126, v127
    s_waitcnt lgkmcnt(0)
    s_nop 1
    v_mfma_f32_32x32x16_bf16 v[128:143], v[192:195], v[144:147], v[128:143]
    v_mfma_f32_32x32x16_bf16 v[128:143], v[196:199], v[148:151], v[128:143]
    v_mfma_f32_32x32x16_bf16 v[128:143], v[200:203], v[152:155], v[128:143]
    v_mfma_f32_32x32x16_bf16 v[128:143], v[204:207], v[156:159], v[128:143]
    v_mfma_f32_32x32x16_bf16 v[128:143], v[208:211], v[160:163], v[128:143]
    v_mfma_f32_32x32x16_bf16 v[128:143], v[212:215], v[164:167], v[128:143]
    v_mfma_f32_32x32x16_bf16 v[128:143], v[216:219], v[168:171], v[128:143]
    v_mfma_f32_32x32x16_bf16 v[128:143], v[220:223], v[172:175], v[128:143]
    s_add_u32 s39, s39, 1
    s_cmp_lt_u32 s39, 3
    s_cbranch_scc1 k2_attn_kernel_loop6
    s_nop 15
k2_attn_kernel_combine1:
    v_lshlrev_b32 v3, 2, v1
    s_mul_i32 s45, s33, 4352
    v_add_u32 v3, s45, v3
    s_cmp_eq_u32 s44, 0
    s_cbranch_scc1 k2_attn_kernel_up11
    ds_write_b32 v3, v128 offset:0
    ds_write_b32 v3, v129 offset:256
    ds_write_b32 v3, v130 offset:512
    ds_write_b32 v3, v131 offset:768
    ds_write_b32 v3, v132 offset:1024
    ds_write_b32 v3, v133 offset:1280
    ds_write_b32 v3, v134 offset:1536
    ds_write_b32 v3, v135 offset:1792
    ds_write_b32 v3, v136 offset:2048
    ds_write_b32 v3, v137 offset:2304
    ds_write_b32 v3, v138 offset:2560
    ds_write_b32 v3, v139 offset:2816
    ds_write_b32 v3, v140 offset:3072
    ds_write_b32 v3, v141 offset:3328
    ds_write_b32 v3, v142 offset:3584
    ds_write_b32 v3, v143 offset:3840
    ds_write_b32 v3, v20 offset:4096
    s_waitcnt lgkmcnt(0)
    s_barrier
    s_endpgm
k2_attn_kernel_up11:
    s_barrier
    ds_read_b32 v64, v3 offset:0
    ds_read_b32 v65, v3 offset:256
    ds_read_b32 v66, v3 offset:512
    ds_read_b32 v67, v3 offset:768
    ds_read_b32 v68, v3 offset:1024
    ds_read_b32 v69, v3 offset:1280
    ds_read_b32 v70, v3 offset:1536
    ds_read_b32 v71, v3 offset:1792
    ds_read_b32 v72, v3 offset:2048
    ds_read_b32 v73, v3 offset:2304
    ds_read_b32 v74, v3 offset:2560
    ds_read_b32 v75, v3 offset:2816
    ds_read_b32 v76, v3 offset:3072
    ds_read_b32 v77, v3 offset:3328
    ds_read_b32 v78, v3 offset:3584
    ds_read_b32 v79, v3 offset:3840
    ds_read_b32 v80, v3 offset:4096
    s_waitcnt lgkmcnt(0)
    v_max_f32 v21, v20, v80
    v_sub_f32 v22, v20, v21
    v_sub_f32 v23, v80, v21
    v_exp_f32 v22, v22
    v_exp_f32 v23, v23
    s_nop 0
    v_mul_f32 v128, v128, v22
    v_fma_f32 v128, v64, v23, v128
    v_mul_f32 v129, v129, v22
    v_fma_f32 v129, v65, v23, v129
    v_mul_f32 v130, v130, v22
    v_fma_f32 v130, v66, v23, v130
    v_mul_f32 v131, v131, v22
    v_fma_f32 v131, v67, v23, v131
    v_mul_f32 v132, v132, v22
    v_fma_f32 v132, v68, v23, v132
    v_mul_f32 v133, v133, v22
    v_fma_f32 v133, v69, v23, v133
    v_mul_f32 v134, v134, v22
    v_fma_f32 v134, v70, v23, v134
    v_mul_f32 v135, v135, v22
    v_fma_f32 v135, v71, v23, v135
    v_mul_f32 v136, v136, v22
    v_fma_f32 v136, v72, v23, v136
    v_mul_f32 v137, v137, v22
    v_fma_f32 v137, v73, v23, v137
    v_mul_f32 v138, v138, v22
    v_fma_f32 v138, v74, v23, v138
    v_mul_f32 v139, v139, v22
    v_fma_f32 v139, v75, v23, v139
    v_mul_f32 v140, v140, v22
    v_fma_f32 v140, v76, v23, v140
    v_mul_f32 v141, v141, v22
    v_fma_f32 v141, v77, v23, v141
    v_mul_f32 v142, v142, v22
    v_fma_f32 v142, v78, v23, v142
    v_mul_f32 v143, v143, v22
    v_fma_f32 v143, v79, v23, v143
    s_nop 0
    v_mov_b32 v21, v140
    v_mov_b32 v22, v140
    s_nop 1
    v_permlane32_swap_b32 v21, v22
    s_nop 1
    v_rcp_f32 v22, v22
    s_nop 0
    v_mul_f32 v128, v128, v22
    v_mul_f32 v129, v129, v22
    v_mul_f32 v130, v130, v22
    v_mul_f32 v131, v131, v22
    v_mul_f32 v132, v132, v22
    v_mul_f32 v133, v133, v22
    v_mul_f32 v134, v134, v22
    v_mul_f32 v135, v135, v22
    v_mul_f32 v136, v136, v22
    v_mul_f32 v137, v137, v22
    v_mul_f32 v138, v138, v22
    v_mul_f32 v139, v139, v22
    v_mul_f32 v140, v140, v22
    v_mul_f32 v141, v141, v22
    v_mul_f32 v142, v142, v22
    v_mul_f32 v143, v143, v22
    v_cndmask_b32 v140, v140, 0, s[46:47]
    v_cndmask_b32 v141, v141, 0, s[46:47]
    v_cndmask_b32 v142, v142, 0, s[46:47]
    v_cndmask_b32 v143, v143, 0, s[46:47]
    v_cvt_pk_bf16_f32 v28, v128, v129
    v_cvt_pk_bf16_f32 v29, v130, v131
    v_cvt_pk_bf16_f32 v30, v132, v133
    v_cvt_pk_bf16_f32 v31, v134, v135
    v_cvt_pk_bf16_f32 v32, v136, v137
    v_cvt_pk_bf16_f32 v33, v138, v139
    v_cvt_pk_bf16_f32 v34, v140, v141
    v_cvt_pk_bf16_f32 v35, v142, v143
    v_lshlrev_b32 v3, 4, v1
    s_lshr_b32 s40, s34, 5
    s_lshl_b32 s40, s40, 5
    s_lshl_b32 s41, s31, 1
    s_add_u32 s40, s40, s41
    s_lshl_b32 s40, s40, 10
    buffer_store_dwordx4 v[28:31], v3, s[16:19], s40 offen offset:0 sc1
    buffer_store_dwordx4 v[32:35], v3, s[16:19], s40 offen offset:1024 sc1
k2_attn_kernel_end:
    s_endpgm
.globl k3_wo_kernel
.p2align 8
.type k3_wo_kernel,@function
k3_wo_kernel:
    s_cmp_ge_u32 s2, 224
    s_cbranch_scc1 k3_wo_kernel_cs
    s_load_dwordx2 s[28:29], s[0:1], 72
    s_load_dwordx2 s[6:7], s[0:1], 16
    s_load_dwordx2 s[20:21], s[0:1], 0
    v_and_b32 v1, 63, v0
    v_lshrrev_b32 v2, 6, v0
    s_and_b32 s30, s2, 7
    s_lshr_b32 s31, s2, 3
    v_readfirstlane_b32 s3, v2
    s_and_b32 s32, s31, 3
    s_lshl_b32 s30, s30, 2
    s_add_u32 s30, s30, s32
    s_lshr_b32 s31, s31, 2
    v_lshlrev_b32 v3, 4, v1
    v_lshrrev_b32 v4, 3, v1
    v_and_b32 v5, 7, v1
    v_bfe_u32 v6, v1, 4, 1
    v_lshlrev_b32 v6, 2, v6
    v_xor_b32 v5, v5, v6
    s_movk_i32 s44, 896
    s_and_b32 s33, s3, 1
    s_lshl_b32 s33, s33, 4
    v_add_u32 v6, s33, v4
    v_add_u32 v7, 8, v6
    v_min_u32 v7, 27, v7
    v_mul_u32_u24 v6, s44, v6
    v_mul_u32_u24 v7, s44, v7
    v_lshl_add_u32 v6, v5, 4, v6
    v_lshl_add_u32 v7, v5, 4, v7
    s_waitcnt lgkmcnt(0)
    s_add_u32 s8, s28, 0x600000
    s_addc_u32 s9, s29, 0
    s_mov_b32 s10, 0x200000
    s_mov_b32 s11, 0x00020000
    s_mov_b32 s12, s6
    s_mov_b32 s13, s7
    s_mov_b32 s14, 0x62000
    s_mov_b32 s15, 0x00020000
    s_mul_i32 s34, s30, 65536
    s_lshl_b32 s35, s3, 10
    s_add_u32 s34, s34, s35
    s_lshl_b32 s36, s31, 7
    s_lshr_b32 s37, s3, 1
    s_mul_i32 s37, s37, 25088
    s_add_u32 s36, s36, s37
    s_mul_i32 s38, s3, 8192
    s_mul_i32 s47, s31, 1
    s_mul_i32 s48, s32, 2
    s_add_u32 s47, s47, s48
    s_cmp_ge_u32 s47, 8
    s_cselect_b32 s48, 8, 0
    s_sub_u32 s47, s47, s48
    s_lshl_b32 s48, s47, 12
    s_add_u32 s34, s34, s48
    s_mul_i32 s48, s47, 50176
    s_add_u32 s36, s36, s48
    buffer_load_dwordx4 v[128:131], v3, s[8:11], s34 offen
    s_add_u32 s39, s34, 32768
    buffer_load_dwordx4 v[132:135], v3, s[8:11], s39 offen
    s_add_u32 m0, s38, 0
    s_add_u32 s34, s34, 4096
    buffer_load_dwordx4 v6, s[12:15], s36 offen lds
    s_add_u32 m0, s38, 1024
    s_nop 0
    buffer_load_dwordx4 v7, s[12:15], s36 offen lds
    s_add_u32 s36, s36, 50176
    s_add_u32 s47, s47, 1
    s_cmp_eq_u32 s47, 8
    s_cselect_b32 s48, 32768, 0
    s_cselect_b32 s49, 401408, 0
    s_sub_u32 s34, s34, s48
    s_sub_u32 s36, s36, s49
    buffer_load_dwordx4 v[136:139], v3, s[8:11], s34 offen
    s_add_u32 s39, s34, 32768
    buffer_load_dwordx4 v[140:143], v3, s[8:11], s39 offen
    s_add_u32 m0, s38, 2048
    s_add_u32 s34, s34, 4096
    buffer_load_dwordx4 v6, s[12:15], s36 offen lds
    s_add_u32 m0, s38, 3072
    s_nop 0
    buffer_load_dwordx4 v7, s[12:15], s36 offen lds
    s_add_u32 s36, s36, 50176
    s_add_u32 s47, s47, 1
    s_cmp_eq_u32 s47, 8
    s_cselect_b32 s48, 32768, 0
    s_cselect_b32 s49, 401408, 0
    s_sub_u32 s34, s34, s48
    s_sub_u32 s36, s36, s49
    buffer_load_dwordx4 v[144:147], v3, s[8:11], s34 offen
    s_add_u32 s39, s34, 32768
    buffer_load_dwordx4 v[148:151], v3, s[8:11], s39 offen
    s_add_u32 m0, s38, 4096
    s_add_u32 s34, s34, 4096
    buffer_load_dwordx4 v6, s[12:15], s36 offen lds
    s_add_u32 m0, s38, 5120
    s_nop 0
    buffer_load_dwordx4 v7, s[12:15], s36 offen lds
    s_add_u32 s36, s36, 50176
    s_add_u32 s47, s47, 1
    s_cmp_eq_u32 s47, 8
    s_cselect_b32 s48, 32768, 0
    s_cselect_b32 s49, 401408, 0
    s_sub_u32 s34, s34, s48
    s_sub_u32 s36, s36, s49
    buffer_load_dwordx4 v[152:155], v3, s[8:11], s34 offen
    s_add_u32 s39, s34, 32768
    buffer_load_dwordx4 v[156:159], v3, s[8:11], s39 offen
    s_add_u32 m0, s38, 6144
    s_add_u32 s34, s34, 4096
    buffer_load_dwordx4 v6, s[12:15], s36 offen lds
    s_add_u32 m0, s38, 7168
    s_nop 0
    buffer_load_dwordx4 v7, s[12:15], s36 offen lds
    s_add_u32 s36, s36, 50176
    s_add_u32 s47, s47, 1
    s_cmp_eq_u32 s47, 8
    s_cselect_b32 s48, 32768, 0
    s_cselect_b32 s49, 401408, 0
    s_sub_u32 s34, s34, s48
    s_sub_u32 s36, s36, s49
    v_lshrrev_b32 v8, 5, v1
    v_bfe_u32 v9, v1, 2, 2
    v_lshl_add_u32 v10, v8, 2, v9
    v_lshlrev_b32 v10, 7, v10
    v_lshrrev_b32 v11, 1, v9
    v_lshl_add_u32 v10, v11, 6, v10
    v_bfe_u32 v11, v1, 4, 1
    v_lshl_add_u32 v10, v11, 5, v10
    v_and_b32 v11, 3, v1
    v_lshl_add_u32 v10, v11, 3, v10
    v_add_u32 v10, s38, v10
    v_xor_b32 v11, 64, v10
    s_waitcnt vmcnt(12)
    ds_read_b64_tr_b16 v[192:193], v10 offset:0
    ds_read_b64_tr_b16 v[194:195], v10 offset:1024
    ds_read_b64_tr_b16 v[196:197], v11 offset:0
    ds_read_b64_tr_b16 v[198:199], v11 offset:1024
    s_waitcnt vmcnt(8)
    ds_read_b64_tr_b16 v[200:201], v10 offset:2048
    ds_read_b64_tr_b16 v[202:203], v10 offset:3072
    ds_read_b64_tr_b16 v[204:205], v11 offset:2048
    ds_read_b64_tr_b16 v[206:207], v11 offset:3072
    s_waitcnt lgkmcnt(4)
    v_mfma_f32_32x32x16_bf16 v[64:79], v[192:195], v[128:131], 0
    v_mfma_f32_32x32x16_bf16 v[80:95], v[196:199], v[128:131], 0
    v_mfma_f32_32x32x16_bf16 v[96:111], v[192:195], v[132:135], 0
    v_mfma_f32_32x32x16_bf16 v[112:127], v[196:199], v[132:135], 0
    buffer_load_dwordx4 v[128:131], v3, s[8:11], s34 offen
    s_add_u32 s39, s34, 32768
    buffer_load_dwordx4 v[132:135], v3, s[8:11], s39 offen
    s_add_u32 m0, s38, 0
    s_add_u32 s34, s34, 4096
    buffer_load_dwordx4 v6, s[12:15], s36 offen lds
    s_add_u32 m0, s38, 1024
    s_nop 0
    buffer_load_dwordx4 v7, s[12:15], s36 offen lds
    s_add_u32 s36, s36, 50176
    s_add_u32 s47, s47, 1
    s_cmp_eq_u32 s47, 8
    s_cselect_b32 s48, 32768, 0
    s_cselect_b32 s49, 401408, 0
    s_sub_u32 s34, s34, s48
    s_sub_u32 s36, s36, s49
    s_waitcnt vmcnt(8)
    ds_read_b64_tr_b16 v[192:193], v10 offset:4096
    ds_read_b64_tr_b16 v[194:195], v10 offset:5120
    ds_read_b64_tr_b16 v[196:197], v11 offset:4096
    ds_read_b64_tr_b16 v[198:199], v11 offset:5120
    s_waitcnt lgkmcnt(4)
    v_mfma_f32_32x32x16_bf16 v[64:79], v[200:203], v[136:139], v[64:79]
    v_mfma_f32_32x32x16_bf16 v[80:95], v[204:207], v[136:139], v[80:95]
    v_mfma_f32_32x32x16_bf16 v[96:111], v[200:203], v[140:143], v[96:111]
    v_mfma_f32_32x32x16_bf16 v[112:127], v[204:207], v[140:143], v[112:127]
    buffer_load_dwordx4 v[136:139], v3, s[8:11], s34 offen
    s_add_u32 s39, s34, 32768
    buffer_load_dwordx4 v[140:143], v3, s[8:11], s39 offen
    s_add_u32 m0, s38, 2048
    s_add_u32 s34, s34, 4096
    buffer_load_dwordx4 v6, s[12:15], s36 offen lds
    s_add_u32 m0, s38, 3072
    s_nop 0
    buffer_load_dwordx4 v7, s[12:15], s36 offen lds
    s_add_u32 s36, s36, 50176
    s_add_u32 s47, s47, 1
    s_cmp_eq_u32 s47, 8
    s_cselect_b32 s48, 32768, 0
    s_cselect_b32 s49, 401408, 0
    s_sub_u32 s34, s34, s48
    s_sub_u32 s36, s36, s49
    s_waitcnt vmcnt(8)
    ds_read_b64_tr_b16 v[200:201], v10 offset:6144
    ds_read_b64_tr_b16 v[202:203], v10 offset:7168
    ds_read_b64_tr_b16 v[204:205], v11 offset:6144
    ds_read_b64_tr_b16 v[206:207], v11 offset:7168
    s_waitcnt lgkmcnt(4)
    v_mfma_f32_32x32x16_bf16 v[64:79], v[192:195], v[144:147], v[64:79]
    v_mfma_f32_32x32x16_bf16 v[80:95], v[196:199], v[144:147], v[80:95]
    v_mfma_f32_32x32x16_bf16 v[96:111], v[192:195], v[148:151], v[96:111]
    v_mfma_f32_32x32x16_bf16 v[112:127], v[196:199], v[148:151], v[112:127]
    buffer_load_dwordx4 v[144:147], v3, s[8:11], s34 offen
    s_add_u32 s39, s34, 32768
    buffer_load_dwordx4 v[148:151], v3, s[8:11], s39 offen
    s_add_u32 m0, s38, 4096
    s_add_u32 s34, s34, 4096
    buffer_load_dwordx4 v6, s[12:15], s36 offen lds
    s_add_u32 m0, s38, 5120
    s_nop 0
    buffer_load_dwordx4 v7, s[12:15], s36 offen lds
    s_add_u32 s36, s36, 50176
    s_add_u32 s47, s47, 1
    s_cmp_eq_u32 s47, 8
    s_cselect_b32 s48, 32768, 0
    s_cselect_b32 s49, 401408, 0
    s_sub_u32 s34, s34, s48
    s_sub_u32 s36, s36, s49
    s_waitcnt vmcnt(8)
    ds_read_b64_tr_b16 v[192:193], v10 offset:0
    ds_read_b64_tr_b16 v[194:195], v10 offset:1024
    ds_read_b64_tr_b16 v[196:197], v11 offset:0
    ds_read_b64_tr_b16 v[198:199], v11 offset:1024
    s_waitcnt lgkmcnt(4)
    v_mfma_f32_32x32x16_bf16 v[64:79], v[200:203], v[152:155], v[64:79]
    v_mfma_f32_32x32x16_bf16 v[80:95], v[204:207], v[152:155], v[80:95]
    v_mfma_f32_32x32x16_bf16 v[96:111], v[200:203], v[156:159], v[96:111]
    v_mfma_f32_32x32x16_bf16 v[112:127], v[204:207], v[156:159], v[112:127]
    buffer_load_dwordx4 v[152:155], v3, s[8:11], s34 offen
    s_add_u32 s39, s34, 32768
    buffer_load_dwordx4 v[156:159], v3, s[8:11], s39 offen
    s_add_u32 m0, s38, 6144
    s_add_u32 s34, s34, 4096
    buffer_load_dwordx4 v6, s[12:15], s36 offen lds
    s_add_u32 m0, s38, 7168
    s_nop 0
    buffer_load_dwordx4 v7, s[12:15], s36 offen lds
    s_add_u32 s36, s36, 50176
    s_add_u32 s47, s47, 1
    s_cmp_eq_u32 s47, 8
    s_cselect_b32 s48, 32768, 0
    s_cselect_b32 s49, 401408, 0
    s_sub_u32 s34, s34, s48
    s_sub_u32 s36, s36, s49
    s_waitcnt vmcnt(8)
    ds_read_b64_tr_b16 v[200:201], v10 offset:2048
    ds_read_b64_tr_b16 v[202:203], v10 offset:3072
    ds_read_b64_tr_b16 v[204:205], v11 offset:2048
    ds_read_b64_tr_b16 v[206:207], v11 offset:3072
    s_waitcnt lgkmcnt(4)
    v_mfma_f32_32x32x16_bf16 v[64:79], v[192:195], v[128:131], v[64:79]
    v_mfma_f32_32x32x16_bf16 v[80:95], v[196:199], v[128:131], v[80:95]
    v_mfma_f32_32x32x16_bf16 v[96:111], v[192:195], v[132:135], v[96:111]
    v_mfma_f32_32x32x16_bf16 v[112:127], v[196:199], v[132:135], v[112:127]
    s_waitcnt vmcnt(4)
    ds_read_b64_tr_b16 v[192:193], v10 offset:4096
    ds_read_b64_tr_b16 v[194:195], v10 offset:5120
    ds_read_b64_tr_b16 v[196:197], v11 offset:4096
    ds_read_b64_tr_b16 v[198:199], v11 offset:5120
    s_waitcnt lgkmcnt(4)
    v_mfma_f32_32x32x16_bf16 v[64:79], v[200:203], v[136:139], v[64:79]
    v_mfma_f32_32x32x16_bf16 v[80:95], v[204:207], v[136:139], v[80:95]
    v_mfma_f32_32x32x16_bf16 v[96:111], v[200:203], v[140:143], v[96:111]
    v_mfma_f32_32x32x16_bf16 v[112:127], v[204:207], v[140:143], v[112:127]
    s_waitcnt vmcnt(0)
    ds_read_b64_tr_b16 v[200:201], v10 offset:6144
    ds_read_b64_tr_b16 v[202:203], v10 offset:7168
    ds_read_b64_tr_b16 v[204:205], v11 offset:6144
    ds_read_b64_tr_b16 v[206:207], v11 offset:7168
    s_waitcnt lgkmcnt(4)
    v_mfma_f32_32x32x16_bf16 v[64:79], v[192:195], v[144:147], v[64:79]
    v_mfma_f32_32x32x16_bf16 v[80:95], v[196:199], v[144:147], v[80:95]
    v_mfma_f32_32x32x16_bf16 v[96:111], v[192:195], v[148:151], v[96:111]
    v_mfma_f32_32x32x16_bf16 v[112:127], v[196:199], v[148:151], v[112:127]
    s_waitcnt lgkmcnt(0)
    v_mfma_f32_32x32x16_bf16 v[64:79], v[200:203], v[152:155], v[64:79]
    v_mfma_f32_32x32x16_bf16 v[80:95], v[204:207], v[152:155], v[80:95]
    v_mfma_f32_32x32x16_bf16 v[96:111], v[200:203], v[156:159], v[96:111]
    v_mfma_f32_32x32x16_bf16 v[112:127], v[204:207], v[156:159], v[112:127]
    s_lshr_b32 s40, s3, 1
    s_and_b32 s41, s3, 1
    s_lshl_b32 s42, s30, 1
    s_add_u32 s42, s42, s40
    s_lshl_b32 s43, s31, 1
    s_add_u32 s43, s43, s41
    v_and_b32 v12, 31, v1
    s_mov_b32 s16, s20
    s_mov_b32 s17, s21
    s_mov_b32 s18, 0x1c0000
    s_mov_b32 s19, 0x00020000
    s_add_u32 s24, s28, 0x800000
    s_addc_u32 s25, s29, 0
    s_mov_b32 s26, 0x1c0000
    s_mov_b32 s27, 0x00020000
    s_lshl_b32 s45, s42, 5
    v_add_u32 v13, s45, v12
    v_mul_u32_u24 v13, s44, v13
    v_lshl_add_u32 v13, v8, 3, v13
    s_lshl_b32 s45, s43, 6
    buffer_load_dwordx2 v[208:209], v13, s[16:19], s45 offen offset:0
    buffer_load_dwordx2 v[210:211], v13, s[16:19], s45 offen offset:16
    buffer_load_dwordx2 v[212:213], v13, s[16:19], s45 offen offset:32
    buffer_load_dwordx2 v[214:215], v13, s[16:19], s45 offen offset:48
    s_barrier
    s_nop 7
    s_cmp_eq_u32 s3, 0
    s_cbranch_scc1 k3_wo_kernel_own1
    s_sub_u32 s45, s3, 1
    s_and_b32 s45, s45, 3
    s_lshl_b32 s45, s45, 12
    s_add_u32 s45, s45, 0
    v_add_u32 v14, s45, v3
    ds_write_b128 v14, v[64:67] offset:0
    ds_write_b128 v14, v[68:71] offset:1024
    ds_write_b128 v14, v[72:75] offset:2048
    ds_write_b128 v14, v[76:79] offset:3072
k3_wo_kernel_own1:
    s_cmp_eq_u32 s3, 1
    s_cbranch_scc1 k3_wo_kernel_own2
    s_sub_u32 s45, s3, 2
    s_and_b32 s45, s45, 3
    s_lshl_b32 s45, s45, 12
    s_add_u32 s45, s45, 12288
    v_add_u32 v14, s45, v3
    ds_write_b128 v14, v[80:83] offset:0
    ds_write_b128 v14, v[84:87] offset:1024
    ds_write_b128 v14, v[88:91] offset:2048
    ds_write_b128 v14, v[92:95] offset:3072
k3_wo_kernel_own2:
    s_cmp_eq_u32 s3, 2
    s_cbranch_scc1 k3_wo_kernel_own3
    s_sub_u32 s45, s3, 3
    s_and_b32 s45, s45, 3
    s_lshl_b32 s45, s45, 12
    s_add_u32 s45, s45, 24576
    v_add_u32 v14, s45, v3
    ds_write_b128 v14, v[96:99] offset:0
    ds_write_b128 v14, v[100:103] offset:1024
    ds_write_b128 v14, v[104:107] offset:2048
    ds_write_b128 v14, v[108:111] offset:3072
k3_wo_kernel_own3:
    s_cmp_eq_u32 s3, 3
    s_cbranch_scc1 k3_wo_kernel_own4
    s_sub_u32 s45, s3, 4
    s_and_b32 s45, s45, 3
    s_lshl_b32 s45, s45, 12
    s_add_u32 s45, s45, 36864
    v_add_u32 v14, s45, v3
    ds_write_b128 v14, v[112:115] offset:0
    ds_write_b128 v14, v[116:119] offset:1024
    ds_write_b128 v14, v[120:123] offset:2048
    ds_write_b128 v14, v[124:127] offset:3072
k3_wo_kernel_own4:
    s_cmp_lg_u32 s3, 0
    s_cbranch_scc1 k3_wo_kernel_mv5
    v_mov_b32 v128, v64
    v_mov_b32 v129, v65
    v_mov_b32 v130, v66
    v_mov_b32 v131, v67
    v_mov_b32 v132, v68
    v_mov_b32 v133, v69
    v_mov_b32 v134, v70
    v_mov_b32 v135, v71
    v_mov_b32 v136, v72
    v_mov_b32 v137, v73
    v_mov_b32 v138, v74
    v_mov_b32 v139, v75
    v_mov_b32 v140, v76
    v_mov_b32 v141, v77
    v_mov_b32 v142, v78
    v_mov_b32 v143, v79
k3_wo_kernel_mv5:
    s_cmp_lg_u32 s3, 1
    s_cbranch_scc1 k3_wo_kernel_mv6
    v_mov_b32 v128, v80
    v_mov_b32 v129, v81
    v_mov_b32 v130, v82
    v_mov_b32 v131, v83
    v_mov_b32 v132, v84
    v_mov_b32 v133, v85
    v_mov_b32 v134, v86
    v_mov_b32 v135, v87
    v_mov_b32 v136, v88
    v_mov_b32 v137, v89
    v_mov_b32 v138, v90
    v_mov_b32 v139, v91
    v_mov_b32 v140, v92
    v_mov_b32 v141, v93
    v_mov_b32 v142, v94
    v_mov_b32 v143, v95
k3_wo_kernel_mv6:
    s_cmp_lg_u32 s3, 2
    s_cbranch_scc1 k3_wo_kernel_mv7
    v_mov_b32 v128, v96
    v_mov_b32 v129, v97
    v_mov_b32 v130, v98
    v_mov_b32 v131, v99
    v_mov_b32 v132, v100
    v_mov_b32 v133, v101
    v_mov_b32 v134, v102
    v_mov_b32 v135, v103
    v_mov_b32 v136, v104
    v_mov_b32 v137, v105
    v_mov_b32 v138, v106
    v_mov_b32 v139, v107
    v_mov_b32 v140, v108
    v_mov_b32 v141, v109
    v_mov_b32 v142, v110
    v_mov_b32 v143, v111
k3_wo_kernel_mv7:
    s_cmp_lg_u32 s3, 3
    s_cbranch_scc1 k3_wo_kernel_mv8
    v_mov_b32 v128, v112
    v_mov_b32 v129, v113
    v_mov_b32 v130, v114
    v_mov_b32 v131, v115
    v_mov_b32 v132, v116
    v_mov_b32 v133, v117
    v_mov_b32 v134, v118
    v_mov_b32 v135, v119
    v_mov_b32 v136, v120
    v_mov_b32 v137, v121
    v_mov_b32 v138, v122
    v_mov_b32 v139, v123
    v_mov_b32 v140, v124
    v_mov_b32 v141, v125
    v_mov_b32 v142, v126
    v_mov_b32 v143, v127
k3_wo_kernel_mv8:
    s_waitcnt lgkmcnt(0)
    s_barrier
    s_mul_i32 s45, s3, 12288
    v_add_u32 v14, s45, v3
    ds_read_b128 v[144:147], v14 offset:0
    ds_read_b128 v[148:151], v14 offset:1024
    ds_read_b128 v[152:155], v14 offset:2048
    ds_read_b128 v[156:159], v14 offset:3072
    ds_read_b128 v[160:163], v14 offset:4096
    ds_read_b128 v[164:167], v14 offset:5120
    ds_read_b128 v[168:171], v14 offset:6144
    ds_read_b128 v[172:175], v14 offset:7168
    ds_read_b128 v[176:179], v14 offset:8192
    ds_read_b128 v[180:183], v14 offset:9216
    ds_read_b128 v[184:187], v14 offset:10240
    ds_read_b128 v[188:191], v14 offset:11264
    s_waitcnt lgkmcnt(8)
    v_add_f32 v128, v128, v144
    v_add_f32 v129, v129, v145
    v_add_f32 v130, v130, v146
    v_add_f32 v131, v131, v147
    v_add_f32 v132, v132, v148
    v_add_f32 v133, v133, v149
    v_add_f32 v134, v134, v150
    v_add_f32 v135, v135, v151
    v_add_f32 v136, v136, v152
    v_add_f32 v137, v137, v153
    v_add_f32 v138, v138, v154
    v_add_f32 v139, v139, v155
    v_add_f32 v140, v140, v156
    v_add_f32 v141, v141, v157
    v_add_f32 v142, v142, v158
    v_add_f32 v143, v143, v159
    s_waitcnt lgkmcnt(4)
    v_add_f32 v128, v128, v160
    v_add_f32 v129, v129, v161
    v_add_f32 v130, v130, v162
    v_add_f32 v131, v131, v163
    v_add_f32 v132, v132, v164
    v_add_f32 v133, v133, v165
    v_add_f32 v134, v134, v166
    v_add_f32 v135, v135, v167
    v_add_f32 v136, v136, v168
    v_add_f32 v137, v137, v169
    v_add_f32 v138, v138, v170
    v_add_f32 v139, v139, v171
    v_add_f32 v140, v140, v172
    v_add_f32 v141, v141, v173
    v_add_f32 v142, v142, v174
    v_add_f32 v143, v143, v175
    s_waitcnt lgkmcnt(0)
    v_add_f32 v128, v128, v176
    v_add_f32 v129, v129, v177
    v_add_f32 v130, v130, v178
    v_add_f32 v131, v131, v179
    v_add_f32 v132, v132, v180
    v_add_f32 v133, v133, v181
    v_add_f32 v134, v134, v182
    v_add_f32 v135, v135, v183
    v_add_f32 v136, v136, v184
    v_add_f32 v137, v137, v185
    v_add_f32 v138, v138, v186
    v_add_f32 v139, v139, v187
    v_add_f32 v140, v140, v188
    v_add_f32 v141, v141, v189
    v_add_f32 v142, v142, v190
    v_add_f32 v143, v143, v191
    s_waitcnt vmcnt(0)
    v_lshlrev_b32 v14, 16, v208
    v_and_b32 v15, 0xffff0000, v208
    v_add_f32 v14, v14, v128
    v_add_f32 v15, v15, v129
    v_cvt_pk_bf16_f32 v208, v14, v15
    v_lshlrev_b32 v14, 16, v209
    v_and_b32 v15, 0xffff0000, v209
    v_add_f32 v14, v14, v130
    v_add_f32 v15, v15, v131
    v_cvt_pk_bf16_f32 v209, v14, v15
    v_lshlrev_b32 v14, 16, v210
    v_and_b32 v15, 0xffff0000, v210
    v_add_f32 v14, v14, v132
    v_add_f32 v15, v15, v133
    v_cvt_pk_bf16_f32 v210, v14, v15
    v_lshlrev_b32 v14, 16, v211
    v_and_b32 v15, 0xffff0000, v211
    v_add_f32 v14, v14, v134
    v_add_f32 v15, v15, v135
    v_cvt_pk_bf16_f32 v211, v14, v15
    v_lshlrev_b32 v14, 16, v212
    v_and_b32 v15, 0xffff0000, v212
    v_add_f32 v14, v14, v136
    v_add_f32 v15, v15, v137
    v_cvt_pk_bf16_f32 v212, v14, v15
    v_lshlrev_b32 v14, 16, v213
    v_and_b32 v15, 0xffff0000, v213
    v_add_f32 v14, v14, v138
    v_add_f32 v15, v15, v139
    v_cvt_pk_bf16_f32 v213, v14, v15
    v_lshlrev_b32 v14, 16, v214
    v_and_b32 v15, 0xffff0000, v214
    v_add_f32 v14, v14, v140
    v_add_f32 v15, v15, v141
    v_cvt_pk_bf16_f32 v214, v14, v15
    v_lshlrev_b32 v14, 16, v215
    v_and_b32 v15, 0xffff0000, v215
    v_add_f32 v14, v14, v142
    v_add_f32 v15, v15, v143
    v_cvt_pk_bf16_f32 v215, v14, v15
    s_mul_i32 s45, s42, 28
    s_lshl_b32 s46, s43, 1
    s_add_u32 s45, s45, s46
    s_lshl_b32 s45, s45, 10
    buffer_store_dwordx4 v[208:211], v3, s[24:27], s45 offen offset:0
    buffer_store_dwordx4 v[212:215], v3, s[24:27], s45 offen offset:1024
    v_mov_b32 v16, 0
    v_mov_b32 v17, 0
    s_mov_b32 s46, 0x3f803f80
    v_dot2_f32_bf16 v16, v208, s46, v16
    v_dot2_f32_bf16 v17, v208, v208, v17
    v_dot2_f32_bf16 v16, v209, s46, v16
    v_dot2_f32_bf16 v17, v209, v209, v17
    v_dot2_f32_bf16 v16, v210, s46, v16
    v_dot2_f32_bf16 v17, v210, v210, v17
    v_dot2_f32_bf16 v16, v211, s46, v16
    v_dot2_f32_bf16 v17, v211, v211, v17
    v_dot2_f32_bf16 v16, v212, s46, v16
    v_dot2_f32_bf16 v17, v212, v212, v17
    v_dot2_f32_bf16 v16, v213, s46, v16
    v_dot2_f32_bf16 v17, v213, v213, v17
    v_dot2_f32_bf16 v16, v214, s46, v16
    v_dot2_f32_bf16 v17, v214, v214, v17
    v_dot2_f32_bf16 v16, v215, s46, v16
    v_dot2_f32_bf16 v17, v215, v215, v17
    s_nop 1
    v_mov_b32 v18, v16
    v_mov_b32 v19, v17
    s_nop 1
    v_permlane32_swap_b32 v16, v18
    v_permlane32_swap_b32 v17, v19
    s_nop 1
    v_add_f32 v16, v16, v18
    v_add_f32 v17, v17, v19
    s_add_u32 s16, s28, 0x1200000
    s_addc_u32 s17, s29, 0
    s_mov_b32 s18, 0x38000
    s_mov_b32 s19, 0x00020000
    s_lshl_b32 s45, s42, 5
    v_add_u32 v13, s45, v12
    v_lshlrev_b32 v13, 3, v13
    s_lshl_b32 s45, s43, 14
    v_cmp_gt_u32 vcc, 32, v1
    s_and_saveexec_b64 s[46:47], vcc
    buffer_store_dwordx2 v[16:17], v13, s[16:19], s45 offen
    s_branch k3_wo_kernel_fin
k3_wo_kernel_cs:
    s_cmp_ge_u32 s2, 252
    s_cbranch_scc1 k3_wo_kernel_end
    s_load_dwordx2 s[28:29], s[0:1], 72
    s_load_dwordx2 s[4:5], s[0:1], 32
    s_load_dwordx2 s[6:7], s[0:1], 40
    v_and_b32 v1, 63, v0
    v_lshrrev_b32 v2, 6, v0
    s_sub_u32 s30, s2, 224
    v_readfirstlane_b32 s3, v2
    s_cmp_ge_u32 s30, 14
    s_cselect_b32 s31, 14, 0
    s_cselect_b32 s33, 1, 0
    s_sub_u32 s32, s30, s31
    v_lshrrev_b32 v4, 4, v1
    v_and_b32 v5, 15, v1
    s_movk_i32 s44, 3584
    v_mul_u32_u24 v4, s44, v4
    v_lshl_add_u32 v4, v5, 4, v4
    s_waitcnt lgkmcnt(0)
    s_cmp_eq_u32 s33, 1
    s_cselect_b32 s4, s6, s4
    s_cselect_b32 s5, s7, s5
    s_mov_b32 s8, s4
    s_mov_b32 s9, s5
    s_mov_b32 s10, 0x188000
    s_mov_b32 s11, 0x00020000
    s_mul_i32 s34, s3, 401408
    s_lshl_b32 s35, s32, 8
    s_add_u32 s34, s34, s35
    buffer_load_dwordx4 v[64:67], v4, s[8:11], s34 offen
    s_add_u32 s34, s34, 14336
    buffer_load_dwordx4 v[68:71], v4, s[8:11], s34 offen
    s_add_u32 s34, s34, 14336
    buffer_load_dwordx4 v[72:75], v4, s[8:11], s34 offen
    s_add_u32 s34, s34, 14336
    buffer_load_dwordx4 v[76:79], v4, s[8:11], s34 offen
    s_add_u32 s34, s34, 14336
    buffer_load_dwordx4 v[80:83], v4, s[8:11], s34 offen
    s_add_u32 s34, s34, 14336
    buffer_load_dwordx4 v[84:87], v4, s[8:11], s34 offen
    s_add_u32 s34, s34, 14336
    buffer_load_dwordx4 v[88:91], v4, s[8:11], s34 offen
    s_add_u32 s34, s34, 14336
    buffer_load_dwordx4 v[92:95], v4, s[8:11], s34 offen
    s_add_u32 s34, s34, 14336
    buffer_load_dwordx4 v[96:99], v4, s[8:11], s34 offen
    s_add_u32 s34, s34, 14336
    buffer_load_dwordx4 v[100:103], v4, s[8:11], s34 offen
    s_add_u32 s34, s34, 14336
    buffer_load_dwordx4 v[104:107], v4, s[8:11], s34 offen
    s_add_u32 s34, s34, 14336
    buffer_load_dwordx4 v[108:111], v4, s[8:11], s34 offen
    s_add_u32 s34, s34, 14336
    buffer_load_dwordx4 v[112:115], v4, s[8:11], s34 offen
    s_add_u32 s34, s34, 14336
    buffer_load_dwordx4 v[116:119], v4, s[8:11], s34 offen
    s_add_u32 s34, s34, 14336
    buffer_load_dwordx4 v[120:123], v4, s[8:11], s34 offen
    s_add_u32 s34, s34, 14336
    buffer_load_dwordx4 v[124:127], v4, s[8:11], s34 offen
    s_add_u32 s34, s34, 14336
    buffer_load_dwordx4 v[128:131], v4, s[8:11], s34 offen
    s_add_u32 s34, s34, 14336
    buffer_load_dwordx4 v[132:135], v4, s[8:11], s34 offen
    s_add_u32 s34, s34, 14336
    buffer_load_dwordx4 v[136:139], v4, s[8:11], s34 offen
    s_add_u32 s34, s34, 14336
    buffer_load_dwordx4 v[140:143], v4, s[8:11], s34 offen
    s_add_u32 s34, s34, 14336
    buffer_load_dwordx4 v[144:147], v4, s[8:11], s34 offen
    s_add_u32 s34, s34, 14336
    buffer_load_dwordx4 v[148:151], v4, s[8:11], s34 offen
    s_add_u32 s34, s34, 14336
    buffer_load_dwordx4 v[152:155], v4, s[8:11], s34 offen
    s_add_u32 s34, s34, 14336
    buffer_load_dwordx4 v[156:159], v4, s[8:11], s34 offen
    s_add_u32 s34, s34, 14336
    buffer_load_dwordx4 v[160:163], v4, s[8:11], s34 offen
    s_add_u32 s34, s34, 14336
    buffer_load_dwordx4 v[164:167], v4, s[8:11], s34 offen
    s_add_u32 s34, s34, 14336
    buffer_load_dwordx4 v[168:171], v4, s[8:11], s34 offen
    s_add_u32 s34, s34, 14336
    buffer_load_dwordx4 v[172:175], v4, s[8:11], s34 offen
    s_add_u32 s34, s34, 14336
    v_mov_b32 v16, 0
    v_mov_b32 v17, 0
    v_mov_b32 v18, 0
    v_mov_b32 v19, 0
    v_mov_b32 v20, 0
    v_mov_b32 v21, 0
    v_mov_b32 v22, 0
    v_mov_b32 v23, 0
    s_waitcnt vmcnt(27)
    v_lshlrev_b32 v24, 16, v64
    v_and_b32 v25, 0xffff0000, v64
    v_lshlrev_b32 v26, 16, v65
    v_and_b32 v27, 0xffff0000, v65
    v_lshlrev_b32 v28, 16, v66
    v_and_b32 v29, 0xffff0000, v66
    v_lshlrev_b32 v30, 16, v67
    v_and_b32 v31, 0xffff0000, v67
    v_add_f32 v16, v16, v24
    v_add_f32 v17, v17, v25
    v_add_f32 v18, v18, v26
    v_add_f32 v19, v19, v27
    v_add_f32 v20, v20, v28
    v_add_f32 v21, v21, v29
    v_add_f32 v22, v22, v30
    v_add_f32 v23, v23, v31
    s_waitcnt vmcnt(26)
    v_lshlrev_b32 v24, 16, v68
    v_and_b32 v25, 0xffff0000, v68
    v_lshlrev_b32 v26, 16, v69
    v_and_b32 v27, 0xffff0000, v69
    v_lshlrev_b32 v28, 16, v70
    v_and_b32 v29, 0xffff0000, v70
    v_lshlrev_b32 v30, 16, v71
    v_and_b32 v31, 0xffff0000, v71
    v_add_f32 v16, v16, v24
    v_add_f32 v17, v17, v25
    v_add_f32 v18, v18, v26
    v_add_f32 v19, v19, v27
    v_add_f32 v20, v20, v28
    v_add_f32 v21, v21, v29
    v_add_f32 v22, v22, v30
    v_add_f32 v23, v23, v31
    s_waitcnt vmcnt(25)
    v_lshlrev_b32 v24, 16, v72
    v_and_b32 v25, 0xffff0000, v72
    v_lshlrev_b32 v26, 16, v73
    v_and_b32 v27, 0xffff0000, v73
    v_lshlrev_b32 v28, 16, v74
    v_and_b32 v29, 0xffff0000, v74
    v_lshlrev_b32 v30, 16, v75
    v_and_b32 v31, 0xffff0000, v75
    v_add_f32 v16, v16, v24
    v_add_f32 v17, v17, v25
    v_add_f32 v18, v18, v26
    v_add_f32 v19, v19, v27
    v_add_f32 v20, v20, v28
    v_add_f32 v21, v21, v29
    v_add_f32 v22, v22, v30
    v_add_f32 v23, v23, v31
    s_waitcnt vmcnt(24)
    v_lshlrev_b32 v24, 16, v76
    v_and_b32 v25, 0xffff0000, v76
    v_lshlrev_b32 v26, 16, v77
    v_and_b32 v27, 0xffff0000, v77
    v_lshlrev_b32 v28, 16, v78
    v_and_b32 v29, 0xffff0000, v78
    v_lshlrev_b32 v30, 16, v79
    v_and_b32 v31, 0xffff0000, v79
    v_add_f32 v16, v16, v24
    v_add_f32 v17, v17, v25
    v_add_f32 v18, v18, v26
    v_add_f32 v19, v19, v27
    v_add_f32 v20, v20, v28
    v_add_f32 v21, v21, v29
    v_add_f32 v22, v22, v30
    v_add_f32 v23, v23, v31
    s_waitcnt vmcnt(23)
    v_lshlrev_b32 v24, 16, v80
    v_and_b32 v25, 0xffff0000, v80
    v_lshlrev_b32 v26, 16, v81
    v_and_b32 v27, 0xffff0000, v81
    v_lshlrev_b32 v28, 16, v82
    v_and_b32 v29, 0xffff0000, v82
    v_lshlrev_b32 v30, 16, v83
    v_and_b32 v31, 0xffff0000, v83
    v_add_f32 v16, v16, v24
    v_add_f32 v17, v17, v25
    v_add_f32 v18, v18, v26
    v_add_f32 v19, v19, v27
    v_add_f32 v20, v20, v28
    v_add_f32 v21, v21, v29
    v_add_f32 v22, v22, v30
    v_add_f32 v23, v23, v31
    s_waitcnt vmcnt(22)
    v_lshlrev_b32 v24, 16, v84
    v_and_b32 v25, 0xffff0000, v84
    v_lshlrev_b32 v26, 16, v85
    v_and_b32 v27, 0xffff0000, v85
    v_lshlrev_b32 v28, 16, v86
    v_and_b32 v29, 0xffff0000, v86
    v_lshlrev_b32 v30, 16, v87
    v_and_b32 v31, 0xffff0000, v87
    v_add_f32 v16, v16, v24
    v_add_f32 v17, v17, v25
    v_add_f32 v18, v18, v26
    v_add_f32 v19, v19, v27
    v_add_f32 v20, v20, v28
    v_add_f32 v21, v21, v29
    v_add_f32 v22, v22, v30
    v_add_f32 v23, v23, v31
    s_waitcnt vmcnt(21)
    v_lshlrev_b32 v24, 16, v88
    v_and_b32 v25, 0xffff0000, v88
    v_lshlrev_b32 v26, 16, v89
    v_and_b32 v27, 0xffff0000, v89
    v_lshlrev_b32 v28, 16, v90
    v_and_b32 v29, 0xffff0000, v90
    v_lshlrev_b32 v30, 16, v91
    v_and_b32 v31, 0xffff0000, v91
    v_add_f32 v16, v16, v24
    v_add_f32 v17, v17, v25
    v_add_f32 v18, v18, v26
    v_add_f32 v19, v19, v27
    v_add_f32 v20, v20, v28
    v_add_f32 v21, v21, v29
    v_add_f32 v22, v22, v30
    v_add_f32 v23, v23, v31
    s_waitcnt vmcnt(20)
    v_lshlrev_b32 v24, 16, v92
    v_and_b32 v25, 0xffff0000, v92
    v_lshlrev_b32 v26, 16, v93
    v_and_b32 v27, 0xffff0000, v93
    v_lshlrev_b32 v28, 16, v94
    v_and_b32 v29, 0xffff0000, v94
    v_lshlrev_b32 v30, 16, v95
    v_and_b32 v31, 0xffff0000, v95
    v_add_f32 v16, v16, v24
    v_add_f32 v17, v17, v25
    v_add_f32 v18, v18, v26
    v_add_f32 v19, v19, v27
    v_add_f32 v20, v20, v28
    v_add_f32 v21, v21, v29
    v_add_f32 v22, v22, v30
    v_add_f32 v23, v23, v31
    s_waitcnt vmcnt(19)
    v_lshlrev_b32 v24, 16, v96
    v_and_b32 v25, 0xffff0000, v96
    v_lshlrev_b32 v26, 16, v97
    v_and_b32 v27, 0xffff0000, v97
    v_lshlrev_b32 v28, 16, v98
    v_and_b32 v29, 0xffff0000, v98
    v_lshlrev_b32 v30, 16, v99
    v_and_b32 v31, 0xffff0000, v99
    v_add_f32 v16, v16, v24
    v_add_f32 v17, v17, v25
    v_add_f32 v18, v18, v26
    v_add_f32 v19, v19, v27
    v_add_f32 v20, v20, v28
    v_add_f32 v21, v21, v29
    v_add_f32 v22, v22, v30
    v_add_f32 v23, v23, v31
    s_waitcnt vmcnt(18)
    v_lshlrev_b32 v24, 16, v100
    v_and_b32 v25, 0xffff0000, v100
    v_lshlrev_b32 v26, 16, v101
    v_and_b32 v27, 0xffff0000, v101
    v_lshlrev_b32 v28, 16, v102
    v_and_b32 v29, 0xffff0000, v102
    v_lshlrev_b32 v30, 16, v103
    v_and_b32 v31, 0xffff0000, v103
    v_add_f32 v16, v16, v24
    v_add_f32 v17, v17, v25
    v_add_f32 v18, v18, v26
    v_add_f32 v19, v19, v27
    v_add_f32 v20, v20, v28
    v_add_f32 v21, v21, v29
    v_add_f32 v22, v22, v30
    v_add_f32 v23, v23, v31
    s_waitcnt vmcnt(17)
    v_lshlrev_b32 v24, 16, v104
    v_and_b32 v25, 0xffff0000, v104
    v_lshlrev_b32 v26, 16, v105
    v_and_b32 v27, 0xffff0000, v105
    v_lshlrev_b32 v28, 16, v106
    v_and_b32 v29, 0xffff0000, v106
    v_lshlrev_b32 v30, 16, v107
    v_and_b32 v31, 0xffff0000, v107
    v_add_f32 v16, v16, v24
    v_add_f32 v17, v17, v25
    v_add_f32 v18, v18, v26
    v_add_f32 v19, v19, v27
    v_add_f32 v20, v20, v28
    v_add_f32 v21, v21, v29
    v_add_f32 v22, v22, v30
    v_add_f32 v23, v23, v31
    s_waitcnt vmcnt(16)
    v_lshlrev_b32 v24, 16, v108
    v_and_b32 v25, 0xffff0000, v108
    v_lshlrev_b32 v26, 16, v109
    v_and_b32 v27, 0xffff0000, v109
    v_lshlrev_b32 v28, 16, v110
    v_and_b32 v29, 0xffff0000, v110
    v_lshlrev_b32 v30, 16, v111
    v_and_b32 v31, 0xffff0000, v111
    v_add_f32 v16, v16, v24
    v_add_f32 v17, v17, v25
    v_add_f32 v18, v18, v26
    v_add_f32 v19, v19, v27
    v_add_f32 v20, v20, v28
    v_add_f32 v21, v21, v29
    v_add_f32 v22, v22, v30
    v_add_f32 v23, v23, v31
    s_waitcnt vmcnt(15)
    v_lshlrev_b32 v24, 16, v112
    v_and_b32 v25, 0xffff0000, v112
    v_lshlrev_b32 v26, 16, v113
    v_and_b32 v27, 0xffff0000, v113
    v_lshlrev_b32 v28, 16, v114
    v_and_b32 v29, 0xffff0000, v114
    v_lshlrev_b32 v30, 16, v115
    v_and_b32 v31, 0xffff0000, v115
    v_add_f32 v16, v16, v24
    v_add_f32 v17, v17, v25
    v_add_f32 v18, v18, v26
    v_add_f32 v19, v19, v27
    v_add_f32 v20, v20, v28
    v_add_f32 v21, v21, v29
    v_add_f32 v22, v22, v30
    v_add_f32 v23, v23, v31
    s_waitcnt vmcnt(14)
    v_lshlrev_b32 v24, 16, v116
    v_and_b32 v25, 0xffff0000, v116
    v_lshlrev_b32 v26, 16, v117
    v_and_b32 v27, 0xffff0000, v117
    v_lshlrev_b32 v28, 16, v118
    v_and_b32 v29, 0xffff0000, v118
    v_lshlrev_b32 v30, 16, v119
    v_and_b32 v31, 0xffff0000, v119
    v_add_f32 v16, v16, v24
    v_add_f32 v17, v17, v25
    v_add_f32 v18, v18, v26
    v_add_f32 v19, v19, v27
    v_add_f32 v20, v20, v28
    v_add_f32 v21, v21, v29
    v_add_f32 v22, v22, v30
    v_add_f32 v23, v23, v31
    s_waitcnt vmcnt(13)
    v_lshlrev_b32 v24, 16, v120
    v_and_b32 v25, 0xffff0000, v120
    v_lshlrev_b32 v26, 16, v121
    v_and_b32 v27, 0xffff0000, v121
    v_lshlrev_b32 v28, 16, v122
    v_and_b32 v29, 0xffff0000, v122
    v_lshlrev_b32 v30, 16, v123
    v_and_b32 v31, 0xffff0000, v123
    v_add_f32 v16, v16, v24
    v_add_f32 v17, v17, v25
    v_add_f32 v18, v18, v26
    v_add_f32 v19, v19, v27
    v_add_f32 v20, v20, v28
    v_add_f32 v21, v21, v29
    v_add_f32 v22, v22, v30
    v_add_f32 v23, v23, v31
    s_waitcnt vmcnt(12)
    v_lshlrev_b32 v24, 16, v124
    v_and_b32 v25, 0xffff0000, v124
    v_lshlrev_b32 v26, 16, v125
    v_and_b32 v27, 0xffff0000, v125
    v_lshlrev_b32 v28, 16, v126
    v_and_b32 v29, 0xffff0000, v126
    v_lshlrev_b32 v30, 16, v127
    v_and_b32 v31, 0xffff0000, v127
    v_add_f32 v16, v16, v24
    v_add_f32 v17, v17, v25
    v_add_f32 v18, v18, v26
    v_add_f32 v19, v19, v27
    v_add_f32 v20, v20, v28
    v_add_f32 v21, v21, v29
    v_add_f32 v22, v22, v30
    v_add_f32 v23, v23, v31
    s_waitcnt vmcnt(11)
    v_lshlrev_b32 v24, 16, v128
    v_and_b32 v25, 0xffff0000, v128
    v_lshlrev_b32 v26, 16, v129
    v_and_b32 v27, 0xffff0000, v129
    v_lshlrev_b32 v28, 16, v130
    v_and_b32 v29, 0xffff0000, v130
    v_lshlrev_b32 v30, 16, v131
    v_and_b32 v31, 0xffff0000, v131
    v_add_f32 v16, v16, v24
    v_add_f32 v17, v17, v25
    v_add_f32 v18, v18, v26
    v_add_f32 v19, v19, v27
    v_add_f32 v20, v20, v28
    v_add_f32 v21, v21, v29
    v_add_f32 v22, v22, v30
    v_add_f32 v23, v23, v31
    s_waitcnt vmcnt(10)
    v_lshlrev_b32 v24, 16, v132
    v_and_b32 v25, 0xffff0000, v132
    v_lshlrev_b32 v26, 16, v133
    v_and_b32 v27, 0xffff0000, v133
    v_lshlrev_b32 v28, 16, v134
    v_and_b32 v29, 0xffff0000, v134
    v_lshlrev_b32 v30, 16, v135
    v_and_b32 v31, 0xffff0000, v135
    v_add_f32 v16, v16, v24
    v_add_f32 v17, v17, v25
    v_add_f32 v18, v18, v26
    v_add_f32 v19, v19, v27
    v_add_f32 v20, v20, v28
    v_add_f32 v21, v21, v29
    v_add_f32 v22, v22, v30
    v_add_f32 v23, v23, v31
    s_waitcnt vmcnt(9)
    v_lshlrev_b32 v24, 16, v136
    v_and_b32 v25, 0xffff0000, v136
    v_lshlrev_b32 v26, 16, v137
    v_and_b32 v27, 0xffff0000, v137
    v_lshlrev_b32 v28, 16, v138
    v_and_b32 v29, 0xffff0000, v138
    v_lshlrev_b32 v30, 16, v139
    v_and_b32 v31, 0xffff0000, v139
    v_add_f32 v16, v16, v24
    v_add_f32 v17, v17, v25
    v_add_f32 v18, v18, v26
    v_add_f32 v19, v19, v27
    v_add_f32 v20, v20, v28
    v_add_f32 v21, v21, v29
    v_add_f32 v22, v22, v30
    v_add_f32 v23, v23, v31
    s_waitcnt vmcnt(8)
    v_lshlrev_b32 v24, 16, v140
    v_and_b32 v25, 0xffff0000, v140
    v_lshlrev_b32 v26, 16, v141
    v_and_b32 v27, 0xffff0000, v141
    v_lshlrev_b32 v28, 16, v142
    v_and_b32 v29, 0xffff0000, v142
    v_lshlrev_b32 v30, 16, v143
    v_and_b32 v31, 0xffff0000, v143
    v_add_f32 v16, v16, v24
    v_add_f32 v17, v17, v25
    v_add_f32 v18, v18, v26
    v_add_f32 v19, v19, v27
    v_add_f32 v20, v20, v28
    v_add_f32 v21, v21, v29
    v_add_f32 v22, v22, v30
    v_add_f32 v23, v23, v31
    s_waitcnt vmcnt(7)
    v_lshlrev_b32 v24, 16, v144
    v_and_b32 v25, 0xffff0000, v144
    v_lshlrev_b32 v26, 16, v145
    v_and_b32 v27, 0xffff0000, v145
    v_lshlrev_b32 v28, 16, v146
    v_and_b32 v29, 0xffff0000, v146
    v_lshlrev_b32 v30, 16, v147
    v_and_b32 v31, 0xffff0000, v147
    v_add_f32 v16, v16, v24
    v_add_f32 v17, v17, v25
    v_add_f32 v18, v18, v26
    v_add_f32 v19, v19, v27
    v_add_f32 v20, v20, v28
    v_add_f32 v21, v21, v29
    v_add_f32 v22, v22, v30
    v_add_f32 v23, v23, v31
    s_waitcnt vmcnt(6)
    v_lshlrev_b32 v24, 16, v148
    v_and_b32 v25, 0xffff0000, v148
    v_lshlrev_b32 v26, 16, v149
    v_and_b32 v27, 0xffff0000, v149
    v_lshlrev_b32 v28, 16, v150
    v_and_b32 v29, 0xffff0000, v150
    v_lshlrev_b32 v30, 16, v151
    v_and_b32 v31, 0xffff0000, v151
    v_add_f32 v16, v16, v24
    v_add_f32 v17, v17, v25
    v_add_f32 v18, v18, v26
    v_add_f32 v19, v19, v27
    v_add_f32 v20, v20, v28
    v_add_f32 v21, v21, v29
    v_add_f32 v22, v22, v30
    v_add_f32 v23, v23, v31
    s_waitcnt vmcnt(5)
    v_lshlrev_b32 v24, 16, v152
    v_and_b32 v25, 0xffff0000, v152
    v_lshlrev_b32 v26, 16, v153
    v_and_b32 v27, 0xffff0000, v153
    v_lshlrev_b32 v28, 16, v154
    v_and_b32 v29, 0xffff0000, v154
    v_lshlrev_b32 v30, 16, v155
    v_and_b32 v31, 0xffff0000, v155
    v_add_f32 v16, v16, v24
    v_add_f32 v17, v17, v25
    v_add_f32 v18, v18, v26
    v_add_f32 v19, v19, v27
    v_add_f32 v20, v20, v28
    v_add_f32 v21, v21, v29
    v_add_f32 v22, v22, v30
    v_add_f32 v23, v23, v31
    s_waitcnt vmcnt(4)
    v_lshlrev_b32 v24, 16, v156
    v_and_b32 v25, 0xffff0000, v156
    v_lshlrev_b32 v26, 16, v157
    v_and_b32 v27, 0xffff0000, v157
    v_lshlrev_b32 v28, 16, v158
    v_and_b32 v29, 0xffff0000, v158
    v_lshlrev_b32 v30, 16, v159
    v_and_b32 v31, 0xffff0000, v159
    v_add_f32 v16, v16, v24
    v_add_f32 v17, v17, v25
    v_add_f32 v18, v18, v26
    v_add_f32 v19, v19, v27
    v_add_f32 v20, v20, v28
    v_add_f32 v21, v21, v29
    v_add_f32 v22, v22, v30
    v_add_f32 v23, v23, v31
    s_waitcnt vmcnt(3)
    v_lshlrev_b32 v24, 16, v160
    v_and_b32 v25, 0xffff0000, v160
    v_lshlrev_b32 v26, 16, v161
    v_and_b32 v27, 0xffff0000, v161
    v_lshlrev_b32 v28, 16, v162
    v_and_b32 v29, 0xffff0000, v162
    v_lshlrev_b32 v30, 16, v163
    v_and_b32 v31, 0xffff0000, v163
    v_add_f32 v16, v16, v24
    v_add_f32 v17, v17, v25
    v_add_f32 v18, v18, v26
    v_add_f32 v19, v19, v27
    v_add_f32 v20, v20, v28
    v_add_f32 v21, v21, v29
    v_add_f32 v22, v22, v30
    v_add_f32 v23, v23, v31
    s_waitcnt vmcnt(2)
    v_lshlrev_b32 v24, 16, v164
    v_and_b32 v25, 0xffff0000, v164
    v_lshlrev_b32 v26, 16, v165
    v_and_b32 v27, 0xffff0000, v165
    v_lshlrev_b32 v28, 16, v166
    v_and_b32 v29, 0xffff0000, v166
    v_lshlrev_b32 v30, 16, v167
    v_and_b32 v31, 0xffff0000, v167
    v_add_f32 v16, v16, v24
    v_add_f32 v17, v17, v25
    v_add_f32 v18, v18, v26
    v_add_f32 v19, v19, v27
    v_add_f32 v20, v20, v28
    v_add_f32 v21, v21, v29
    v_add_f32 v22, v22, v30
    v_add_f32 v23, v23, v31
    s_waitcnt vmcnt(1)
    v_lshlrev_b32 v24, 16, v168
    v_and_b32 v25, 0xffff0000, v168
    v_lshlrev_b32 v26, 16, v169
    v_and_b32 v27, 0xffff0000, v169
    v_lshlrev_b32 v28, 16, v170
    v_and_b32 v29, 0xffff0000, v170
    v_lshlrev_b32 v30, 16, v171
    v_and_b32 v31, 0xffff0000, v171
    v_add_f32 v16, v16, v24
    v_add_f32 v17, v17, v25
    v_add_f32 v18, v18, v26
    v_add_f32 v19, v19, v27
    v_add_f32 v20, v20, v28
    v_add_f32 v21, v21, v29
    v_add_f32 v22, v22, v30
    v_add_f32 v23, v23, v31
    s_waitcnt vmcnt(0)
    v_lshlrev_b32 v24, 16, v172
    v_and_b32 v25, 0xffff0000, v172
    v_lshlrev_b32 v26, 16, v173
    v_and_b32 v27, 0xffff0000, v173
    v_lshlrev_b32 v28, 16, v174
    v_and_b32 v29, 0xffff0000, v174
    v_lshlrev_b32 v30, 16, v175
    v_and_b32 v31, 0xffff0000, v175
    v_add_f32 v16, v16, v24
    v_add_f32 v17, v17, v25
    v_add_f32 v18, v18, v26
    v_add_f32 v19, v19, v27
    v_add_f32 v20, v20, v28
    v_add_f32 v21, v21, v29
    v_add_f32 v22, v22, v30
    v_add_f32 v23, v23, v31
    v_lshrrev_b32 v6, 4, v1
    s_lshl_b32 s35, s3, 2
    v_add_u32 v6, s35, v6
    v_lshlrev_b32 v6, 9, v6
    v_lshl_add_u32 v6, v5, 5, v6
    ds_write_b128 v6, v[16:19]
    ds_write_b128 v6, v[20:23] offset:16
    s_waitcnt lgkmcnt(0)
    s_barrier
    s_cmp_ge_u32 s3, 2
    s_cbranch_scc1 k3_wo_kernel_end
    v_lshlrev_b32 v6, 2, v0
    ds_read_b32 v32, v6 offset:0
    ds_read_b32 v33, v6 offset:512
    ds_read_b32 v34, v6 offset:1024
    ds_read_b32 v35, v6 offset:1536
    ds_read_b32 v36, v6 offset:2048
    ds_read_b32 v37, v6 offset:2560
    ds_read_b32 v38, v6 offset:3072
    ds_read_b32 v39, v6 offset:3584
    ds_read_b32 v40, v6 offset:4096
    ds_read_b32 v41, v6 offset:4608
    ds_read_b32 v42, v6 offset:5120
    ds_read_b32 v43, v6 offset:5632
    ds_read_b32 v44, v6 offset:6144
    ds_read_b32 v45, v6 offset:6656
    ds_read_b32 v46, v6 offset:7168
    ds_read_b32 v47, v6 offset:7680
    s_add_u32 s12, s28, 0x1240000
    s_addc_u32 s13, s29, 0
    s_mov_b32 s14, 0x3800
    s_mov_b32 s15, 0x00020000
    s_mul_i32 s35, s33, 7168
    s_lshl_b32 s36, s32, 9
    s_add_u32 s35, s35, s36
    s_waitcnt lgkmcnt(0)
    v_add_f32 v32, v32, v40
    v_add_f32 v33, v33, v41
    v_add_f32 v34, v34, v42
    v_add_f32 v35, v35, v43
    v_add_f32 v36, v36, v44
    v_add_f32 v37, v37, v45
    v_add_f32 v38, v38, v46
    v_add_f32 v39, v39, v47
    v_add_f32 v32, v32, v36
    v_add_f32 v33, v33, v37
    v_add_f32 v34, v34, v38
    v_add_f32 v35, v35, v39
    v_add_f32 v32, v32, v34
    v_add_f32 v33, v33, v35
    v_add_f32 v32, v32, v33
    buffer_store_dword v32, v6, s[12:15], s35 offen
    s_branch k3_wo_kernel_end
k3_wo_kernel_fin:
k3_wo_kernel_end:
    s_endpgm
.globl k4_ffn_kernel
.p2align 8
.type k4_ffn_kernel,@function
k4_ffn_kernel:
    s_cmp_ge_u32 s2, 224
    s_cbranch_scc1 k4_ffn_kernel_end
    s_load_dwordx2 s[28:29], s[0:1], 72
    s_load_dwordx2 s[4:5], s[0:1], 32
    s_load_dwordx2 s[6:7], s[0:1], 40
    s_load_dwordx2 s[50:51], s[0:1], 48
    v_and_b32 v1, 63, v0
    v_lshrrev_b32 v2, 6, v0
    s_and_b32 s30, s2, 7
    s_lshr_b32 s31, s2, 3
    v_readfirstlane_b32 s3, v2
    s_and_b32 s32, s30, 3
    s_lshl_b32 s32, s32, 2
    s_and_b32 s33, s31, 3
    s_add_u32 s32, s32, s33
    s_lshr_b32 s30, s30, 2
    s_mul_i32 s30, s30, 7
    s_lshr_b32 s31, s31, 2
    s_lshl_b32 s47, s33, 1
    s_add_u32 s47, s47, s31
    s_cmp_ge_u32 s47, 7
    s_cselect_b32 s48, 7, 0
    s_sub_u32 s47, s47, s48
    s_add_u32 s31, s31, s30
    s_mov_b32 s30, s32
    s_lshr_b32 s32, s3, 2
    s_and_b32 s33, s3, 3
    v_lshlrev_b32 v3, 4, v1
    v_and_b32 v12, 31, v1
    v_lshrrev_b32 v8, 5, v1
    v_lshrrev_b32 v4, 4, v1
    v_and_b32 v5, 15, v1
    v_lshlrev_b32 v6, 2, v4
    v_xor_b32 v5, v5, v6
    s_movk_i32 s44, 3584
    v_mul_u32_u24 v4, s44, v4
    v_lshl_add_u32 v4, v5, 4, v4
    s_lshl_b32 s36, s3, 10
    s_lshl_b32 s37, s30, 2
    s_add_u32 s37, s37, s32
    s_mul_i32 s37, s37, 28
    s_add_u32 s37, s37, s33
    s_lshl_b32 s37, s37, 10
    s_mul_i32 s38, s3, 14336
    s_lshl_b32 s39, s31, 8
    s_add_u32 s38, s38, s39
    s_lshl_b32 s48, s47, 12
    s_add_u32 s37, s37, s48
    s_mul_i32 s48, s47, 229376
    s_add_u32 s38, s38, s48
    s_waitcnt lgkmcnt(0)
    s_add_u32 s8, s28, 0x800000
    s_addc_u32 s9, s29, 0
    s_mov_b32 s10, 0x1c0000
    s_mov_b32 s11, 0x00020000
    s_mov_b32 s12, s4
    s_mov_b32 s13, s5
    s_mov_b32 s14, 0x188000
    s_mov_b32 s15, 0x00020000
    s_mov_b32 s16, s6
    s_mov_b32 s17, s7
    s_mov_b32 s18, 0x188000
    s_mov_b32 s19, 0x00020000
    s_add_u32 m0, s36, 0
    s_add_u32 s39, s37, 57344
    buffer_load_dwordx4 v3, s[8:11], s37 offen lds
    s_add_u32 m0, s36, 8192
    s_add_u32 s37, s37, 4096
    buffer_load_dwordx4 v3, s[8:11], s39 offen lds
    s_add_u32 m0, s36, 16384
    s_add_u32 s39, s38, 114688
    buffer_load_dwordx4 v4, s[12:15], s38 offen lds
    s_add_u32 m0, s36, 24576
    s_nop 0
    buffer_load_dwordx4 v4, s[12:15], s39 offen lds
    s_add_u32 m0, s36, 32768
    s_add_u32 s39, s38, 114688
    buffer_load_dwordx4 v4, s[16:19], s38 offen lds
    s_add_u32 m0, s36, 40960
    s_nop 0
    buffer_load_dwordx4 v4, s[16:19], s39 offen lds
    s_add_u32 s38, s38, 229376
    s_add_u32 s47, s47, 1
    s_cmp_eq_u32 s47, 7
    s_cselect_b32 s48, 28672, 0
    s_cselect_b32 s49, 1605632, 0
    s_sub_u32 s37, s37, s48
    s_sub_u32 s38, s38, s49
    s_barrier
    s_add_u32 s20, s28, 0x1200000
    s_addc_u32 s21, s29, 0
    s_mov_b32 s22, 0x38000
    s_mov_b32 s23, 0x00020000
    s_add_u32 s24, s28, 0xa00000
    s_addc_u32 s25, s29, 0
    s_mov_b32 s26, 0x700000
    s_mov_b32 s27, 0x00020000
    s_add_u32 s52, s28, 0x1240000
    s_addc_u32 s53, s29, 0
    s_mov_b32 s54, 0x3800
    s_mov_b32 s55, 0x00020000
    s_lshl_b32 s34, s30, 7
    s_lshl_b32 s35, s32, 6
    s_add_u32 s34, s34, s35
    v_add_u32 v5, s34, v1
    v_lshlrev_b32 v5, 3, v5
    s_lshl_b32 s40, s33, 14
    buffer_load_dwordx2 v[36:37], v5, s[20:23], s40 offen
    s_add_u32 s40, s40, 65536
    buffer_load_dwordx2 v[38:39], v5, s[20:23], s40 offen
    s_add_u32 s40, s40, 65536
    buffer_load_dwordx2 v[40:41], v5, s[20:23], s40 offen
    s_add_u32 s40, s40, 65536
    buffer_load_dwordx2 v[42:43], v5, s[20:23], s40 offen
    v_lshlrev_b32 v16, 3, v0
    v_add_u32 v16, 147456, v16
    s_lshl_b32 s40, s32, 11
    v_lshlrev_b32 v17, 3, v1
    v_add_u32 v17, s40, v17
    v_add_u32 v17, 147456, v17
    s_lshl_b32 s40, s32, 13
    v_add_u32 v20, s40, v3
    v_add_u32 v21, 49152, v20
    v_add_u32 v22, 98304, v20
    v_bfe_u32 v9, v1, 2, 2
    v_lshl_add_u32 v10, v8, 2, v9
    v_lshlrev_b32 v10, 8, v10
    v_xor_b32 v11, s33, v9
    v_lshl_add_u32 v10, v11, 6, v10
    v_bfe_u32 v11, v1, 4, 1
    v_lshl_add_u32 v10, v11, 5, v10
    v_and_b32 v11, 3, v1
    v_lshl_add_u32 v24, v11, 3, v10
    v_add_u32 v25, 49152, v24
    v_add_u32 v26, 98304, v24
    v_lshlrev_b32 v6, 4, v8
    s_lshl_b32 s41, s31, 9
    s_lshl_b32 s42, s33, 7
    s_add_u32 s41, s41, s42
    s_add_u32 s42, s41, 7168
    s_waitcnt vmcnt(4) lgkmcnt(0)
    s_barrier
    ds_read_b128 v[64:67], v20 offset:0
    ds_read_b128 v[68:71], v20 offset:4096
    ds_read_b64_tr_b16 v[72:73], v24 offset:16384
    ds_read_b64_tr_b16 v[74:75], v24 offset:18432
    ds_read_b64_tr_b16 v[76:77], v24 offset:32768
    ds_read_b64_tr_b16 v[78:79], v24 offset:34816
    ds_read_b128 v[80:83], v20 offset:1024
    ds_read_b128 v[84:87], v20 offset:5120
    ds_read_b64_tr_b16 v[88:89], v24 offset:20480
    ds_read_b64_tr_b16 v[90:91], v24 offset:22528
    ds_read_b64_tr_b16 v[92:93], v24 offset:36864
    ds_read_b64_tr_b16 v[94:95], v24 offset:38912
    ds_read_b128 v[96:99], v20 offset:2048
    ds_read_b128 v[100:103], v20 offset:6144
    ds_read_b64_tr_b16 v[104:105], v24 offset:24576
    ds_read_b64_tr_b16 v[106:107], v24 offset:26624
    ds_read_b64_tr_b16 v[108:109], v24 offset:40960
    ds_read_b64_tr_b16 v[110:111], v24 offset:43008
    ds_read_b128 v[112:115], v20 offset:3072
    ds_read_b128 v[116:119], v20 offset:7168
    ds_read_b64_tr_b16 v[120:121], v24 offset:28672
    ds_read_b64_tr_b16 v[122:123], v24 offset:30720
    ds_read_b64_tr_b16 v[124:125], v24 offset:45056
    ds_read_b64_tr_b16 v[126:127], v24 offset:47104
    s_add_u32 m0, s36, 49152
    s_add_u32 s39, s37, 57344
    buffer_load_dwordx4 v3, s[8:11], s37 offen lds
    s_add_u32 m0, s36, 57344
    s_add_u32 s37, s37, 4096
    buffer_load_dwordx4 v3, s[8:11], s39 offen lds
    s_waitcnt lgkmcnt(0)
    v_mfma_f32_32x32x16_bf16 v[192:207], v[72:75], v[64:67], 0
    s_add_u32 m0, s36, 65536
    s_add_u32 s39, s38, 114688
    buffer_load_dwordx4 v4, s[12:15], s38 offen lds
    v_mfma_f32_32x32x16_bf16 v[208:223], v[76:79], v[64:67], 0
    s_add_u32 m0, s36, 73728
    s_nop 0
    buffer_load_dwordx4 v4, s[12:15], s39 offen lds
    v_mfma_f32_32x32x16_bf16 v[224:239], v[72:75], v[68:71], 0
    s_add_u32 m0, s36, 81920
    s_add_u32 s39, s38, 114688
    buffer_load_dwordx4 v4, s[16:19], s38 offen lds
    v_mfma_f32_32x32x16_bf16 v[240:255], v[76:79], v[68:71], 0
    s_add_u32 m0, s36, 90112
    s_nop 0
    buffer_load_dwordx4 v4, s[16:19], s39 offen lds
    s_add_u32 s38, s38, 229376
    s_add_u32 s47, s47, 1
    s_cmp_eq_u32 s47, 7
    s_cselect_b32 s48, 28672, 0
    s_cselect_b32 s49, 1605632, 0
    s_sub_u32 s37, s37, s48
    s_sub_u32 s38, s38, s49
    v_mfma_f32_32x32x16_bf16 v[192:207], v[88:91], v[80:83], v[192:207]
    v_mfma_f32_32x32x16_bf16 v[208:223], v[92:95], v[80:83], v[208:223]
    v_mfma_f32_32x32x16_bf16 v[224:239], v[88:91], v[84:87], v[224:239]
    v_mfma_f32_32x32x16_bf16 v[240:255], v[92:95], v[84:87], v[240:255]
    s_add_u32 m0, s36, 98304
    s_add_u32 s39, s37, 57344
    buffer_load_dwordx4 v3, s[8:11], s37 offen lds
    s_add_u32 m0, s36, 106496
    s_add_u32 s37, s37, 4096
    buffer_load_dwordx4 v3, s[8:11], s39 offen lds
    s_add_u32 m0, s36, 114688
    s_add_u32 s39, s38, 114688
    buffer_load_dwordx4 v4, s[12:15], s38 offen lds
    s_add_u32 m0, s36, 122880
    s_nop 0
    buffer_load_dwordx4 v4, s[12:15], s39 offen lds
    s_add_u32 m0, s36, 131072
    s_add_u32 s39, s38, 114688
    buffer_load_dwordx4 v4, s[16:19], s38 offen lds
    s_add_u32 m0, s36, 139264
    s_nop 0
    buffer_load_dwordx4 v4, s[16:19], s39 offen lds
    s_add_u32 s38, s38, 229376
    s_add_u32 s47, s47, 1
    s_cmp_eq_u32 s47, 7
    s_cselect_b32 s48, 28672, 0
    s_cselect_b32 s49, 1605632, 0
    s_sub_u32 s37, s37, s48
    s_sub_u32 s38, s38, s49
    s_waitcnt vmcnt(6) lgkmcnt(0)
    s_barrier
    v_mfma_f32_32x32x16_bf16 v[192:207], v[104:107], v[96:99], v[192:207]
    ds_read_b128 v[128:131], v21 offset:0
    ds_read_b128 v[132:135], v21 offset:4096
    ds_read_b64_tr_b16 v[136:137], v25 offset:16384
    v_mfma_f32_32x32x16_bf16 v[208:223], v[108:111], v[96:99], v[208:223]
    ds_read_b64_tr_b16 v[138:139], v25 offset:18432
    ds_read_b64_tr_b16 v[140:141], v25 offset:32768
    ds_read_b64_tr_b16 v[142:143], v25 offset:34816
    v_mfma_f32_32x32x16_bf16 v[224:239], v[104:107], v[100:103], v[224:239]
    ds_read_b128 v[144:147], v21 offset:1024
    ds_read_b128 v[148:151], v21 offset:5120
    ds_read_b64_tr_b16 v[152:153], v25 offset:20480
    v_mfma_f32_32x32x16_bf16 v[240:255], v[108:111], v[100:103], v[240:255]
    ds_read_b64_tr_b16 v[154:155], v25 offset:22528
    ds_read_b64_tr_b16 v[156:157], v25 offset:36864
    ds_read_b64_tr_b16 v[158:159], v25 offset:38912
    v_mfma_f32_32x32x16_bf16 v[192:207], v[120:123], v[112:115], v[192:207]
    ds_read_b128 v[160:163], v21 offset:2048
    ds_read_b128 v[164:167], v21 offset:6144
    ds_read_b64_tr_b16 v[168:169], v25 offset:24576
    v_mfma_f32_32x32x16_bf16 v[208:223], v[124:127], v[112:115], v[208:223]
    ds_read_b64_tr_b16 v[170:171], v25 offset:26624
    ds_read_b64_tr_b16 v[172:173], v25 offset:40960
    ds_read_b64_tr_b16 v[174:175], v25 offset:43008
    v_mfma_f32_32x32x16_bf16 v[224:239], v[120:123], v[116:119], v[224:239]
    ds_read_b128 v[176:179], v21 offset:3072
    ds_read_b128 v[180:183], v21 offset:7168
    ds_read_b64_tr_b16 v[184:185], v25 offset:28672
    v_mfma_f32_32x32x16_bf16 v[240:255], v[124:127], v[116:119], v[240:255]
    ds_read_b64_tr_b16 v[186:187], v25 offset:30720
    ds_read_b64_tr_b16 v[188:189], v25 offset:45056
    ds_read_b64_tr_b16 v[190:191], v25 offset:47104
    v_add_f32 v36, v36, v38
    v_add_f32 v37, v37, v39
    v_add_f32 v40, v40, v42
    v_add_f32 v41, v41, v43
    v_add_f32 v36, v36, v40
    v_add_f32 v37, v37, v41
    ds_write_b64 v16, v[36:37]
    s_add_u32 m0, s36, 0
    s_add_u32 s39, s37, 57344
    buffer_load_dwordx4 v3, s[8:11], s37 offen lds
    s_add_u32 m0, s36, 8192
    s_add_u32 s37, s37, 4096
    buffer_load_dwordx4 v3, s[8:11], s39 offen lds
    s_add_u32 m0, s36, 16384
    s_add_u32 s39, s38, 114688
    buffer_load_dwordx4 v4, s[12:15], s38 offen lds
    s_add_u32 m0, s36, 24576
    s_nop 0
    buffer_load_dwordx4 v4, s[12:15], s39 offen lds
    s_add_u32 m0, s36, 32768
    s_add_u32 s39, s38, 114688
    buffer_load_dwordx4 v4, s[16:19], s38 offen lds
    s_add_u32 m0, s36, 40960
    s_nop 0
    buffer_load_dwordx4 v4, s[16:19], s39 offen lds
    s_add_u32 s38, s38, 229376
    s_add_u32 s47, s47, 1
    s_cmp_eq_u32 s47, 7
    s_cselect_b32 s48, 28672, 0
    s_cselect_b32 s49, 1605632, 0
    s_sub_u32 s37, s37, s48
    s_sub_u32 s38, s38, s49
    s_waitcnt vmcnt(6) lgkmcnt(0)
    s_barrier
    v_mfma_f32_32x32x16_bf16 v[192:207], v[136:139], v[128:131], v[192:207]
    s_add_u32 m0, s36, 49152
    s_add_u32 s39, s37, 57344
    buffer_load_dwordx4 v3, s[8:11], s37 offen lds
    ds_read_b128 v[64:67], v22 offset:0
    ds_read_b128 v[68:71], v22 offset:4096
    v_mfma_f32_32x32x16_bf16 v[208:223], v[140:143], v[128:131], v[208:223]
    s_add_u32 m0, s36, 57344
    s_add_u32 s37, s37, 4096
    buffer_load_dwordx4 v3, s[8:11], s39 offen lds
    ds_read_b64_tr_b16 v[72:73], v26 offset:16384
    ds_read_b64_tr_b16 v[74:75], v26 offset:18432
    v_mfma_f32_32x32x16_bf16 v[224:239], v[136:139], v[132:135], v[224:239]
    s_add_u32 m0, s36, 65536
    s_add_u32 s39, s38, 114688
    buffer_load_dwordx4 v4, s[12:15], s38 offen lds
    ds_read_b64_tr_b16 v[76:77], v26 offset:32768
    ds_read_b64_tr_b16 v[78:79], v26 offset:34816
    v_mfma_f32_32x32x16_bf16 v[240:255], v[140:143], v[132:135], v[240:255]
    s_add_u32 m0, s36, 73728
    s_nop 0
    buffer_load_dwordx4 v4, s[12:15], s39 offen lds
    ds_read_b128 v[80:83], v22 offset:1024
    ds_read_b128 v[84:87], v22 offset:5120
    v_mfma_f32_32x32x16_bf16 v[192:207], v[152:155], v[144:147], v[192:207]
    s_add_u32 m0, s36, 81920
    s_add_u32 s39, s38, 114688
    buffer_load_dwordx4 v4, s[16:19], s38 offen lds
    ds_read_b64_tr_b16 v[88:89], v26 offset:20480
    ds_read_b64_tr_b16 v[90:91], v26 offset:22528
    v_mfma_f32_32x32x16_bf16 v[208:223], v[156:159], v[144:147], v[208:223]
    s_add_u32 m0, s36, 90112
    s_nop 0
    buffer_load_dwordx4 v4, s[16:19], s39 offen lds
    s_add_u32 s38, s38, 229376
    s_add_u32 s47, s47, 1
    s_cmp_eq_u32 s47, 7
    s_cselect_b32 s48, 28672, 0
    s_cselect_b32 s49, 1605632, 0
    s_sub_u32 s37, s37, s48
    s_sub_u32 s38, s38, s49
    ds_read_b64_tr_b16 v[92:93], v26 offset:36864
    ds_read_b64_tr_b16 v[94:95], v26 offset:38912
    v_mfma_f32_32x32x16_bf16 v[224:239], v[152:155], v[148:151], v[224:239]
    ds_read_b128 v[96:99], v22 offset:2048
    ds_read_b128 v[100:103], v22 offset:6144
    ds_read_b64 v[44:45], v17 offset:0
    ds_read_b64 v[46:47], v17 offset:512
    v_mfma_f32_32x32x16_bf16 v[240:255], v[156:159], v[148:151], v[240:255]
    ds_read_b64_tr_b16 v[104:105], v26 offset:24576
    ds_read_b64_tr_b16 v[106:107], v26 offset:26624
    ds_read_b64 v[48:49], v17 offset:1024
    ds_read_b64 v[50:51], v17 offset:1536
    v_mfma_f32_32x32x16_bf16 v[192:207], v[168:171], v[160:163], v[192:207]
    ds_read_b64_tr_b16 v[108:109], v26 offset:40960
    ds_read_b64_tr_b16 v[110:111], v26 offset:43008
    s_add_u32 s62, s28, 19136512
    s_addc_u32 s63, s29, 0
    v_mfma_f32_32x32x16_bf16 v[208:223], v[172:175], v[160:163], v[208:223]
    ds_read_b128 v[112:115], v22 offset:3072
    ds_read_b128 v[116:119], v22 offset:7168
    s_add_u32 s62, s62, s41
    s_addc_u32 s63, s63, 0
    v_mfma_f32_32x32x16_bf16 v[224:239], v[168:171], v[164:167], v[224:239]
    ds_read_b64_tr_b16 v[120:121], v26 offset:28672
    ds_read_b64_tr_b16 v[122:123], v26 offset:30720
    s_load_dwordx16 s[64:79], s[62:63], 0
    s_load_dwordx8 s[80:87], s[62:63], 64
    v_mfma_f32_32x32x16_bf16 v[240:255], v[172:175], v[164:167], v[240:255]
    ds_read_b64_tr_b16 v[124:125], v26 offset:45056
    ds_read_b64_tr_b16 v[126:127], v26 offset:47104
    s_load_dwordx8 s[92:99], s[62:63], 96
    v_mfma_f32_32x32x16_bf16 v[192:207], v[184:187], v[176:179], v[192:207]
    v_mfma_f32_32x32x16_bf16 v[208:223], v[188:191], v[176:179], v[208:223]
    v_mfma_f32_32x32x16_bf16 v[224:239], v[184:187], v[180:183], v[224:239]
    v_mfma_f32_32x32x16_bf16 v[240:255], v[188:191], v[180:183], v[240:255]
    s_waitcnt vmcnt(6) lgkmcnt(0)
    s_barrier
    v_mfma_f32_32x32x16_bf16 v[192:207], v[72:75], v[64:67], v[192:207]
    s_add_u32 m0, s36, 98304
    s_add_u32 s39, s37, 57344
    buffer_load_dwordx4 v3, s[8:11], s37 offen lds
    ds_read_b128 v[128:131], v20 offset:0
    ds_read_b128 v[132:135], v20 offset:4096
    v_mfma_f32_32x32x16_bf16 v[208:223], v[76:79], v[64:67], v[208:223]
    s_add_u32 m0, s36, 106496
    s_add_u32 s37, s37, 4096
    buffer_load_dwordx4 v3, s[8:11], s39 offen lds
    ds_read_b64_tr_b16 v[136:137], v24 offset:16384
    ds_read_b64_tr_b16 v[138:139], v24 offset:18432
    v_mfma_f32_32x32x16_bf16 v[224:239], v[72:75], v[68:71], v[224:239]
    s_add_u32 m0, s36, 114688
    s_add_u32 s39, s38, 114688
    buffer_load_dwordx4 v4, s[12:15], s38 offen lds
    ds_read_b64_tr_b16 v[140:141], v24 offset:32768
    ds_read_b64_tr_b16 v[142:143], v24 offset:34816
    v_mfma_f32_32x32x16_bf16 v[240:255], v[76:79], v[68:71], v[240:255]
    s_add_u32 m0, s36, 122880
    s_nop 0
    buffer_load_dwordx4 v4, s[12:15], s39 offen lds
    ds_read_b128 v[144:147], v20 offset:1024
    ds_read_b128 v[148:151], v20 offset:5120
    v_mfma_f32_32x32x16_bf16 v[192:207], v[88:91], v[80:83], v[192:207]
    s_add_u32 m0, s36, 131072
    s_add_u32 s39, s38, 114688
    buffer_load_dwordx4 v4, s[16:19], s38 offen lds
    ds_read_b64_tr_b16 v[152:153], v24 offset:20480
    ds_read_b64_tr_b16 v[154:155], v24 offset:22528
    v_mfma_f32_32x32x16_bf16 v[208:223], v[92:95], v[80:83], v[208:223]
    s_add_u32 m0, s36, 139264
    s_nop 0
    buffer_load_dwordx4 v4, s[16:19], s39 offen lds
    s_add_u32 s38, s38, 229376
    s_add_u32 s47, s47, 1
    s_cmp_eq_u32 s47, 7
    s_cselect_b32 s48, 28672, 0
    s_cselect_b32 s49, 1605632, 0
    s_sub_u32 s37, s37, s48
    s_sub_u32 s38, s38, s49
    ds_read_b64_tr_b16 v[156:157], v24 offset:36864
    ds_read_b64_tr_b16 v[158:159], v24 offset:38912
    v_mfma_f32_32x32x16_bf16 v[224:239], v[88:91], v[84:87], v[224:239]
    ds_read_b128 v[160:163], v20 offset:2048
    ds_read_b128 v[164:167], v20 offset:6144
    v_add_f32 v44, v44, v46
    v_add_f32 v45, v45, v47
    v_add_f32 v48, v48, v50
    v_add_f32 v49, v49, v51
    v_add_f32 v36, v44, v48
    v_mfma_f32_32x32x16_bf16 v[240:255], v[92:95], v[84:87], v[240:255]
    ds_read_b64_tr_b16 v[168:169], v24 offset:24576
    ds_read_b64_tr_b16 v[170:171], v24 offset:26624
    v_add_f32 v37, v45, v49
    s_mov_b32 s40, 0x3b124925
    v_mul_f32 v13, s40, v36
    v_mul_f32 v14, s40, v37
    v_fma_f32 v14, -v13, v13, v14
    v_mfma_f32_32x32x16_bf16 v[192:207], v[104:107], v[96:99], v[192:207]
    ds_read_b64_tr_b16 v[172:173], v24 offset:40960
    ds_read_b64_tr_b16 v[174:175], v24 offset:43008
    v_max_f32 v14, 0, v14
    v_add_f32 v34, 0x3727c5ac, v14
    v_rsq_f32 v15, v34
    v_sub_f32 v28, 0, v13
    v_mul_f32 v7, v15, v15
    v_mfma_f32_32x32x16_bf16 v[208:223], v[108:111], v[96:99], v[208:223]
    ds_read_b128 v[176:179], v20 offset:3072
    ds_read_b128 v[180:183], v20 offset:7168
    v_mul_f32 v7, v7, v15
    v_mul_f32 v30, 0xc0135761, v15
    v_mul_f32 v32, 0xbdd2d3e8, v7
    v_mov_b32 v29, v28
    v_mov_b32 v31, v30
    v_mfma_f32_32x32x16_bf16 v[224:239], v[104:107], v[100:103], v[224:239]
    ds_read_b64_tr_b16 v[184:185], v24 offset:28672
    ds_read_b64_tr_b16 v[186:187], v24 offset:30720
    v_mov_b32 v33, v32
    v_mov_b32 v35, v34
    s_nop 1
    v_permlane32_swap_b32 v34, v35
    v_permlane32_swap_b32 v28, v29
    v_mfma_f32_32x32x16_bf16 v[240:255], v[108:111], v[100:103], v[240:255]
    ds_read_b64_tr_b16 v[188:189], v24 offset:45056
    ds_read_b64_tr_b16 v[190:191], v24 offset:47104
    v_permlane32_swap_b32 v30, v31
    v_permlane32_swap_b32 v32, v33
  v_mov_b32 v36, s64
  v_mov_b32 v37, s65
  v_mov_b32 v38, s66
    v_mfma_f32_32x32x16_bf16 v[192:207], v[120:123], v[112:115], v[192:207]
  v_mov_b32 v39, s67
  s_mov_b32 exec_lo, 0
  v_mov_b32 v36, s68
  v_mov_b32 v37, s69
  v_mov_b32 v38, s70
  v_mov_b32 v39, s71
  s_mov_b32 exec_lo, -1
  v_mov_b32 v40, s72
  v_mov_b32 v41, s73
  v_mov_b32 v42, s74
    v_mfma_f32_32x32x16_bf16 v[208:223], v[124:127], v[112:115], v[208:223]
  v_mov_b32 v43, s75
  s_mov_b32 exec_lo, 0
  v_mov_b32 v40, s76
  v_mov_b32 v41, s77
  v_mov_b32 v42, s78
  v_mov_b32 v43, s79
  s_mov_b32 exec_lo, -1
  v_mov_b32 v44, s80
  v_mov_b32 v45, s81
  v_mov_b32 v46, s82
    v_mfma_f32_32x32x16_bf16 v[224:239], v[120:123], v[116:119], v[224:239]
  v_mov_b32 v47, s83
  s_mov_b32 exec_lo, 0
  v_mov_b32 v44, s84
  v_mov_b32 v45, s85
  v_mov_b32 v46, s86
  v_mov_b32 v47, s87
  s_mov_b32 exec_lo, -1
  v_mov_b32 v48, s92
  v_mov_b32 v49, s93
  v_mov_b32 v50, s94
    v_mfma_f32_32x32x16_bf16 v[240:255], v[124:127], v[116:119], v[240:255]
  v_mov_b32 v51, s95
  s_mov_b32 exec_lo, 0
  v_mov_b32 v48, s96
  v_mov_b32 v49, s97
  v_mov_b32 v50, s98
  v_mov_b32 v51, s99
  s_mov_b32 exec_lo, -1
    s_waitcnt vmcnt(6) lgkmcnt(0)
    s_barrier
    v_mfma_f32_32x32x16_bf16 v[192:207], v[136:139], v[128:131], v[192:207]
    s_add_u32 m0, s36, 0
    s_add_u32 s39, s37, 57344
    buffer_load_dwordx4 v3, s[8:11], s37 offen lds
    ds_read_b128 v[64:67], v21 offset:0
    ds_read_b128 v[68:71], v21 offset:4096
    v_mfma_f32_32x32x16_bf16 v[208:223], v[140:143], v[128:131], v[208:223]
    s_add_u32 m0, s36, 8192
    s_add_u32 s37, s37, 4096
    buffer_load_dwordx4 v3, s[8:11], s39 offen lds
    ds_read_b64_tr_b16 v[72:73], v25 offset:16384
    ds_read_b64_tr_b16 v[74:75], v25 offset:18432
    v_mfma_f32_32x32x16_bf16 v[224:239], v[136:139], v[132:135], v[224:239]
    s_add_u32 m0, s36, 16384
    s_add_u32 s39, s38, 114688
    buffer_load_dwordx4 v4, s[12:15], s38 offen lds
    ds_read_b64_tr_b16 v[76:77], v25 offset:32768
    ds_read_b64_tr_b16 v[78:79], v25 offset:34816
    v_mfma_f32_32x32x16_bf16 v[240:255], v[140:143], v[132:135], v[240:255]
    s_add_u32 m0, s36, 24576
    s_nop 0
    buffer_load_dwordx4 v4, s[12:15], s39 offen lds
    ds_read_b128 v[80:83], v21 offset:1024
    ds_read_b128 v[84:87], v21 offset:5120
    v_mfma_f32_32x32x16_bf16 v[192:207], v[152:155], v[144:147], v[192:207]
    s_add_u32 m0, s36, 32768
    s_add_u32 s39, s38, 114688
    buffer_load_dwordx4 v4, s[16:19], s38 offen lds
    ds_read_b64_tr_b16 v[88:89], v25 offset:20480
    ds_read_b64_tr_b16 v[90:91], v25 offset:22528
    v_mfma_f32_32x32x16_bf16 v[208:223], v[156:159], v[144:147], v[208:223]
    s_add_u32 m0, s36, 40960
    s_nop 0
    buffer_load_dwordx4 v4, s[16:19], s39 offen lds
    s_add_u32 s38, s38, 229376
    s_add_u32 s47, s47, 1
    s_cmp_eq_u32 s47, 7
    s_cselect_b32 s48, 28672, 0
    s_cselect_b32 s49, 1605632, 0
    s_sub_u32 s37, s37, s48
    s_sub_u32 s38, s38, s49
    ds_read_b64_tr_b16 v[92:93], v25 offset:36864
    ds_read_b64_tr_b16 v[94:95], v25 offset:38912
    v_mfma_f32_32x32x16_bf16 v[224:239], v[152:155], v[148:151], v[224:239]
    ds_read_b128 v[96:99], v21 offset:2048
    ds_read_b128 v[100:103], v21 offset:6144
    s_load_dwordx16 s[64:79], s[62:63], 7168
    v_mfma_f32_32x32x16_bf16 v[240:255], v[156:159], v[148:151], v[240:255]
    ds_read_b64_tr_b16 v[104:105], v25 offset:24576
    ds_read_b64_tr_b16 v[106:107], v25 offset:26624
    s_load_dwordx8 s[80:87], s[62:63], 7232
    v_mfma_f32_32x32x16_bf16 v[192:207], v[168:171], v[160:163], v[192:207]
    ds_read_b64_tr_b16 v[108:109], v25 offset:40960
    ds_read_b64_tr_b16 v[110:111], v25 offset:43008
    s_load_dwordx8 s[92:99], s[62:63], 7264
    v_mfma_f32_32x32x16_bf16 v[208:223], v[172:175], v[160:163], v[208:223]
    ds_read_b128 v[112:115], v21 offset:3072
    ds_read_b128 v[116:119], v21 offset:7168
    v_mfma_f32_32x32x16_bf16 v[224:239], v[168:171], v[164:167], v[224:239]
    ds_read_b64_tr_b16 v[120:121], v25 offset:28672
    ds_read_b64_tr_b16 v[122:123], v25 offset:30720
    v_mfma_f32_32x32x16_bf16 v[240:255], v[172:175], v[164:167], v[240:255]
    ds_read_b64_tr_b16 v[124:125], v25 offset:45056
    ds_read_b64_tr_b16 v[126:127], v25 offset:47104
    v_mfma_f32_32x32x16_bf16 v[192:207], v[184:187], v[176:179], v[192:207]
    v_mfma_f32_32x32x16_bf16 v[208:223], v[188:191], v[176:179], v[208:223]
    v_mfma_f32_32x32x16_bf16 v[224:239], v[184:187], v[180:183], v[224:239]
    v_mfma_f32_32x32x16_bf16 v[240:255], v[188:191], v[180:183], v[240:255]
    s_waitcnt vmcnt(6) lgkmcnt(0)
    s_barrier
    v_mfma_f32_32x32x16_bf16 v[192:207], v[72:75], v[64:67], v[192:207]
    ds_read_b128 v[128:131], v22 offset:0
    ds_read_b128 v[132:135], v22 offset:4096
    v_mfma_f32_32x32x16_bf16 v[208:223], v[76:79], v[64:67], v[208:223]
    ds_read_b64_tr_b16 v[136:137], v26 offset:16384
    ds_read_b64_tr_b16 v[138:139], v26 offset:18432
    v_mfma_f32_32x32x16_bf16 v[224:239], v[72:75], v[68:71], v[224:239]
    ds_read_b64_tr_b16 v[140:141], v26 offset:32768
    ds_read_b64_tr_b16 v[142:143], v26 offset:34816
    v_mfma_f32_32x32x16_bf16 v[240:255], v[76:79], v[68:71], v[240:255]
    ds_read_b128 v[144:147], v22 offset:1024
    ds_read_b128 v[148:151], v22 offset:5120
    v_mfma_f32_32x32x16_bf16 v[192:207], v[88:91], v[80:83], v[192:207]
    ds_read_b64_tr_b16 v[152:153], v26 offset:20480
    ds_read_b64_tr_b16 v[154:155], v26 offset:22528
    v_mfma_f32_32x32x16_bf16 v[208:223], v[92:95], v[80:83], v[208:223]
    ds_read_b64_tr_b16 v[156:157], v26 offset:36864
    ds_read_b64_tr_b16 v[158:159], v26 offset:38912
    v_mfma_f32_32x32x16_bf16 v[224:239], v[88:91], v[84:87], v[224:239]
    ds_read_b128 v[160:163], v22 offset:2048
    ds_read_b128 v[164:167], v22 offset:6144
  v_mov_b32 v52, s64
  v_mov_b32 v53, s65
  v_mov_b32 v54, s66
    v_mfma_f32_32x32x16_bf16 v[240:255], v[92:95], v[84:87], v[240:255]
    ds_read_b64_tr_b16 v[168:169], v26 offset:24576
    ds_read_b64_tr_b16 v[170:171], v26 offset:26624
  v_mov_b32 v55, s67
  s_mov_b32 exec_lo, 0
  v_mov_b32 v52, s68
  v_mov_b32 v53, s69
  v_mov_b32 v54, s70
  v_mov_b32 v55, s71
  s_mov_b32 exec_lo, -1
  v_mov_b32 v56, s72
    v_mfma_f32_32x32x16_bf16 v[192:207], v[104:107], v[96:99], v[192:207]
    ds_read_b64_tr_b16 v[172:173], v26 offset:40960
    ds_read_b64_tr_b16 v[174:175], v26 offset:43008
  v_mov_b32 v57, s73
  v_mov_b32 v58, s74
  v_mov_b32 v59, s75
    v_mfma_f32_32x32x16_bf16 v[208:223], v[108:111], v[96:99], v[208:223]
    ds_read_b128 v[176:179], v22 offset:3072
    ds_read_b128 v[180:183], v22 offset:7168
  s_mov_b32 exec_lo, 0
  v_mov_b32 v56, s76
  v_mov_b32 v57, s77
  v_mov_b32 v58, s78
  v_mov_b32 v59, s79
  s_mov_b32 exec_lo, -1
  v_mov_b32 v60, s80
  v_mov_b32 v61, s81
    v_mfma_f32_32x32x16_bf16 v[224:239], v[104:107], v[100:103], v[224:239]
    ds_read_b64_tr_b16 v[184:185], v26 offset:28672
    ds_read_b64_tr_b16 v[186:187], v26 offset:30720
  v_mov_b32 v62, s82
  v_mov_b32 v63, s83
  s_mov_b32 exec_lo, 0
  v_mov_b32 v60, s84
  v_mov_b32 v61, s85
  v_mov_b32 v62, s86
  v_mov_b32 v63, s87
  s_mov_b32 exec_lo, -1
    v_mfma_f32_32x32x16_bf16 v[240:255], v[108:111], v[100:103], v[240:255]
    ds_read_b64_tr_b16 v[188:189], v26 offset:45056
    ds_read_b64_tr_b16 v[190:191], v26 offset:47104
  v_mov_b32 v16, s92
  v_mov_b32 v17, s93
  v_mov_b32 v18, s94
    v_mfma_f32_32x32x16_bf16 v[192:207], v[120:123], v[112:115], v[192:207]
  v_mov_b32 v19, s95
  s_mov_b32 exec_lo, 0
  v_mov_b32 v16, s96
  v_mov_b32 v17, s97
  v_mov_b32 v18, s98
  v_mov_b32 v19, s99
  s_mov_b32 exec_lo, -1
    v_min_u32 v7, 447, v0
    v_mfma_f32_32x32x16_bf16 v[208:223], v[124:127], v[112:115], v[208:223]
    v_lshlrev_b32 v7, 7, v7
    s_lshr_b32 s43, s2, 3
    s_mul_i32 s43, s43, 57344
    v_mfma_f32_32x32x16_bf16 v[224:239], v[120:123], v[116:119], v[224:239]
    s_mov_b32 s56, s50
    s_mov_b32 s57, s51
    s_mov_b32 s58, 0x188000
    v_mfma_f32_32x32x16_bf16 v[240:255], v[124:127], v[116:119], v[240:255]
    s_mov_b32 s59, 0x00020000
    buffer_load_dword v23, v7, s[56:59], s43 offen
    s_waitcnt vmcnt(1) lgkmcnt(0)
    s_barrier
    v_mfma_f32_32x32x16_bf16 v[192:207], v[136:139], v[128:131], v[192:207]
    ds_read_b128 v[64:67], v20 offset:0
    ds_read_b128 v[68:71], v20 offset:4096
    v_mfma_f32_32x32x16_bf16 v[208:223], v[140:143], v[128:131], v[208:223]
    ds_read_b64_tr_b16 v[72:73], v24 offset:16384
    ds_read_b64_tr_b16 v[74:75], v24 offset:18432
    v_mfma_f32_32x32x16_bf16 v[224:239], v[136:139], v[132:135], v[224:239]
    ds_read_b64_tr_b16 v[76:77], v24 offset:32768
    ds_read_b64_tr_b16 v[78:79], v24 offset:34816
    v_mfma_f32_32x32x16_bf16 v[240:255], v[140:143], v[132:135], v[240:255]
    ds_read_b128 v[80:83], v20 offset:1024
    ds_read_b128 v[84:87], v20 offset:5120
    v_mfma_f32_32x32x16_bf16 v[192:207], v[152:155], v[144:147], v[192:207]
    ds_read_b64_tr_b16 v[88:89], v24 offset:20480
    ds_read_b64_tr_b16 v[90:91], v24 offset:22528
    v_mfma_f32_32x32x16_bf16 v[208:223], v[156:159], v[144:147], v[208:223]
    ds_read_b64_tr_b16 v[92:93], v24 offset:36864
    ds_read_b64_tr_b16 v[94:95], v24 offset:38912
    v_mfma_f32_32x32x16_bf16 v[224:239], v[152:155], v[148:151], v[224:239]
    ds_read_b128 v[96:99], v20 offset:2048
    ds_read_b128 v[100:103], v20 offset:6144
    v_mfma_f32_32x32x16_bf16 v[240:255], v[156:159], v[148:151], v[240:255]
    ds_read_b64_tr_b16 v[104:105], v24 offset:24576
    ds_read_b64_tr_b16 v[106:107], v24 offset:26624
    v_mfma_f32_32x32x16_bf16 v[192:207], v[168:171], v[160:163], v[192:207]
    ds_read_b64_tr_b16 v[108:109], v24 offset:40960
    ds_read_b64_tr_b16 v[110:111], v24 offset:43008
    v_mfma_f32_32x32x16_bf16 v[208:223], v[172:175], v[160:163], v[208:223]
    ds_read_b128 v[112:115], v20 offset:3072
    ds_read_b128 v[116:119], v20 offset:7168
    v_mfma_f32_32x32x16_bf16 v[224:239], v[168:171], v[164:167], v[224:239]
    ds_read_b64_tr_b16 v[120:121], v24 offset:28672
    ds_read_b64_tr_b16 v[122:123], v24 offset:30720
    v_mfma_f32_32x32x16_bf16 v[240:255], v[172:175], v[164:167], v[240:255]
    ds_read_b64_tr_b16 v[124:125], v24 offset:45056
    ds_read_b64_tr_b16 v[126:127], v24 offset:47104
    v_mfma_f32_32x32x16_bf16 v[192:207], v[184:187], v[176:179], v[192:207]
    v_mfma_f32_32x32x16_bf16 v[208:223], v[188:191], v[176:179], v[208:223]
    v_mfma_f32_32x32x16_bf16 v[224:239], v[184:187], v[180:183], v[224:239]
    v_mfma_f32_32x32x16_bf16 v[240:255], v[188:191], v[180:183], v[240:255]
    s_waitcnt lgkmcnt(0)
    v_mfma_f32_32x32x16_bf16 v[192:207], v[72:75], v[64:67], v[192:207]
    v_mfma_f32_32x32x16_bf16 v[208:223], v[76:79], v[64:67], v[208:223]
    v_mfma_f32_32x32x16_bf16 v[224:239], v[72:75], v[68:71], v[224:239]
    v_mfma_f32_32x32x16_bf16 v[240:255], v[76:79], v[68:71], v[240:255]
    v_mfma_f32_32x32x16_bf16 v[192:207], v[88:91], v[80:83], v[192:207]
    v_mfma_f32_32x32x16_bf16 v[208:223], v[92:95], v[80:83], v[208:223]
    v_mfma_f32_32x32x16_bf16 v[224:239], v[88:91], v[84:87], v[224:239]
    v_mfma_f32_32x32x16_bf16 v[240:255], v[92:95], v[84:87], v[240:255]
    v_mfma_f32_32x32x16_bf16 v[192:207], v[104:107], v[96:99], v[192:207]
    v_mfma_f32_32x32x16_bf16 v[208:223], v[108:111], v[96:99], v[208:223]
    v_mfma_f32_32x32x16_bf16 v[224:239], v[104:107], v[100:103], v[224:239]
    v_mfma_f32_32x32x16_bf16 v[240:255], v[108:111], v[100:103], v[240:255]
    v_mfma_f32_32x32x16_bf16 v[192:207], v[120:123], v[112:115], v[192:207]
    v_mfma_f32_32x32x16_bf16 v[208:223], v[124:127], v[112:115], v[208:223]
    v_mfma_f32_32x32x16_bf16 v[224:239], v[120:123], v[116:119], v[224:239]
    v_mfma_f32_32x32x16_bf16 v[240:255], v[124:127], v[116:119], v[240:255]
    s_lshl_b32 s40, s30, 2
    s_lshl_b32 s41, s32, 1
    s_add_u32 s40, s40, s41
    s_mul_i32 s40, s40, 112
    s_lshl_b32 s41, s31, 2
    s_add_u32 s41, s41, s33
    s_lshl_b32 s41, s41, 1
    s_add_u32 s40, s40, s41
    s_lshl_b32 s40, s40, 10
    s_nop 15
    v_pk_fma_f32 v[192:193], v[36:37], v[28:29], v[192:193] op_sel:[0,0,0] op_sel_hi:[1,0,1]
    v_pk_fma_f32 v[208:209], v[52:53], v[28:29], v[208:209] op_sel:[0,0,0] op_sel_hi:[1,0,1]
    v_pk_fma_f32 v[194:195], v[38:39], v[28:29], v[194:195] op_sel:[0,0,0] op_sel_hi:[1,0,1]
    v_pk_fma_f32 v[210:211], v[54:55], v[28:29], v[210:211] op_sel:[0,0,0] op_sel_hi:[1,0,1]
    v_pk_fma_f32 v[196:197], v[40:41], v[28:29], v[196:197] op_sel:[0,0,0] op_sel_hi:[1,0,1]
    v_pk_fma_f32 v[212:213], v[56:57], v[28:29], v[212:213] op_sel:[0,0,0] op_sel_hi:[1,0,1]
    v_pk_fma_f32 v[198:199], v[42:43], v[28:29], v[198:199] op_sel:[0,0,0] op_sel_hi:[1,0,1]
    v_pk_fma_f32 v[214:215], v[58:59], v[28:29], v[214:215] op_sel:[0,0,0] op_sel_hi:[1,0,1]
    v_pk_fma_f32 v[200:201], v[44:45], v[28:29], v[200:201] op_sel:[0,0,0] op_sel_hi:[1,0,1]
    v_pk_fma_f32 v[216:217], v[60:61], v[28:29], v[216:217] op_sel:[0,0,0] op_sel_hi:[1,0,1]
    v_pk_fma_f32 v[202:203], v[46:47], v[28:29], v[202:203] op_sel:[0,0,0] op_sel_hi:[1,0,1]
    v_pk_fma_f32 v[218:219], v[62:63], v[28:29], v[218:219] op_sel:[0,0,0] op_sel_hi:[1,0,1]
    v_pk_fma_f32 v[204:205], v[48:49], v[28:29], v[204:205] op_sel:[0,0,0] op_sel_hi:[1,0,1]
    v_pk_fma_f32 v[220:221], v[16:17], v[28:29], v[220:221] op_sel:[0,0,0] op_sel_hi:[1,0,1]
    v_pk_fma_f32 v[206:207], v[50:51], v[28:29], v[206:207] op_sel:[0,0,0] op_sel_hi:[1,0,1]
    v_pk_fma_f32 v[222:223], v[18:19], v[28:29], v[222:223] op_sel:[0,0,0] op_sel_hi:[1,0,1]
    v_pk_mul_f32 v[96:97], v[192:193], v[192:193] op_sel:[0,0] op_sel_hi:[1,1]
    v_pk_mul_f32 v[98:99], v[194:195], v[194:195] op_sel:[0,0] op_sel_hi:[1,1]
    v_pk_mul_f32 v[100:101], v[196:197], v[196:197] op_sel:[0,0] op_sel_hi:[1,1]
    v_pk_mul_f32 v[102:103], v[198:199], v[198:199] op_sel:[0,0] op_sel_hi:[1,1]
    v_pk_mul_f32 v[104:105], v[200:201], v[200:201] op_sel:[0,0] op_sel_hi:[1,1]
    v_pk_mul_f32 v[106:107], v[202:203], v[202:203] op_sel:[0,0] op_sel_hi:[1,1]
    v_pk_mul_f32 v[108:109], v[204:205], v[204:205] op_sel:[0,0] op_sel_hi:[1,1]
    v_pk_mul_f32 v[110:111], v[206:207], v[206:207] op_sel:[0,0] op_sel_hi:[1,1]
    v_pk_fma_f32 v[96:97], v[96:97], v[32:33], v[30:31] op_sel:[0,0,0] op_sel_hi:[1,0,0]
    v_pk_fma_f32 v[98:99], v[98:99], v[32:33], v[30:31] op_sel:[0,0,0] op_sel_hi:[1,0,0]
    v_pk_fma_f32 v[100:101], v[100:101], v[32:33], v[30:31] op_sel:[0,0,0] op_sel_hi:[1,0,0]
    v_pk_fma_f32 v[102:103], v[102:103], v[32:33], v[30:31] op_sel:[0,0,0] op_sel_hi:[1,0,0]
    v_pk_fma_f32 v[104:105], v[104:105], v[32:33], v[30:31] op_sel:[0,0,0] op_sel_hi:[1,0,0]
    v_pk_fma_f32 v[106:107], v[106:107], v[32:33], v[30:31] op_sel:[0,0,0] op_sel_hi:[1,0,0]
    v_pk_fma_f32 v[108:109], v[108:109], v[32:33], v[30:31] op_sel:[0,0,0] op_sel_hi:[1,0,0]
    v_pk_fma_f32 v[110:111], v[110:111], v[32:33], v[30:31] op_sel:[0,0,0] op_sel_hi:[1,0,0]
    v_pk_mul_f32 v[96:97], v[96:97], v[192:193] op_sel:[0,0] op_sel_hi:[1,1]
    v_pk_mul_f32 v[98:99], v[98:99], v[194:195] op_sel:[0,0] op_sel_hi:[1,1]
    v_pk_mul_f32 v[100:101], v[100:101], v[196:197] op_sel:[0,0] op_sel_hi:[1,1]
    v_pk_mul_f32 v[102:103], v[102:103], v[198:199] op_sel:[0,0] op_sel_hi:[1,1]
    v_pk_mul_f32 v[104:105], v[104:105], v[200:201] op_sel:[0,0] op_sel_hi:[1,1]
    v_pk_mul_f32 v[106:107], v[106:107], v[202:203] op_sel:[0,0] op_sel_hi:[1,1]
    v_pk_mul_f32 v[108:109], v[108:109], v[204:205] op_sel:[0,0] op_sel_hi:[1,1]
    v_pk_mul_f32 v[110:111], v[110:111], v[206:207] op_sel:[0,0] op_sel_hi:[1,1]
    v_exp_f32 v96, v96
    v_exp_f32 v97, v97
    v_exp_f32 v98, v98
    v_exp_f32 v99, v99
    v_exp_f32 v100, v100
    v_exp_f32 v101, v101
    v_exp_f32 v102, v102
    v_exp_f32 v103, v103
    v_exp_f32 v104, v104
    v_exp_f32 v105, v105
    v_exp_f32 v106, v106
    v_exp_f32 v107, v107
    v_exp_f32 v108, v108
    v_exp_f32 v109, v109
    v_exp_f32 v110, v110
    v_exp_f32 v111, v111
    v_pk_mul_f32 v[208:209], v[208:209], v[192:193] op_sel:[0,0] op_sel_hi:[1,1]
    v_pk_mul_f32 v[210:211], v[210:211], v[194:195] op_sel:[0,0] op_sel_hi:[1,1]
    v_pk_mul_f32 v[212:213], v[212:213], v[196:197] op_sel:[0,0] op_sel_hi:[1,1]
    v_pk_mul_f32 v[214:215], v[214:215], v[198:199] op_sel:[0,0] op_sel_hi:[1,1]
    v_pk_mul_f32 v[216:217], v[216:217], v[200:201] op_sel:[0,0] op_sel_hi:[1,1]
    v_pk_mul_f32 v[218:219], v[218:219], v[202:203] op_sel:[0,0] op_sel_hi:[1,1]
    v_pk_mul_f32 v[220:221], v[220:221], v[204:205] op_sel:[0,0] op_sel_hi:[1,1]
    v_pk_mul_f32 v[222:223], v[222:223], v[206:207] op_sel:[0,0] op_sel_hi:[1,1]
    v_pk_fma_f32 v[96:97], v[96:97], v[34:35], v[34:35] op_sel:[0,0,0] op_sel_hi:[1,0,0]
    v_pk_fma_f32 v[98:99], v[98:99], v[34:35], v[34:35] op_sel:[0,0,0] op_sel_hi:[1,0,0]
    v_pk_fma_f32 v[100:101], v[100:101], v[34:35], v[34:35] op_sel:[0,0,0] op_sel_hi:[1,0,0]
    v_pk_fma_f32 v[102:103], v[102:103], v[34:35], v[34:35] op_sel:[0,0,0] op_sel_hi:[1,0,0]
    v_pk_fma_f32 v[104:105], v[104:105], v[34:35], v[34:35] op_sel:[0,0,0] op_sel_hi:[1,0,0]
    v_pk_fma_f32 v[106:107], v[106:107], v[34:35], v[34:35] op_sel:[0,0,0] op_sel_hi:[1,0,0]
    v_pk_fma_f32 v[108:109], v[108:109], v[34:35], v[34:35] op_sel:[0,0,0] op_sel_hi:[1,0,0]
    v_pk_fma_f32 v[110:111], v[110:111], v[34:35], v[34:35] op_sel:[0,0,0] op_sel_hi:[1,0,0]
    v_rcp_f32 v96, v96
    v_rcp_f32 v97, v97
    v_rcp_f32 v98, v98
    v_rcp_f32 v99, v99
    v_rcp_f32 v100, v100
    v_rcp_f32 v101, v101
    v_rcp_f32 v102, v102
    v_rcp_f32 v103, v103
    v_rcp_f32 v104, v104
    v_rcp_f32 v105, v105
    v_rcp_f32 v106, v106
    v_rcp_f32 v107, v107
    v_rcp_f32 v108, v108
    v_rcp_f32 v109, v109
    v_rcp_f32 v110, v110
    v_rcp_f32 v111, v111
    s_nop 0
    v_pk_mul_f32 v[208:209], v[208:209], v[96:97] op_sel:[0,0] op_sel_hi:[1,1]
    v_pk_mul_f32 v[210:211], v[210:211], v[98:99] op_sel:[0,0] op_sel_hi:[1,1]
    v_pk_mul_f32 v[212:213], v[212:213], v[100:101] op_sel:[0,0] op_sel_hi:[1,1]
    v_pk_mul_f32 v[214:215], v[214:215], v[102:103] op_sel:[0,0] op_sel_hi:[1,1]
    v_pk_mul_f32 v[216:217], v[216:217], v[104:105] op_sel:[0,0] op_sel_hi:[1,1]
    v_pk_mul_f32 v[218:219], v[218:219], v[106:107] op_sel:[0,0] op_sel_hi:[1,1]
    v_pk_mul_f32 v[220:221], v[220:221], v[108:109] op_sel:[0,0] op_sel_hi:[1,1]
    v_pk_mul_f32 v[222:223], v[222:223], v[110:111] op_sel:[0,0] op_sel_hi:[1,1]
    v_cvt_pk_bf16_f32 v112, v208, v209
    v_cvt_pk_bf16_f32 v113, v210, v211
    v_cvt_pk_bf16_f32 v114, v212, v213
    v_cvt_pk_bf16_f32 v115, v214, v215
    v_cvt_pk_bf16_f32 v116, v216, v217
    v_cvt_pk_bf16_f32 v117, v218, v219
    v_cvt_pk_bf16_f32 v118, v220, v221
    v_cvt_pk_bf16_f32 v119, v222, v223
    buffer_store_dwordx4 v[112:115], v3, s[24:27], s40 offen offset:0 sc1
    buffer_store_dwordx4 v[116:119], v3, s[24:27], s40 offen offset:1024 sc1
    v_pk_fma_f32 v[224:225], v[36:37], v[28:29], v[224:225] op_sel:[0,1,0] op_sel_hi:[1,1,1]
    v_pk_fma_f32 v[240:241], v[52:53], v[28:29], v[240:241] op_sel:[0,1,0] op_sel_hi:[1,1,1]
    v_pk_fma_f32 v[226:227], v[38:39], v[28:29], v[226:227] op_sel:[0,1,0] op_sel_hi:[1,1,1]
    v_pk_fma_f32 v[242:243], v[54:55], v[28:29], v[242:243] op_sel:[0,1,0] op_sel_hi:[1,1,1]
    v_pk_fma_f32 v[228:229], v[40:41], v[28:29], v[228:229] op_sel:[0,1,0] op_sel_hi:[1,1,1]
    v_pk_fma_f32 v[244:245], v[56:57], v[28:29], v[244:245] op_sel:[0,1,0] op_sel_hi:[1,1,1]
    v_pk_fma_f32 v[230:231], v[42:43], v[28:29], v[230:231] op_sel:[0,1,0] op_sel_hi:[1,1,1]
    v_pk_fma_f32 v[246:247], v[58:59], v[28:29], v[246:247] op_sel:[0,1,0] op_sel_hi:[1,1,1]
    v_pk_fma_f32 v[232:233], v[44:45], v[28:29], v[232:233] op_sel:[0,1,0] op_sel_hi:[1,1,1]
    v_pk_fma_f32 v[248:249], v[60:61], v[28:29], v[248:249] op_sel:[0,1,0] op_sel_hi:[1,1,1]
    v_pk_fma_f32 v[234:235], v[46:47], v[28:29], v[234:235] op_sel:[0,1,0] op_sel_hi:[1,1,1]
    v_pk_fma_f32 v[250:251], v[62:63], v[28:29], v[250:251] op_sel:[0,1,0] op_sel_hi:[1,1,1]
    v_pk_fma_f32 v[236:237], v[48:49], v[28:29], v[236:237] op_sel:[0,1,0] op_sel_hi:[1,1,1]
    v_pk_fma_f32 v[252:253], v[16:17], v[28:29], v[252:253] op_sel:[0,1,0] op_sel_hi:[1,1,1]
    v_pk_fma_f32 v[238:239], v[50:51], v[28:29], v[238:239] op_sel:[0,1,0] op_sel_hi:[1,1,1]
    v_pk_fma_f32 v[254:255], v[18:19], v[28:29], v[254:255] op_sel:[0,1,0] op_sel_hi:[1,1,1]
    v_pk_mul_f32 v[96:97], v[224:225], v[224:225] op_sel:[0,0] op_sel_hi:[1,1]
    v_pk_mul_f32 v[98:99], v[226:227], v[226:227] op_sel:[0,0] op_sel_hi:[1,1]
    v_pk_mul_f32 v[100:101], v[228:229], v[228:229] op_sel:[0,0] op_sel_hi:[1,1]
    v_pk_mul_f32 v[102:103], v[230:231], v[230:231] op_sel:[0,0] op_sel_hi:[1,1]
    v_pk_mul_f32 v[104:105], v[232:233], v[232:233] op_sel:[0,0] op_sel_hi:[1,1]
    v_pk_mul_f32 v[106:107], v[234:235], v[234:235] op_sel:[0,0] op_sel_hi:[1,1]
    v_pk_mul_f32 v[108:109], v[236:237], v[236:237] op_sel:[0,0] op_sel_hi:[1,1]
    v_pk_mul_f32 v[110:111], v[238:239], v[238:239] op_sel:[0,0] op_sel_hi:[1,1]
    v_pk_fma_f32 v[96:97], v[96:97], v[32:33], v[30:31] op_sel:[0,1,1] op_sel_hi:[1,1,1]
    v_pk_fma_f32 v[98:99], v[98:99], v[32:33], v[30:31] op_sel:[0,1,1] op_sel_hi:[1,1,1]
    v_pk_fma_f32 v[100:101], v[100:101], v[32:33], v[30:31] op_sel:[0,1,1] op_sel_hi:[1,1,1]
    v_pk_fma_f32 v[102:103], v[102:103], v[32:33], v[30:31] op_sel:[0,1,1] op_sel_hi:[1,1,1]
    v_pk_fma_f32 v[104:105], v[104:105], v[32:33], v[30:31] op_sel:[0,1,1] op_sel_hi:[1,1,1]
    v_pk_fma_f32 v[106:107], v[106:107], v[32:33], v[30:31] op_sel:[0,1,1] op_sel_hi:[1,1,1]
    v_pk_fma_f32 v[108:109], v[108:109], v[32:33], v[30:31] op_sel:[0,1,1] op_sel_hi:[1,1,1]
    v_pk_fma_f32 v[110:111], v[110:111], v[32:33], v[30:31] op_sel:[0,1,1] op_sel_hi:[1,1,1]
    v_pk_mul_f32 v[96:97], v[96:97], v[224:225] op_sel:[0,0] op_sel_hi:[1,1]
    v_pk_mul_f32 v[98:99], v[98:99], v[226:227] op_sel:[0,0] op_sel_hi:[1,1]
    v_pk_mul_f32 v[100:101], v[100:101], v[228:229] op_sel:[0,0] op_sel_hi:[1,1]
    v_pk_mul_f32 v[102:103], v[102:103], v[230:231] op_sel:[0,0] op_sel_hi:[1,1]
    v_pk_mul_f32 v[104:105], v[104:105], v[232:233] op_sel:[0,0] op_sel_hi:[1,1]
    v_pk_mul_f32 v[106:107], v[106:107], v[234:235] op_sel:[0,0] op_sel_hi:[1,1]
    v_pk_mul_f32 v[108:109], v[108:109], v[236:237] op_sel:[0,0] op_sel_hi:[1,1]
    v_pk_mul_f32 v[110:111], v[110:111], v[238:239] op_sel:[0,0] op_sel_hi:[1,1]
    v_exp_f32 v96, v96
    v_exp_f32 v97, v97
    v_exp_f32 v98, v98
    v_exp_f32 v99, v99
    v_exp_f32 v100, v100
    v_exp_f32 v101, v101
    v_exp_f32 v102, v102
    v_exp_f32 v103, v103
    v_exp_f32 v104, v104
    v_exp_f32 v105, v105
    v_exp_f32 v106, v106
    v_exp_f32 v107, v107
    v_exp_f32 v108, v108
    v_exp_f32 v109, v109
    v_exp_f32 v110, v110
    v_exp_f32 v111, v111
    v_pk_mul_f32 v[240:241], v[240:241], v[224:225] op_sel:[0,0] op_sel_hi:[1,1]
    v_pk_mul_f32 v[242:243], v[242:243], v[226:227] op_sel:[0,0] op_sel_hi:[1,1]
    v_pk_mul_f32 v[244:245], v[244:245], v[228:229] op_sel:[0,0] op_sel_hi:[1,1]
    v_pk_mul_f32 v[246:247], v[246:247], v[230:231] op_sel:[0,0] op_sel_hi:[1,1]
    v_pk_mul_f32 v[248:249], v[248:249], v[232:233] op_sel:[0,0] op_sel_hi:[1,1]
    v_pk_mul_f32 v[250:251], v[250:251], v[234:235] op_sel:[0,0] op_sel_hi:[1,1]
    v_pk_mul_f32 v[252:253], v[252:253], v[236:237] op_sel:[0,0] op_sel_hi:[1,1]
    v_pk_mul_f32 v[254:255], v[254:255], v[238:239] op_sel:[0,0] op_sel_hi:[1,1]
    v_pk_fma_f32 v[96:97], v[96:97], v[34:35], v[34:35] op_sel:[0,1,1] op_sel_hi:[1,1,1]
    v_pk_fma_f32 v[98:99], v[98:99], v[34:35], v[34:35] op_sel:[0,1,1] op_sel_hi:[1,1,1]
    v_pk_fma_f32 v[100:101], v[100:101], v[34:35], v[34:35] op_sel:[0,1,1] op_sel_hi:[1,1,1]
    v_pk_fma_f32 v[102:103], v[102:103], v[34:35], v[34:35] op_sel:[0,1,1] op_sel_hi:[1,1,1]
    v_pk_fma_f32 v[104:105], v[104:105], v[34:35], v[34:35] op_sel:[0,1,1] op_sel_hi:[1,1,1]
    v_pk_fma_f32 v[106:107], v[106:107], v[34:35], v[34:35] op_sel:[0,1,1] op_sel_hi:[1,1,1]
    v_pk_fma_f32 v[108:109], v[108:109], v[34:35], v[34:35] op_sel:[0,1,1] op_sel_hi:[1,1,1]
    v_pk_fma_f32 v[110:111], v[110:111], v[34:35], v[34:35] op_sel:[0,1,1] op_sel_hi:[1,1,1]
    v_rcp_f32 v96, v96
    v_rcp_f32 v97, v97
    v_rcp_f32 v98, v98
    v_rcp_f32 v99, v99
    v_rcp_f32 v100, v100
    v_rcp_f32 v101, v101
    v_rcp_f32 v102, v102
    v_rcp_f32 v103, v103
    v_rcp_f32 v104, v104
    v_rcp_f32 v105, v105
    v_rcp_f32 v106, v106
    v_rcp_f32 v107, v107
    v_rcp_f32 v108, v108
    v_rcp_f32 v109, v109
    v_rcp_f32 v110, v110
    v_rcp_f32 v111, v111
    s_nop 0
    v_pk_mul_f32 v[240:241], v[240:241], v[96:97] op_sel:[0,0] op_sel_hi:[1,1]
    v_pk_mul_f32 v[242:243], v[242:243], v[98:99] op_sel:[0,0] op_sel_hi:[1,1]
    v_pk_mul_f32 v[244:245], v[244:245], v[100:101] op_sel:[0,0] op_sel_hi:[1,1]
    v_pk_mul_f32 v[246:247], v[246:247], v[102:103] op_sel:[0,0] op_sel_hi:[1,1]
    v_pk_mul_f32 v[248:249], v[248:249], v[104:105] op_sel:[0,0] op_sel_hi:[1,1]
    v_pk_mul_f32 v[250:251], v[250:251], v[106:107] op_sel:[0,0] op_sel_hi:[1,1]
    v_pk_mul_f32 v[252:253], v[252:253], v[108:109] op_sel:[0,0] op_sel_hi:[1,1]
    v_pk_mul_f32 v[254:255], v[254:255], v[110:111] op_sel:[0,0] op_sel_hi:[1,1]
    v_cvt_pk_bf16_f32 v112, v240, v241
    v_cvt_pk_bf16_f32 v113, v242, v243
    v_cvt_pk_bf16_f32 v114, v244, v245
    v_cvt_pk_bf16_f32 v115, v246, v247
    v_cvt_pk_bf16_f32 v116, v248, v249
    v_cvt_pk_bf16_f32 v117, v250, v251
    v_cvt_pk_bf16_f32 v118, v252, v253
    v_cvt_pk_bf16_f32 v119, v254, v255
    s_add_u32 s40, s40, 114688
    buffer_store_dwordx4 v[112:115], v3, s[24:27], s40 offen offset:0 sc1
    buffer_store_dwordx4 v[116:119], v3, s[24:27], s40 offen offset:1024 sc1
k4_ffn_kernel_end:
    s_endpgm
.globl k5_down_kernel
.p2align 8
.type k5_down_kernel,@function
k5_down_kernel:
    s_cmp_ge_u32 s2, 224
    s_cbranch_scc1 k5_down_kernel_end
    s_load_dwordx2 s[28:29], s[0:1], 72
    s_load_dwordx2 s[6:7], s[0:1], 48
    s_load_dwordx2 s[20:21], s[0:1], 56
    v_and_b32 v1, 63, v0
    v_lshrrev_b32 v2, 6, v0
    s_and_b32 s30, s2, 7
    s_lshr_b32 s31, s2, 3
    v_readfirstlane_b32 s3, v2
    s_and_b32 s32, s31, 3
    s_lshl_b32 s30, s30, 2
    s_add_u32 s30, s30, s32
    s_lshr_b32 s31, s31, 2
    v_lshlrev_b32 v3, 4, v1
    v_lshrrev_b32 v4, 3, v1
    v_and_b32 v5, 7, v1
    v_bfe_u32 v6, v1, 4, 1
    v_lshlrev_b32 v6, 2, v6
    v_xor_b32 v5, v5, v6
    s_movk_i32 s44, 896
    v_mul_u32_u24 v6, s44, v4
    v_lshl_add_u32 v6, v5, 4, v6
    v_add_u32 v7, 7168, v6
    s_waitcnt lgkmcnt(0)
    s_add_u32 s8, s28, 0xa00000
    s_addc_u32 s9, s29, 0
    s_mov_b32 s10, 0x700000
    s_mov_b32 s11, 0x00020000
    s_mov_b32 s12, s6
    s_mov_b32 s13, s7
    s_mov_b32 s14, 0x188000
    s_mov_b32 s15, 0x00020000
    s_mul_i32 s34, s30, 229376
    s_lshl_b32 s35, s3, 10
    s_add_u32 s34, s34, s35
    s_lshl_b32 s36, s31, 7
    s_mul_i32 s37, s3, 14336
    s_add_u32 s36, s36, s37
    s_mul_i32 s38, s3, 8192
    s_mul_i32 s47, s31, 4
    s_mul_i32 s48, s32, 7
    s_add_u32 s47, s47, s48
    s_cmp_ge_u32 s47, 28
    s_cselect_b32 s48, 28, 0
    s_sub_u32 s47, s47, s48
    s_lshl_b32 s48, s47, 12
    s_add_u32 s34, s34, s48
    s_mul_i32 s48, s47, 57344
    s_add_u32 s36, s36, s48
    buffer_load_dwordx4 v[128:131], v3, s[8:11], s34 offen
    s_add_u32 s39, s34, 114688
    buffer_load_dwordx4 v[132:135], v3, s[8:11], s39 offen
    s_add_u32 m0, s38, 0
    s_add_u32 s34, s34, 4096
    buffer_load_dwordx4 v6, s[12:15], s36 offen lds
    s_add_u32 m0, s38, 1024
    s_nop 0
    buffer_load_dwordx4 v7, s[12:15], s36 offen lds
    s_add_u32 s36, s36, 57344
    s_add_u32 s47, s47, 1
    s_cmp_eq_u32 s47, 28
    s_cselect_b32 s48, 114688, 0
    s_cselect_b32 s49, 1605632, 0
    s_sub_u32 s34, s34, s48
    s_sub_u32 s36, s36, s49
    buffer_load_dwordx4 v[136:139], v3, s[8:11], s34 offen
    s_add_u32 s39, s34, 114688
    buffer_load_dwordx4 v[140:143], v3, s[8:11], s39 offen
    s_add_u32 m0, s38, 2048
    s_add_u32 s34, s34, 4096
    buffer_load_dwordx4 v6, s[12:15], s36 offen lds
    s_add_u32 m0, s38, 3072
    s_nop 0
    buffer_load_dwordx4 v7, s[12:15], s36 offen lds
    s_add_u32 s36, s36, 57344
    s_add_u32 s47, s47, 1
    s_cmp_eq_u32 s47, 28
    s_cselect_b32 s48, 114688, 0
    s_cselect_b32 s49, 1605632, 0
    s_sub_u32 s34, s34, s48
    s_sub_u32 s36, s36, s49
    buffer_load_dwordx4 v[144:147], v3, s[8:11], s34 offen
    s_add_u32 s39, s34, 114688
    buffer_load_dwordx4 v[148:151], v3, s[8:11], s39 offen
    s_add_u32 m0, s38, 4096
    s_add_u32 s34, s34, 4096
    buffer_load_dwordx4 v6, s[12:15], s36 offen lds
    s_add_u32 m0, s38, 5120
    s_nop 0
    buffer_load_dwordx4 v7, s[12:15], s36 offen lds
    s_add_u32 s36, s36, 57344
    s_add_u32 s47, s47, 1
    s_cmp_eq_u32 s47, 28
    s_cselect_b32 s48, 114688, 0
    s_cselect_b32 s49, 1605632, 0
    s_sub_u32 s34, s34, s48
    s_sub_u32 s36, s36, s49
    buffer_load_dwordx4 v[152:155], v3, s[8:11], s34 offen
    s_add_u32 s39, s34, 114688
    buffer_load_dwordx4 v[156:159], v3, s[8:11], s39 offen
    s_add_u32 m0, s38, 6144
    s_add_u32 s34, s34, 4096
    buffer_load_dwordx4 v6, s[12:15], s36 offen lds
    s_add_u32 m0, s38, 7168
    s_nop 0
    buffer_load_dwordx4 v7, s[12:15], s36 offen lds
    s_add_u32 s36, s36, 57344
    s_add_u32 s47, s47, 1
    s_cmp_eq_u32 s47, 28
    s_cselect_b32 s48, 114688, 0
    s_cselect_b32 s49, 1605632, 0
    s_sub_u32 s34, s34, s48
    s_sub_u32 s36, s36, s49
    v_lshrrev_b32 v8, 5, v1
    v_bfe_u32 v9, v1, 2, 2
    v_lshl_add_u32 v10, v8, 2, v9
    v_lshlrev_b32 v10, 7, v10
    v_lshrrev_b32 v11, 1, v9
    v_lshl_add_u32 v10, v11, 6, v10
    v_bfe_u32 v11, v1, 4, 1
    v_lshl_add_u32 v10, v11, 5, v10
    v_and_b32 v11, 3, v1
    v_lshl_add_u32 v10, v11, 3, v10
    v_add_u32 v10, s38, v10
    v_xor_b32 v11, 64, v10
    s_waitcnt vmcnt(12)
    ds_read_b64_tr_b16 v[192:193], v10 offset:0
    ds_read_b64_tr_b16 v[194:195], v10 offset:1024
    ds_read_b64_tr_b16 v[196:197], v11 offset:0
    ds_read_b64_tr_b16 v[198:199], v11 offset:1024
    s_waitcnt vmcnt(8)
    ds_read_b64_tr_b16 v[200:201], v10 offset:2048
    ds_read_b64_tr_b16 v[202:203], v10 offset:3072
    ds_read_b64_tr_b16 v[204:205], v11 offset:2048
    ds_read_b64_tr_b16 v[206:207], v11 offset:3072
    s_waitcnt lgkmcnt(4)
    v_mfma_f32_32x32x16_bf16 v[64:79], v[192:195], v[128:131], 0
    v_mfma_f32_32x32x16_bf16 v[80:95], v[196:199], v[128:131], 0
    v_mfma_f32_32x32x16_bf16 v[96:111], v[192:195], v[132:135], 0
    v_mfma_f32_32x32x16_bf16 v[112:127], v[196:199], v[132:135], 0
    buffer_load_dwordx4 v[128:131], v3, s[8:11], s34 offen
    s_add_u32 s39, s34, 114688
    buffer_load_dwordx4 v[132:135], v3, s[8:11], s39 offen
    s_add_u32 m0, s38, 0
    s_add_u32 s34, s34, 4096
    buffer_load_dwordx4 v6, s[12:15], s36 offen lds
    s_add_u32 m0, s38, 1024
    s_nop 0
    buffer_load_dwordx4 v7, s[12:15], s36 offen lds
    s_add_u32 s36, s36, 57344
    s_add_u32 s47, s47, 1
    s_cmp_eq_u32 s47, 28
    s_cselect_b32 s48, 114688, 0
    s_cselect_b32 s49, 1605632, 0
    s_sub_u32 s34, s34, s48
    s_sub_u32 s36, s36, s49
    s_waitcnt vmcnt(8)
    ds_read_b64_tr_b16 v[192:193], v10 offset:4096
    ds_read_b64_tr_b16 v[194:195], v10 offset:5120
    ds_read_b64_tr_b16 v[196:197], v11 offset:4096
    ds_read_b64_tr_b16 v[198:199], v11 offset:5120
    s_waitcnt lgkmcnt(4)
    v_mfma_f32_32x32x16_bf16 v[64:79], v[200:203], v[136:139], v[64:79]
    v_mfma_f32_32x32x16_bf16 v[80:95], v[204:207], v[136:139], v[80:95]
    v_mfma_f32_32x32x16_bf16 v[96:111], v[200:203], v[140:143], v[96:111]
    v_mfma_f32_32x32x16_bf16 v[112:127], v[204:207], v[140:143], v[112:127]
    buffer_load_dwordx4 v[136:139], v3, s[8:11], s34 offen
    s_add_u32 s39, s34, 114688
    buffer_load_dwordx4 v[140:143], v3, s[8:11], s39 offen
    s_add_u32 m0, s38, 2048
    s_add_u32 s34, s34, 4096
    buffer_load_dwordx4 v6, s[12:15], s36 offen lds
    s_add_u32 m0, s38, 3072
    s_nop 0
    buffer_load_dwordx4 v7, s[12:15], s36 offen lds
    s_add_u32 s36, s36, 57344
    s_add_u32 s47, s47, 1
    s_cmp_eq_u32 s47, 28
    s_cselect_b32 s48, 114688, 0
    s_cselect_b32 s49, 1605632, 0
    s_sub_u32 s34, s34, s48
    s_sub_u32 s36, s36, s49
    s_waitcnt vmcnt(8)
    ds_read_b64_tr_b16 v[200:201], v10 offset:6144
    ds_read_b64_tr_b16 v[202:203], v10 offset:7168
    ds_read_b64_tr_b16 v[204:205], v11 offset:6144
    ds_read_b64_tr_b16 v[206:207], v11 offset:7168
    s_waitcnt lgkmcnt(4)
    v_mfma_f32_32x32x16_bf16 v[64:79], v[192:195], v[144:147], v[64:79]
    v_mfma_f32_32x32x16_bf16 v[80:95], v[196:199], v[144:147], v[80:95]
    v_mfma_f32_32x32x16_bf16 v[96:111], v[192:195], v[148:151], v[96:111]
    v_mfma_f32_32x32x16_bf16 v[112:127], v[196:199], v[148:151], v[112:127]
    buffer_load_dwordx4 v[144:147], v3, s[8:11], s34 offen
    s_add_u32 s39, s34, 114688
    buffer_load_dwordx4 v[148:151], v3, s[8:11], s39 offen
    s_add_u32 m0, s38, 4096
    s_add_u32 s34, s34, 4096
    buffer_load_dwordx4 v6, s[12:15], s36 offen lds
    s_add_u32 m0, s38, 5120
    s_nop 0
    buffer_load_dwordx4 v7, s[12:15], s36 offen lds
    s_add_u32 s36, s36, 57344
    s_add_u32 s47, s47, 1
    s_cmp_eq_u32 s47, 28
    s_cselect_b32 s48, 114688, 0
    s_cselect_b32 s49, 1605632, 0
    s_sub_u32 s34, s34, s48
    s_sub_u32 s36, s36, s49
    s_waitcnt vmcnt(8)
    ds_read_b64_tr_b16 v[192:193], v10 offset:0
    ds_read_b64_tr_b16 v[194:195], v10 offset:1024
    ds_read_b64_tr_b16 v[196:197], v11 offset:0
    ds_read_b64_tr_b16 v[198:199], v11 offset:1024
    s_waitcnt lgkmcnt(4)
    v_mfma_f32_32x32x16_bf16 v[64:79], v[200:203], v[152:155], v[64:79]
    v_mfma_f32_32x32x16_bf16 v[80:95], v[204:207], v[152:155], v[80:95]
    v_mfma_f32_32x32x16_bf16 v[96:111], v[200:203], v[156:159], v[96:111]
    v_mfma_f32_32x32x16_bf16 v[112:127], v[204:207], v[156:159], v[112:127]
    buffer_load_dwordx4 v[152:155], v3, s[8:11], s34 offen
    s_add_u32 s39, s34, 114688
    buffer_load_dwordx4 v[156:159], v3, s[8:11], s39 offen
    s_add_u32 m0, s38, 6144
    s_add_u32 s34, s34, 4096
    buffer_load_dwordx4 v6, s[12:15], s36 offen lds
    s_add_u32 m0, s38, 7168
    s_nop 0
    buffer_load_dwordx4 v7, s[12:15], s36 offen lds
    s_add_u32 s36, s36, 57344
    s_add_u32 s47, s47, 1
    s_cmp_eq_u32 s47, 28
    s_cselect_b32 s48, 114688, 0
    s_cselect_b32 s49, 1605632, 0
    s_sub_u32 s34, s34, s48
    s_sub_u32 s36, s36, s49
    s_waitcnt vmcnt(8)
    ds_read_b64_tr_b16 v[200:201], v10 offset:2048
    ds_read_b64_tr_b16 v[202:203], v10 offset:3072
    ds_read_b64_tr_b16 v[204:205], v11 offset:2048
    ds_read_b64_tr_b16 v[206:207], v11 offset:3072
    s_waitcnt lgkmcnt(4)
    v_mfma_f32_32x32x16_bf16 v[64:79], v[192:195], v[128:131], v[64:79]
    v_mfma_f32_32x32x16_bf16 v[80:95], v[196:199], v[128:131], v[80:95]
    v_mfma_f32_32x32x16_bf16 v[96:111], v[192:195], v[132:135], v[96:111]
    v_mfma_f32_32x32x16_bf16 v[112:127], v[196:199], v[132:135], v[112:127]
    buffer_load_dwordx4 v[128:131], v3, s[8:11], s34 offen
    s_add_u32 s39, s34, 114688
    buffer_load_dwordx4 v[132:135], v3, s[8:11], s39 offen
    s_add_u32 m0, s38, 0
    s_add_u32 s34, s34, 4096
    buffer_load_dwordx4 v6, s[12:15], s36 offen lds
    s_add_u32 m0, s38, 1024
    s_nop 0
    buffer_load_dwordx4 v7, s[12:15], s36 offen lds
    s_add_u32 s36, s36, 57344
    s_add_u32 s47, s47, 1
    s_cmp_eq_u32 s47, 28
    s_cselect_b32 s48, 114688, 0
    s_cselect_b32 s49, 1605632, 0
    s_sub_u32 s34, s34, s48
    s_sub_u32 s36, s36, s49
    s_waitcnt vmcnt(8)
    ds_read_b64_tr_b16 v[192:193], v10 offset:4096
    ds_read_b64_tr_b16 v[194:195], v10 offset:5120
    ds_read_b64_tr_b16 v[196:197], v11 offset:4096
    ds_read_b64_tr_b16 v[198:199], v11 offset:5120
    s_waitcnt lgkmcnt(4)
    v_mfma_f32_32x32x16_bf16 v[64:79], v[200:203], v[136:139], v[64:79]
    v_mfma_f32_32x32x16_bf16 v[80:95], v[204:207], v[136:139], v[80:95]
    v_mfma_f32_32x32x16_bf16 v[96:111], v[200:203], v[140:143], v[96:111]
    v_mfma_f32_32x32x16_bf16 v[112:127], v[204:207], v[140:143], v[112:127]
    buffer_load_dwordx4 v[136:139], v3, s[8:11], s34 offen
    s_add_u32 s39, s34, 114688
    buffer_load_dwordx4 v[140:143], v3, s[8:11], s39 offen
    s_add_u32 m0, s38, 2048
    s_add_u32 s34, s34, 4096
    buffer_load_dwordx4 v6, s[12:15], s36 offen lds
    s_add_u32 m0, s38, 3072
    s_nop 0
    buffer_load_dwordx4 v7, s[12:15], s36 offen lds
    s_add_u32 s36, s36, 57344
    s_add_u32 s47, s47, 1
    s_cmp_eq_u32 s47, 28
    s_cselect_b32 s48, 114688, 0
    s_cselect_b32 s49, 1605632, 0
    s_sub_u32 s34, s34, s48
    s_sub_u32 s36, s36, s49
    s_waitcnt vmcnt(8)
    ds_read_b64_tr_b16 v[200:201], v10 offset:6144
    ds_read_b64_tr_b16 v[202:203], v10 offset:7168
    ds_read_b64_tr_b16 v[204:205], v11 offset:6144
    ds_read_b64_tr_b16 v[206:207], v11 offset:7168
    s_waitcnt lgkmcnt(4)
    v_mfma_f32_32x32x16_bf16 v[64:79], v[192:195], v[144:147], v[64:79]
    v_mfma_f32_32x32x16_bf16 v[80:95], v[196:199], v[144:147], v[80:95]
    v_mfma_f32_32x32x16_bf16 v[96:111], v[192:195], v[148:151], v[96:111]
    v_mfma_f32_32x32x16_bf16 v[112:127], v[196:199], v[148:151], v[112:127]
    buffer_load_dwordx4 v[144:147], v3, s[8:11], s34 offen
    s_add_u32 s39, s34, 114688
    buffer_load_dwordx4 v[148:151], v3, s[8:11], s39 offen
    s_add_u32 m0, s38, 4096
    s_add_u32 s34, s34, 4096
    buffer_load_dwordx4 v6, s[12:15], s36 offen lds
    s_add_u32 m0, s38, 5120
    s_nop 0
    buffer_load_dwordx4 v7, s[12:15], s36 offen lds
    s_add_u32 s36, s36, 57344
    s_add_u32 s47, s47, 1
    s_cmp_eq_u32 s47, 28
    s_cselect_b32 s48, 114688, 0
    s_cselect_b32 s49, 1605632, 0
    s_sub_u32 s34, s34, s48
    s_sub_u32 s36, s36, s49
    s_waitcnt vmcnt(8)
    ds_read_b64_tr_b16 v[192:193], v10 offset:0
    ds_read_b64_tr_b16 v[194:195], v10 offset:1024
    ds_read_b64_tr_b16 v[196:197], v11 offset:0
    ds_read_b64_tr_b16 v[198:199], v11 offset:1024
    s_waitcnt lgkmcnt(4)
    v_mfma_f32_32x32x16_bf16 v[64:79], v[200:203], v[152:155], v[64:79]
    v_mfma_f32_32x32x16_bf16 v[80:95], v[204:207], v[152:155], v[80:95]
    v_mfma_f32_32x32x16_bf16 v[96:111], v[200:203], v[156:159], v[96:111]
    v_mfma_f32_32x32x16_bf16 v[112:127], v[204:207], v[156:159], v[112:127]
    buffer_load_dwordx4 v[152:155], v3, s[8:11], s34 offen
    s_add_u32 s39, s34, 114688
    buffer_load_dwordx4 v[156:159], v3, s[8:11], s39 offen
    s_add_u32 m0, s38, 6144
    s_add_u32 s34, s34, 4096
    buffer_load_dwordx4 v6, s[12:15], s36 offen lds
    s_add_u32 m0, s38, 7168
    s_nop 0
    buffer_load_dwordx4 v7, s[12:15], s36 offen lds
    s_add_u32 s36, s36, 57344
    s_add_u32 s47, s47, 1
    s_cmp_eq_u32 s47, 28
    s_cselect_b32 s48, 114688, 0
    s_cselect_b32 s49, 1605632, 0
    s_sub_u32 s34, s34, s48
    s_sub_u32 s36, s36, s49
    s_waitcnt vmcnt(8)
    ds_read_b64_tr_b16 v[200:201], v10 offset:2048
    ds_read_b64_tr_b16 v[202:203], v10 offset:3072
    ds_read_b64_tr_b16 v[204:205], v11 offset:2048
    ds_read_b64_tr_b16 v[206:207], v11 offset:3072
    s_waitcnt lgkmcnt(4)
    v_mfma_f32_32x32x16_bf16 v[64:79], v[192:195], v[128:131], v[64:79]
    v_mfma_f32_32x32x16_bf16 v[80:95], v[196:199], v[128:131], v[80:95]
    v_mfma_f32_32x32x16_bf16 v[96:111], v[192:195], v[132:135], v[96:111]
    v_mfma_f32_32x32x16_bf16 v[112:127], v[196:199], v[132:135], v[112:127]
    buffer_load_dwordx4 v[128:131], v3, s[8:11], s34 offen
    s_add_u32 s39, s34, 114688
    buffer_load_dwordx4 v[132:135], v3, s[8:11], s39 offen
    s_add_u32 m0, s38, 0
    s_add_u32 s34, s34, 4096
    buffer_load_dwordx4 v6, s[12:15], s36 offen lds
    s_add_u32 m0, s38, 1024
    s_nop 0
    buffer_load_dwordx4 v7, s[12:15], s36 offen lds
    s_add_u32 s36, s36, 57344
    s_add_u32 s47, s47, 1
    s_cmp_eq_u32 s47, 28
    s_cselect_b32 s48, 114688, 0
    s_cselect_b32 s49, 1605632, 0
    s_sub_u32 s34, s34, s48
    s_sub_u32 s36, s36, s49
    s_waitcnt vmcnt(8)
    ds_read_b64_tr_b16 v[192:193], v10 offset:4096
    ds_read_b64_tr_b16 v[194:195], v10 offset:5120
    ds_read_b64_tr_b16 v[196:197], v11 offset:4096
    ds_read_b64_tr_b16 v[198:199], v11 offset:5120
    s_waitcnt lgkmcnt(4)
    v_mfma_f32_32x32x16_bf16 v[64:79], v[200:203], v[136:139], v[64:79]
    v_mfma_f32_32x32x16_bf16 v[80:95], v[204:207], v[136:139], v[80:95]
    v_mfma_f32_32x32x16_bf16 v[96:111], v[200:203], v[140:143], v[96:111]
    v_mfma_f32_32x32x16_bf16 v[112:127], v[204:207], v[140:143], v[112:127]
    buffer_load_dwordx4 v[136:139], v3, s[8:11], s34 offen
    s_add_u32 s39, s34, 114688
    buffer_load_dwordx4 v[140:143], v3, s[8:11], s39 offen
    s_add_u32 m0, s38, 2048
    s_add_u32 s34, s34, 4096
    buffer_load_dwordx4 v6, s[12:15], s36 offen lds
    s_add_u32 m0, s38, 3072
    s_nop 0
    buffer_load_dwordx4 v7, s[12:15], s36 offen lds
    s_add_u32 s36, s36, 57344
    s_add_u32 s47, s47, 1
    s_cmp_eq_u32 s47, 28
    s_cselect_b32 s48, 114688, 0
    s_cselect_b32 s49, 1605632, 0
    s_sub_u32 s34, s34, s48
    s_sub_u32 s36, s36, s49
    s_waitcnt vmcnt(8)
    ds_read_b64_tr_b16 v[200:201], v10 offset:6144
    ds_read_b64_tr_b16 v[202:203], v10 offset:7168
    ds_read_b64_tr_b16 v[204:205], v11 offset:6144
    ds_read_b64_tr_b16 v[206:207], v11 offset:7168
    s_waitcnt lgkmcnt(4)
    v_mfma_f32_32x32x16_bf16 v[64:79], v[192:195], v[144:147], v[64:79]
    v_mfma_f32_32x32x16_bf16 v[80:95], v[196:199], v[144:147], v[80:95]
    v_mfma_f32_32x32x16_bf16 v[96:111], v[192:195], v[148:151], v[96:111]
    v_mfma_f32_32x32x16_bf16 v[112:127], v[196:199], v[148:151], v[112:127]
    buffer_load_dwordx4 v[144:147], v3, s[8:11], s34 offen
    s_add_u32 s39, s34, 114688
    buffer_load_dwordx4 v[148:151], v3, s[8:11], s39 offen
    s_add_u32 m0, s38, 4096
    s_add_u32 s34, s34, 4096
    buffer_load_dwordx4 v6, s[12:15], s36 offen lds
    s_add_u32 m0, s38, 5120
    s_nop 0
    buffer_load_dwordx4 v7, s[12:15], s36 offen lds
    s_add_u32 s36, s36, 57344
    s_add_u32 s47, s47, 1
    s_cmp_eq_u32 s47, 28
    s_cselect_b32 s48, 114688, 0
    s_cselect_b32 s49, 1605632, 0
    s_sub_u32 s34, s34, s48
    s_sub_u32 s36, s36, s49
    s_waitcnt vmcnt(8)
    ds_read_b64_tr_b16 v[192:193], v10 offset:0
    ds_read_b64_tr_b16 v[194:195], v10 offset:1024
    ds_read_b64_tr_b16 v[196:197], v11 offset:0
    ds_read_b64_tr_b16 v[198:199], v11 offset:1024
    s_waitcnt lgkmcnt(4)
    v_mfma_f32_32x32x16_bf16 v[64:79], v[200:203], v[152:155], v[64:79]
    v_mfma_f32_32x32x16_bf16 v[80:95], v[204:207], v[152:155], v[80:95]
    v_mfma_f32_32x32x16_bf16 v[96:111], v[200:203], v[156:159], v[96:111]
    v_mfma_f32_32x32x16_bf16 v[112:127], v[204:207], v[156:159], v[112:127]
    buffer_load_dwordx4 v[152:155], v3, s[8:11], s34 offen
    s_add_u32 s39, s34, 114688
    buffer_load_dwordx4 v[156:159], v3, s[8:11], s39 offen
    s_add_u32 m0, s38, 6144
    s_add_u32 s34, s34, 4096
    buffer_load_dwordx4 v6, s[12:15], s36 offen lds
    s_add_u32 m0, s38, 7168
    s_nop 0
    buffer_load_dwordx4 v7, s[12:15], s36 offen lds
    s_add_u32 s36, s36, 57344
    s_add_u32 s47, s47, 1
    s_cmp_eq_u32 s47, 28
    s_cselect_b32 s48, 114688, 0
    s_cselect_b32 s49, 1605632, 0
    s_sub_u32 s34, s34, s48
    s_sub_u32 s36, s36, s49
    s_waitcnt vmcnt(8)
    ds_read_b64_tr_b16 v[200:201], v10 offset:2048
    ds_read_b64_tr_b16 v[202:203], v10 offset:3072
    ds_read_b64_tr_b16 v[204:205], v11 offset:2048
    ds_read_b64_tr_b16 v[206:207], v11 offset:3072
    s_waitcnt lgkmcnt(4)
    v_mfma_f32_32x32x16_bf16 v[64:79], v[192:195], v[128:131], v[64:79]
    v_mfma_f32_32x32x16_bf16 v[80:95], v[196:199], v[128:131], v[80:95]
    v_mfma_f32_32x32x16_bf16 v[96:111], v[192:195], v[132:135], v[96:111]
    v_mfma_f32_32x32x16_bf16 v[112:127], v[196:199], v[132:135], v[112:127]
    buffer_load_dwordx4 v[128:131], v3, s[8:11], s34 offen
    s_add_u32 s39, s34, 114688
    buffer_load_dwordx4 v[132:135], v3, s[8:11], s39 offen
    s_add_u32 m0, s38, 0
    s_add_u32 s34, s34, 4096
    buffer_load_dwordx4 v6, s[12:15], s36 offen lds
    s_add_u32 m0, s38, 1024
    s_nop 0
    buffer_load_dwordx4 v7, s[12:15], s36 offen lds
    s_add_u32 s36, s36, 57344
    s_add_u32 s47, s47, 1
    s_cmp_eq_u32 s47, 28
    s_cselect_b32 s48, 114688, 0
    s_cselect_b32 s49, 1605632, 0
    s_sub_u32 s34, s34, s48
    s_sub_u32 s36, s36, s49
    s_waitcnt vmcnt(8)
    ds_read_b64_tr_b16 v[192:193], v10 offset:4096
    ds_read_b64_tr_b16 v[194:195], v10 offset:5120
    ds_read_b64_tr_b16 v[196:197], v11 offset:4096
    ds_read_b64_tr_b16 v[198:199], v11 offset:5120
    s_waitcnt lgkmcnt(4)
    v_mfma_f32_32x32x16_bf16 v[64:79], v[200:203], v[136:139], v[64:79]
    v_mfma_f32_32x32x16_bf16 v[80:95], v[204:207], v[136:139], v[80:95]
    v_mfma_f32_32x32x16_bf16 v[96:111], v[200:203], v[140:143], v[96:111]
    v_mfma_f32_32x32x16_bf16 v[112:127], v[204:207], v[140:143], v[112:127]
    buffer_load_dwordx4 v[136:139], v3, s[8:11], s34 offen
    s_add_u32 s39, s34, 114688
    buffer_load_dwordx4 v[140:143], v3, s[8:11], s39 offen
    s_add_u32 m0, s38, 2048
    s_add_u32 s34, s34, 4096
    buffer_load_dwordx4 v6, s[12:15], s36 offen lds
    s_add_u32 m0, s38, 3072
    s_nop 0
    buffer_load_dwordx4 v7, s[12:15], s36 offen lds
    s_add_u32 s36, s36, 57344
    s_add_u32 s47, s47, 1
    s_cmp_eq_u32 s47, 28
    s_cselect_b32 s48, 114688, 0
    s_cselect_b32 s49, 1605632, 0
    s_sub_u32 s34, s34, s48
    s_sub_u32 s36, s36, s49
    s_waitcnt vmcnt(8)
    ds_read_b64_tr_b16 v[200:201], v10 offset:6144
    ds_read_b64_tr_b16 v[202:203], v10 offset:7168
    ds_read_b64_tr_b16 v[204:205], v11 offset:6144
    ds_read_b64_tr_b16 v[206:207], v11 offset:7168
    s_waitcnt lgkmcnt(4)
    v_mfma_f32_32x32x16_bf16 v[64:79], v[192:195], v[144:147], v[64:79]
    v_mfma_f32_32x32x16_bf16 v[80:95], v[196:199], v[144:147], v[80:95]
    v_mfma_f32_32x32x16_bf16 v[96:111], v[192:195], v[148:151], v[96:111]
    v_mfma_f32_32x32x16_bf16 v[112:127], v[196:199], v[148:151], v[112:127]
    buffer_load_dwordx4 v[144:147], v3, s[8:11], s34 offen
    s_add_u32 s39, s34, 114688
    buffer_load_dwordx4 v[148:151], v3, s[8:11], s39 offen
    s_add_u32 m0, s38, 4096
    s_add_u32 s34, s34, 4096
    buffer_load_dwordx4 v6, s[12:15], s36 offen lds
    s_add_u32 m0, s38, 5120
    s_nop 0
    buffer_load_dwordx4 v7, s[12:15], s36 offen lds
    s_add_u32 s36, s36, 57344
    s_add_u32 s47, s47, 1
    s_cmp_eq_u32 s47, 28
    s_cselect_b32 s48, 114688, 0
    s_cselect_b32 s49, 1605632, 0
    s_sub_u32 s34, s34, s48
    s_sub_u32 s36, s36, s49
    s_waitcnt vmcnt(8)
    ds_read_b64_tr_b16 v[192:193], v10 offset:0
    ds_read_b64_tr_b16 v[194:195], v10 offset:1024
    ds_read_b64_tr_b16 v[196:197], v11 offset:0
    ds_read_b64_tr_b16 v[198:199], v11 offset:1024
    s_waitcnt lgkmcnt(4)
    v_mfma_f32_32x32x16_bf16 v[64:79], v[200:203], v[152:155], v[64:79]
    v_mfma_f32_32x32x16_bf16 v[80:95], v[204:207], v[152:155], v[80:95]
    v_mfma_f32_32x32x16_bf16 v[96:111], v[200:203], v[156:159], v[96:111]
    v_mfma_f32_32x32x16_bf16 v[112:127], v[204:207], v[156:159], v[112:127]
    buffer_load_dwordx4 v[152:155], v3, s[8:11], s34 offen
    s_add_u32 s39, s34, 114688
    buffer_load_dwordx4 v[156:159], v3, s[8:11], s39 offen
    s_add_u32 m0, s38, 6144
    s_add_u32 s34, s34, 4096
    buffer_load_dwordx4 v6, s[12:15], s36 offen lds
    s_add_u32 m0, s38, 7168
    s_nop 0
    buffer_load_dwordx4 v7, s[12:15], s36 offen lds
    s_add_u32 s36, s36, 57344
    s_add_u32 s47, s47, 1
    s_cmp_eq_u32 s47, 28
    s_cselect_b32 s48, 114688, 0
    s_cselect_b32 s49, 1605632, 0
    s_sub_u32 s34, s34, s48
    s_sub_u32 s36, s36, s49
    s_waitcnt vmcnt(8)
    ds_read_b64_tr_b16 v[200:201], v10 offset:2048
    ds_read_b64_tr_b16 v[202:203], v10 offset:3072
    ds_read_b64_tr_b16 v[204:205], v11 offset:2048
    ds_read_b64_tr_b16 v[206:207], v11 offset:3072
    s_waitcnt lgkmcnt(4)
    v_mfma_f32_32x32x16_bf16 v[64:79], v[192:195], v[128:131], v[64:79]
    v_mfma_f32_32x32x16_bf16 v[80:95], v[196:199], v[128:131], v[80:95]
    v_mfma_f32_32x32x16_bf16 v[96:111], v[192:195], v[132:135], v[96:111]
    v_mfma_f32_32x32x16_bf16 v[112:127], v[196:199], v[132:135], v[112:127]
    buffer_load_dwordx4 v[128:131], v3, s[8:11], s34 offen
    s_add_u32 s39, s34, 114688
    buffer_load_dwordx4 v[132:135], v3, s[8:11], s39 offen
    s_add_u32 m0, s38, 0
    s_add_u32 s34, s34, 4096
    buffer_load_dwordx4 v6, s[12:15], s36 offen lds
    s_add_u32 m0, s38, 1024
    s_nop 0
    buffer_load_dwordx4 v7, s[12:15], s36 offen lds
    s_add_u32 s36, s36, 57344
    s_add_u32 s47, s47, 1
    s_cmp_eq_u32 s47, 28
    s_cselect_b32 s48, 114688, 0
    s_cselect_b32 s49, 1605632, 0
    s_sub_u32 s34, s34, s48
    s_sub_u32 s36, s36, s49
    s_waitcnt vmcnt(8)
    ds_read_b64_tr_b16 v[192:193], v10 offset:4096
    ds_read_b64_tr_b16 v[194:195], v10 offset:5120
    ds_read_b64_tr_b16 v[196:197], v11 offset:4096
    ds_read_b64_tr_b16 v[198:199], v11 offset:5120
    s_waitcnt lgkmcnt(4)
    v_mfma_f32_32x32x16_bf16 v[64:79], v[200:203], v[136:139], v[64:79]
    v_mfma_f32_32x32x16_bf16 v[80:95], v[204:207], v[136:139], v[80:95]
    v_mfma_f32_32x32x16_bf16 v[96:111], v[200:203], v[140:143], v[96:111]
    v_mfma_f32_32x32x16_bf16 v[112:127], v[204:207], v[140:143], v[112:127]
    buffer_load_dwordx4 v[136:139], v3, s[8:11], s34 offen
    s_add_u32 s39, s34, 114688
    buffer_load_dwordx4 v[140:143], v3, s[8:11], s39 offen
    s_add_u32 m0, s38, 2048
    s_add_u32 s34, s34, 4096
    buffer_load_dwordx4 v6, s[12:15], s36 offen lds
    s_add_u32 m0, s38, 3072
    s_nop 0
    buffer_load_dwordx4 v7, s[12:15], s36 offen lds
    s_add_u32 s36, s36, 57344
    s_add_u32 s47, s47, 1
    s_cmp_eq_u32 s47, 28
    s_cselect_b32 s48, 114688, 0
    s_cselect_b32 s49, 1605632, 0
    s_sub_u32 s34, s34, s48
    s_sub_u32 s36, s36, s49
    s_waitcnt vmcnt(8)
    ds_read_b64_tr_b16 v[200:201], v10 offset:6144
    ds_read_b64_tr_b16 v[202:203], v10 offset:7168
    ds_read_b64_tr_b16 v[204:205], v11 offset:6144
    ds_read_b64_tr_b16 v[206:207], v11 offset:7168
    s_waitcnt lgkmcnt(4)
    v_mfma_f32_32x32x16_bf16 v[64:79], v[192:195], v[144:147], v[64:79]
    v_mfma_f32_32x32x16_bf16 v[80:95], v[196:199], v[144:147], v[80:95]
    v_mfma_f32_32x32x16_bf16 v[96:111], v[192:195], v[148:151], v[96:111]
    v_mfma_f32_32x32x16_bf16 v[112:127], v[196:199], v[148:151], v[112:127]
    buffer_load_dwordx4 v[144:147], v3, s[8:11], s34 offen
    s_add_u32 s39, s34, 114688
    buffer_load_dwordx4 v[148:151], v3, s[8:11], s39 offen
    s_add_u32 m0, s38, 4096
    s_add_u32 s34, s34, 4096
    buffer_load_dwordx4 v6, s[12:15], s36 offen lds
    s_add_u32 m0, s38, 5120
    s_nop 0
    buffer_load_dwordx4 v7, s[12:15], s36 offen lds
    s_add_u32 s36, s36, 57344
    s_add_u32 s47, s47, 1
    s_cmp_eq_u32 s47, 28
    s_cselect_b32 s48, 114688, 0
    s_cselect_b32 s49, 1605632, 0
    s_sub_u32 s34, s34, s48
    s_sub_u32 s36, s36, s49
    s_waitcnt vmcnt(8)
    ds_read_b64_tr_b16 v[192:193], v10 offset:0
    ds_read_b64_tr_b16 v[194:195], v10 offset:1024
    ds_read_b64_tr_b16 v[196:197], v11 offset:0
    ds_read_b64_tr_b16 v[198:199], v11 offset:1024
    s_waitcnt lgkmcnt(4)
    v_mfma_f32_32x32x16_bf16 v[64:79], v[200:203], v[152:155], v[64:79]
    v_mfma_f32_32x32x16_bf16 v[80:95], v[204:207], v[152:155], v[80:95]
    v_mfma_f32_32x32x16_bf16 v[96:111], v[200:203], v[156:159], v[96:111]
    v_mfma_f32_32x32x16_bf16 v[112:127], v[204:207], v[156:159], v[112:127]
    buffer_load_dwordx4 v[152:155], v3, s[8:11], s34 offen
    s_add_u32 s39, s34, 114688
    buffer_load_dwordx4 v[156:159], v3, s[8:11], s39 offen
    s_add_u32 m0, s38, 6144
    s_add_u32 s34, s34, 4096
    buffer_load_dwordx4 v6, s[12:15], s36 offen lds
    s_add_u32 m0, s38, 7168
    s_nop 0
    buffer_load_dwordx4 v7, s[12:15], s36 offen lds
    s_add_u32 s36, s36, 57344
    s_add_u32 s47, s47, 1
    s_cmp_eq_u32 s47, 28
    s_cselect_b32 s48, 114688, 0
    s_cselect_b32 s49, 1605632, 0
    s_sub_u32 s34, s34, s48
    s_sub_u32 s36, s36, s49
    s_waitcnt vmcnt(8)
    ds_read_b64_tr_b16 v[200:201], v10 offset:2048
    ds_read_b64_tr_b16 v[202:203], v10 offset:3072
    ds_read_b64_tr_b16 v[204:205], v11 offset:2048
    ds_read_b64_tr_b16 v[206:207], v11 offset:3072
    s_waitcnt lgkmcnt(4)
    v_mfma_f32_32x32x16_bf16 v[64:79], v[192:195], v[128:131], v[64:79]
    v_mfma_f32_32x32x16_bf16 v[80:95], v[196:199], v[128:131], v[80:95]
    v_mfma_f32_32x32x16_bf16 v[96:111], v[192:195], v[132:135], v[96:111]
    v_mfma_f32_32x32x16_bf16 v[112:127], v[196:199], v[132:135], v[112:127]
    buffer_load_dwordx4 v[128:131], v3, s[8:11], s34 offen
    s_add_u32 s39, s34, 114688
    buffer_load_dwordx4 v[132:135], v3, s[8:11], s39 offen
    s_add_u32 m0, s38, 0
    s_add_u32 s34, s34, 4096
    buffer_load_dwordx4 v6, s[12:15], s36 offen lds
    s_add_u32 m0, s38, 1024
    s_nop 0
    buffer_load_dwordx4 v7, s[12:15], s36 offen lds
    s_add_u32 s36, s36, 57344
    s_add_u32 s47, s47, 1
    s_cmp_eq_u32 s47, 28
    s_cselect_b32 s48, 114688, 0
    s_cselect_b32 s49, 1605632, 0
    s_sub_u32 s34, s34, s48
    s_sub_u32 s36, s36, s49
    s_waitcnt vmcnt(8)
    ds_read_b64_tr_b16 v[192:193], v10 offset:4096
    ds_read_b64_tr_b16 v[194:195], v10 offset:5120
    ds_read_b64_tr_b16 v[196:197], v11 offset:4096
    ds_read_b64_tr_b16 v[198:199], v11 offset:5120
    s_waitcnt lgkmcnt(4)
    v_mfma_f32_32x32x16_bf16 v[64:79], v[200:203], v[136:139], v[64:79]
    v_mfma_f32_32x32x16_bf16 v[80:95], v[204:207], v[136:139], v[80:95]
    v_mfma_f32_32x32x16_bf16 v[96:111], v[200:203], v[140:143], v[96:111]
    v_mfma_f32_32x32x16_bf16 v[112:127], v[204:207], v[140:143], v[112:127]
    buffer_load_dwordx4 v[136:139], v3, s[8:11], s34 offen
    s_add_u32 s39, s34, 114688
    buffer_load_dwordx4 v[140:143], v3, s[8:11], s39 offen
    s_add_u32 m0, s38, 2048
    s_add_u32 s34, s34, 4096
    buffer_load_dwordx4 v6, s[12:15], s36 offen lds
    s_add_u32 m0, s38, 3072
    s_nop 0
    buffer_load_dwordx4 v7, s[12:15], s36 offen lds
    s_add_u32 s36, s36, 57344
    s_add_u32 s47, s47, 1
    s_cmp_eq_u32 s47, 28
    s_cselect_b32 s48, 114688, 0
    s_cselect_b32 s49, 1605632, 0
    s_sub_u32 s34, s34, s48
    s_sub_u32 s36, s36, s49
    s_waitcnt vmcnt(8)
    ds_read_b64_tr_b16 v[200:201], v10 offset:6144
    ds_read_b64_tr_b16 v[202:203], v10 offset:7168
    ds_read_b64_tr_b16 v[204:205], v11 offset:6144
    ds_read_b64_tr_b16 v[206:207], v11 offset:7168
    s_waitcnt lgkmcnt(4)
    v_mfma_f32_32x32x16_bf16 v[64:79], v[192:195], v[144:147], v[64:79]
    v_mfma_f32_32x32x16_bf16 v[80:95], v[196:199], v[144:147], v[80:95]
    v_mfma_f32_32x32x16_bf16 v[96:111], v[192:195], v[148:151], v[96:111]
    v_mfma_f32_32x32x16_bf16 v[112:127], v[196:199], v[148:151], v[112:127]
    buffer_load_dwordx4 v[144:147], v3, s[8:11], s34 offen
    s_add_u32 s39, s34, 114688
    buffer_load_dwordx4 v[148:151], v3, s[8:11], s39 offen
    s_add_u32 m0, s38, 4096
    s_add_u32 s34, s34, 4096
    buffer_load_dwordx4 v6, s[12:15], s36 offen lds
    s_add_u32 m0, s38, 5120
    s_nop 0
    buffer_load_dwordx4 v7, s[12:15], s36 offen lds
    s_add_u32 s36, s36, 57344
    s_add_u32 s47, s47, 1
    s_cmp_eq_u32 s47, 28
    s_cselect_b32 s48, 114688, 0
    s_cselect_b32 s49, 1605632, 0
    s_sub_u32 s34, s34, s48
    s_sub_u32 s36, s36, s49
    s_waitcnt vmcnt(8)
    ds_read_b64_tr_b16 v[192:193], v10 offset:0
    ds_read_b64_tr_b16 v[194:195], v10 offset:1024
    ds_read_b64_tr_b16 v[196:197], v11 offset:0
    ds_read_b64_tr_b16 v[198:199], v11 offset:1024
    s_waitcnt lgkmcnt(4)
    v_mfma_f32_32x32x16_bf16 v[64:79], v[200:203], v[152:155], v[64:79]
    v_mfma_f32_32x32x16_bf16 v[80:95], v[204:207], v[152:155], v[80:95]
    v_mfma_f32_32x32x16_bf16 v[96:111], v[200:203], v[156:159], v[96:111]
    v_mfma_f32_32x32x16_bf16 v[112:127], v[204:207], v[156:159], v[112:127]
    buffer_load_dwordx4 v[152:155], v3, s[8:11], s34 offen
    s_add_u32 s39, s34, 114688
    buffer_load_dwordx4 v[156:159], v3, s[8:11], s39 offen
    s_add_u32 m0, s38, 6144
    s_add_u32 s34, s34, 4096
    buffer_load_dwordx4 v6, s[12:15], s36 offen lds
    s_add_u32 m0, s38, 7168
    s_nop 0
    buffer_load_dwordx4 v7, s[12:15], s36 offen lds
    s_add_u32 s36, s36, 57344
    s_add_u32 s47, s47, 1
    s_cmp_eq_u32 s47, 28
    s_cselect_b32 s48, 114688, 0
    s_cselect_b32 s49, 1605632, 0
    s_sub_u32 s34, s34, s48
    s_sub_u32 s36, s36, s49
    s_waitcnt vmcnt(8)
    ds_read_b64_tr_b16 v[200:201], v10 offset:2048
    ds_read_b64_tr_b16 v[202:203], v10 offset:3072
    ds_read_b64_tr_b16 v[204:205], v11 offset:2048
    ds_read_b64_tr_b16 v[206:207], v11 offset:3072
    s_waitcnt lgkmcnt(4)
    v_mfma_f32_32x32x16_bf16 v[64:79], v[192:195], v[128:131], v[64:79]
    v_mfma_f32_32x32x16_bf16 v[80:95], v[196:199], v[128:131], v[80:95]
    v_mfma_f32_32x32x16_bf16 v[96:111], v[192:195], v[132:135], v[96:111]
    v_mfma_f32_32x32x16_bf16 v[112:127], v[196:199], v[132:135], v[112:127]
    s_waitcnt vmcnt(4)
    ds_read_b64_tr_b16 v[192:193], v10 offset:4096
    ds_read_b64_tr_b16 v[194:195], v10 offset:5120
    ds_read_b64_tr_b16 v[196:197], v11 offset:4096
    ds_read_b64_tr_b16 v[198:199], v11 offset:5120
    s_waitcnt lgkmcnt(4)
    v_mfma_f32_32x32x16_bf16 v[64:79], v[200:203], v[136:139], v[64:79]
    v_mfma_f32_32x32x16_bf16 v[80:95], v[204:207], v[136:139], v[80:95]
    v_mfma_f32_32x32x16_bf16 v[96:111], v[200:203], v[140:143], v[96:111]
    v_mfma_f32_32x32x16_bf16 v[112:127], v[204:207], v[140:143], v[112:127]
    s_waitcnt vmcnt(0)
    ds_read_b64_tr_b16 v[200:201], v10 offset:6144
    ds_read_b64_tr_b16 v[202:203], v10 offset:7168
    ds_read_b64_tr_b16 v[204:205], v11 offset:6144
    ds_read_b64_tr_b16 v[206:207], v11 offset:7168
    s_waitcnt lgkmcnt(4)
    v_mfma_f32_32x32x16_bf16 v[64:79], v[192:195], v[144:147], v[64:79]
    v_mfma_f32_32x32x16_bf16 v[80:95], v[196:199], v[144:147], v[80:95]
    v_mfma_f32_32x32x16_bf16 v[96:111], v[192:195], v[148:151], v[96:111]
    v_mfma_f32_32x32x16_bf16 v[112:127], v[196:199], v[148:151], v[112:127]
    s_waitcnt lgkmcnt(0)
    v_mfma_f32_32x32x16_bf16 v[64:79], v[200:203], v[152:155], v[64:79]
    v_mfma_f32_32x32x16_bf16 v[80:95], v[204:207], v[152:155], v[80:95]
    v_mfma_f32_32x32x16_bf16 v[96:111], v[200:203], v[156:159], v[96:111]
    v_mfma_f32_32x32x16_bf16 v[112:127], v[204:207], v[156:159], v[112:127]
    s_lshr_b32 s40, s3, 1
    s_and_b32 s41, s3, 1
    s_lshl_b32 s42, s30, 1
    s_add_u32 s42, s42, s40
    s_lshl_b32 s43, s31, 1
    s_add_u32 s43, s43, s41
    v_and_b32 v12, 31, v1
    s_add_u32 s16, s28, 0x800000
    s_addc_u32 s17, s29, 0
    s_mov_b32 s18, 0x1c0000
    s_mov_b32 s19, 0x00020000
    s_mov_b32 s24, s20
    s_mov_b32 s25, s21
    s_mov_b32 s26, 0x1c0000
    s_mov_b32 s27, 0x00020000
    s_mul_i32 s45, s42, 28
    s_lshl_b32 s46, s43, 1
    s_add_u32 s45, s45, s46
    s_lshl_b32 s45, s45, 10
    buffer_load_dwordx4 v[208:211], v3, s[16:19], s45 offen offset:0
    buffer_load_dwordx4 v[212:215], v3, s[16:19], s45 offen offset:1024
    s_barrier
    s_nop 7
    s_cmp_eq_u32 s3, 0
    s_cbranch_scc1 k5_down_kernel_own1
    s_sub_u32 s45, s3, 1
    s_and_b32 s45, s45, 3
    s_lshl_b32 s45, s45, 12
    s_add_u32 s45, s45, 0
    v_add_u32 v14, s45, v3
    ds_write_b128 v14, v[64:67] offset:0
    ds_write_b128 v14, v[68:71] offset:1024
    ds_write_b128 v14, v[72:75] offset:2048
    ds_write_b128 v14, v[76:79] offset:3072
k5_down_kernel_own1:
    s_cmp_eq_u32 s3, 1
    s_cbranch_scc1 k5_down_kernel_own2
    s_sub_u32 s45, s3, 2
    s_and_b32 s45, s45, 3
    s_lshl_b32 s45, s45, 12
    s_add_u32 s45, s45, 12288
    v_add_u32 v14, s45, v3
    ds_write_b128 v14, v[80:83] offset:0
    ds_write_b128 v14, v[84:87] offset:1024
    ds_write_b128 v14, v[88:91] offset:2048
    ds_write_b128 v14, v[92:95] offset:3072
k5_down_kernel_own2:
    s_cmp_eq_u32 s3, 2
    s_cbranch_scc1 k5_down_kernel_own3
    s_sub_u32 s45, s3, 3
    s_and_b32 s45, s45, 3
    s_lshl_b32 s45, s45, 12
    s_add_u32 s45, s45, 24576
    v_add_u32 v14, s45, v3
    ds_write_b128 v14, v[96:99] offset:0
    ds_write_b128 v14, v[100:103] offset:1024
    ds_write_b128 v14, v[104:107] offset:2048
    ds_write_b128 v14, v[108:111] offset:3072
k5_down_kernel_own3:
    s_cmp_eq_u32 s3, 3
    s_cbranch_scc1 k5_down_kernel_own4
    s_sub_u32 s45, s3, 4
    s_and_b32 s45, s45, 3
    s_lshl_b32 s45, s45, 12
    s_add_u32 s45, s45, 36864
    v_add_u32 v14, s45, v3
    ds_write_b128 v14, v[112:115] offset:0
    ds_write_b128 v14, v[116:119] offset:1024
    ds_write_b128 v14, v[120:123] offset:2048
    ds_write_b128 v14, v[124:127] offset:3072
k5_down_kernel_own4:
    s_cmp_lg_u32 s3, 0
    s_cbranch_scc1 k5_down_kernel_mv5
    v_mov_b32 v128, v64
    v_mov_b32 v129, v65
    v_mov_b32 v130, v66
    v_mov_b32 v131, v67
    v_mov_b32 v132, v68
    v_mov_b32 v133, v69
    v_mov_b32 v134, v70
    v_mov_b32 v135, v71
    v_mov_b32 v136, v72
    v_mov_b32 v137, v73
    v_mov_b32 v138, v74
    v_mov_b32 v139, v75
    v_mov_b32 v140, v76
    v_mov_b32 v141, v77
    v_mov_b32 v142, v78
    v_mov_b32 v143, v79
k5_down_kernel_mv5:
    s_cmp_lg_u32 s3, 1
    s_cbranch_scc1 k5_down_kernel_mv6
    v_mov_b32 v128, v80
    v_mov_b32 v129, v81
    v_mov_b32 v130, v82
    v_mov_b32 v131, v83
    v_mov_b32 v132, v84
    v_mov_b32 v133, v85
    v_mov_b32 v134, v86
    v_mov_b32 v135, v87
    v_mov_b32 v136, v88
    v_mov_b32 v137, v89
    v_mov_b32 v138, v90
    v_mov_b32 v139, v91
    v_mov_b32 v140, v92
    v_mov_b32 v141, v93
    v_mov_b32 v142, v94
    v_mov_b32 v143, v95
k5_down_kernel_mv6:
    s_cmp_lg_u32 s3, 2
    s_cbranch_scc1 k5_down_kernel_mv7
    v_mov_b32 v128, v96
    v_mov_b32 v129, v97
    v_mov_b32 v130, v98
    v_mov_b32 v131, v99
    v_mov_b32 v132, v100
    v_mov_b32 v133, v101
    v_mov_b32 v134, v102
    v_mov_b32 v135, v103
    v_mov_b32 v136, v104
    v_mov_b32 v137, v105
    v_mov_b32 v138, v106
    v_mov_b32 v139, v107
    v_mov_b32 v140, v108
    v_mov_b32 v141, v109
    v_mov_b32 v142, v110
    v_mov_b32 v143, v111
k5_down_kernel_mv7:
    s_cmp_lg_u32 s3, 3
    s_cbranch_scc1 k5_down_kernel_mv8
    v_mov_b32 v128, v112
    v_mov_b32 v129, v113
    v_mov_b32 v130, v114
    v_mov_b32 v131, v115
    v_mov_b32 v132, v116
    v_mov_b32 v133, v117
    v_mov_b32 v134, v118
    v_mov_b32 v135, v119
    v_mov_b32 v136, v120
    v_mov_b32 v137, v121
    v_mov_b32 v138, v122
    v_mov_b32 v139, v123
    v_mov_b32 v140, v124
    v_mov_b32 v141, v125
    v_mov_b32 v142, v126
    v_mov_b32 v143, v127
k5_down_kernel_mv8:
    s_waitcnt lgkmcnt(0)
    s_barrier
    s_mul_i32 s45, s3, 12288
    v_add_u32 v14, s45, v3
    ds_read_b128 v[144:147], v14 offset:0
    ds_read_b128 v[148:151], v14 offset:1024
    ds_read_b128 v[152:155], v14 offset:2048
    ds_read_b128 v[156:159], v14 offset:3072
    ds_read_b128 v[160:163], v14 offset:4096
    ds_read_b128 v[164:167], v14 offset:5120
    ds_read_b128 v[168:171], v14 offset:6144
    ds_read_b128 v[172:175], v14 offset:7168
    ds_read_b128 v[176:179], v14 offset:8192
    ds_read_b128 v[180:183], v14 offset:9216
    ds_read_b128 v[184:187], v14 offset:10240
    ds_read_b128 v[188:191], v14 offset:11264
    s_waitcnt lgkmcnt(8)
    v_add_f32 v128, v128, v144
    v_add_f32 v129, v129, v145
    v_add_f32 v130, v130, v146
    v_add_f32 v131, v131, v147
    v_add_f32 v132, v132, v148
    v_add_f32 v133, v133, v149
    v_add_f32 v134, v134, v150
    v_add_f32 v135, v135, v151
    v_add_f32 v136, v136, v152
    v_add_f32 v137, v137, v153
    v_add_f32 v138, v138, v154
    v_add_f32 v139, v139, v155
    v_add_f32 v140, v140, v156
    v_add_f32 v141, v141, v157
    v_add_f32 v142, v142, v158
    v_add_f32 v143, v143, v159
    s_waitcnt lgkmcnt(4)
    v_add_f32 v128, v128, v160
    v_add_f32 v129, v129, v161
    v_add_f32 v130, v130, v162
    v_add_f32 v131, v131, v163
    v_add_f32 v132, v132, v164
    v_add_f32 v133, v133, v165
    v_add_f32 v134, v134, v166
    v_add_f32 v135, v135, v167
    v_add_f32 v136, v136, v168
    v_add_f32 v137, v137, v169
    v_add_f32 v138, v138, v170
    v_add_f32 v139, v139, v171
    v_add_f32 v140, v140, v172
    v_add_f32 v141, v141, v173
    v_add_f32 v142, v142, v174
    v_add_f32 v143, v143, v175
    s_waitcnt lgkmcnt(0)
    v_add_f32 v128, v128, v176
    v_add_f32 v129, v129, v177
    v_add_f32 v130, v130, v178
    v_add_f32 v131, v131, v179
    v_add_f32 v132, v132, v180
    v_add_f32 v133, v133, v181
    v_add_f32 v134, v134, v182
    v_add_f32 v135, v135, v183
    v_add_f32 v136, v136, v184
    v_add_f32 v137, v137, v185
    v_add_f32 v138, v138, v186
    v_add_f32 v139, v139, v187
    v_add_f32 v140, v140, v188
    v_add_f32 v141, v141, v189
    v_add_f32 v142, v142, v190
    v_add_f32 v143, v143, v191
    s_waitcnt vmcnt(0)
    v_lshlrev_b32 v14, 16, v208
    v_and_b32 v15, 0xffff0000, v208
    v_add_f32 v14, v14, v128
    v_add_f32 v15, v15, v129
    v_cvt_pk_bf16_f32 v208, v14, v15
    v_lshlrev_b32 v14, 16, v209
    v_and_b32 v15, 0xffff0000, v209
    v_add_f32 v14, v14, v130
    v_add_f32 v15, v15, v131
    v_cvt_pk_bf16_f32 v209, v14, v15
    v_lshlrev_b32 v14, 16, v210
    v_and_b32 v15, 0xffff0000, v210
    v_add_f32 v14, v14, v132
    v_add_f32 v15, v15, v133
    v_cvt_pk_bf16_f32 v210, v14, v15
    v_lshlrev_b32 v14, 16, v211
    v_and_b32 v15, 0xffff0000, v211
    v_add_f32 v14, v14, v134
    v_add_f32 v15, v15, v135
    v_cvt_pk_bf16_f32 v211, v14, v15
    v_lshlrev_b32 v14, 16, v212
    v_and_b32 v15, 0xffff0000, v212
    v_add_f32 v14, v14, v136
    v_add_f32 v15, v15, v137
    v_cvt_pk_bf16_f32 v212, v14, v15
    v_lshlrev_b32 v14, 16, v213
    v_and_b32 v15, 0xffff0000, v213
    v_add_f32 v14, v14, v138
    v_add_f32 v15, v15, v139
    v_cvt_pk_bf16_f32 v213, v14, v15
    v_lshlrev_b32 v14, 16, v214
    v_and_b32 v15, 0xffff0000, v214
    v_add_f32 v14, v14, v140
    v_add_f32 v15, v15, v141
    v_cvt_pk_bf16_f32 v214, v14, v15
    v_lshlrev_b32 v14, 16, v215
    v_and_b32 v15, 0xffff0000, v215
    v_add_f32 v14, v14, v142
    v_add_f32 v15, v15, v143
    v_cvt_pk_bf16_f32 v215, v14, v15
    s_nop 1
    v_permlane32_swap_b32 v208, v210
    v_permlane32_swap_b32 v209, v211
    v_permlane32_swap_b32 v212, v214
    v_permlane32_swap_b32 v213, v215
    s_lshl_b32 s45, s42, 5
    v_add_u32 v13, s45, v12
    v_mul_u32_u24 v13, s44, v13
    v_lshl_add_u32 v13, v8, 4, v13
    s_lshl_b32 s45, s43, 6
    s_nop 0
    buffer_store_dwordx4 v[208:211], v13, s[24:27], s45 offen offset:0
    buffer_store_dwordx4 v[212:215], v13, s[24:27], s45 offen offset:32
k5_down_kernel_end:
    s_endpgm
.section .rodata,"a"
.p2align 6
.amdhsa_kernel k1_qkv_kernel
  .amdhsa_next_free_vgpr 512
  .amdhsa_next_free_sgpr 102
  .amdhsa_accum_offset 256
  .amdhsa_group_segment_fixed_size 0
  .amdhsa_kernarg_size 80
  .amdhsa_user_sgpr_count 2
  .amdhsa_user_sgpr_kernarg_segment_ptr 1
  .amdhsa_system_sgpr_workgroup_id_x 1
.end_amdhsa_kernel
.p2align 6
.amdhsa_kernel k2_attn_kernel
  .amdhsa_next_free_vgpr 256
  .amdhsa_next_free_sgpr 102
  .amdhsa_accum_offset 256
  .amdhsa_group_segment_fixed_size 0
  .amdhsa_kernarg_size 80
  .amdhsa_user_sgpr_count 2
  .amdhsa_user_sgpr_kernarg_segment_ptr 1
  .amdhsa_system_sgpr_workgroup_id_x 1
.end_amdhsa_kernel
.p2align 6
.amdhsa_kernel k3_wo_kernel
  .amdhsa_next_free_vgpr 256
  .amdhsa_next_free_sgpr 102
  .amdhsa_accum_offset 256
  .amdhsa_group_segment_fixed_size 0
  .amdhsa_kernarg_size 80
  .amdhsa_user_sgpr_count 2
  .amdhsa_user_sgpr_kernarg_segment_ptr 1
  .amdhsa_system_sgpr_workgroup_id_x 1
.end_amdhsa_kernel
.p2align 6
.amdhsa_kernel k4_ffn_kernel
  .amdhsa_next_free_vgpr 256
  .amdhsa_next_free_sgpr 102
  .amdhsa_accum_offset 256
  .amdhsa_group_segment_fixed_size 0
  .amdhsa_kernarg_size 80
  .amdhsa_user_sgpr_count 2
  .amdhsa_user_sgpr_kernarg_segment_ptr 1
  .amdhsa_system_sgpr_workgroup_id_x 1
.end_amdhsa_kernel
.p2align 6
.amdhsa_kernel k5_down_kernel
  .amdhsa_next_free_vgpr 256
  .amdhsa_next_free_sgpr 102
  .amdhsa_accum_offset 256
  .amdhsa_group_segment_fixed_size 0
  .amdhsa_kernarg_size 80
  .amdhsa_user_sgpr_count 2
  .amdhsa_user_sgpr_kernarg_segment_ptr 1
  .amdhsa_system_sgpr_workgroup_id_x 1
.end_amdhsa_kernel
```
